```python
import torch

def _softmax(x, axis=-1):
    return torch.softmax(x, dim=axis)
def _gelu(x):
    return torch.nn.functional.gelu(x, approximate="tanh")
def _silu(x):
    return torch.nn.functional.silu(x)
def _sigmoid(x):
    return torch.sigmoid(x)
def _layernorm(x, axis=-1, eps=1e-5):
    m = x.mean(dim=axis, keepdim=True)
    v = x.var(dim=axis, keepdim=True, unbiased=False)
    return (x - m) / torch.sqrt(v + eps)
def _scatter_add(tgt, idx, src, axis=0):
    return tgt.clone().index_add_(axis, idx, src)
def _segment_sum(src, seg, n):
    out = torch.zeros((n,) + src.shape[1:], dtype=src.dtype)
    return out.index_add_(0, seg, src)
def _pad(x, pw):
    flat = tuple(v for pair in reversed(pw) for v in pair)
    return torch.nn.functional.pad(x, flat)

kernel_name = 'parallel_sum__sliding_block__swiglu_ffn__prompt'

def setup_inputs():

    _w = (lambda a: (lambda t: t.to(torch.bfloat16) if t.is_floating_point() else t)(torch.as_tensor(a)))
    def _A_setup():
        B, S, D = 1, 2048, 640
        return {
            "x": _w((lambda *s: torch.randn(*s, dtype=torch.bfloat16) * 0.05)(B, S, D)),
            "wqkv": _w((lambda *s: torch.randn(*s, dtype=torch.bfloat16) * 0.05)(D, 3 * D)),
            "wo": _w((lambda *s: torch.randn(*s, dtype=torch.bfloat16) * 0.05)(D, D)),
        }
    _A_in = _A_setup()

    def _B_setup():
        B, S, D, F = 1, 2048, 640, 1536
        return {
            "x": _w((lambda *s: torch.randn(*s, dtype=torch.bfloat16) * 0.05)(B, S, D)),
            "w_gate": _w((lambda *s: torch.randn(*s, dtype=torch.bfloat16) * 0.05)(D, F)),
            "w_up": _w((lambda *s: torch.randn(*s, dtype=torch.bfloat16) * 0.05)(D, F)),
            "w_down": _w((lambda *s: torch.randn(*s, dtype=torch.bfloat16) * 0.05)(F, D)),
        }
    _B_in = _B_setup()

    return {
        "A_x": _A_in["x"],
        "A_wqkv": _A_in["wqkv"],
        "A_wo": _A_in["wo"],
        "B_x": _B_in["x"],
        "B_w_gate": _B_in["w_gate"],
        "B_w_up": _B_in["w_up"],
        "B_w_down": _B_in["w_down"],
    }

def reference(A_x, A_wqkv, A_wo, B_x, B_w_gate, B_w_up, B_w_down):
    def _A_ref(x, wqkv, wo):
        B, S, D = x.shape
        H = 32; Dh = D // H; W = 256
        qkv = (lambda x, *d: x.permute(*d))((x @ wqkv).reshape(B, S, 3, H, Dh), 2, 0, 3, 1, 4)
        q, k, v = qkv[0], qkv[1], qkv[2]
        scores = torch.einsum("bhqd,bhkd->bhqk", q, k) * (Dh ** -0.5)
        idx = torch.arange(S)
        mask = (idx[:, None] - idx[None, :] >= 0) & (idx[:, None] - idx[None, :] < W)
        scores = torch.where(mask[None, None], scores, -1e9)
        p = _softmax(scores, axis=-1)
        o = torch.einsum("bhqk,bhkd->bhqd", p, v)
        return (lambda x, *d: x.permute(*d))(o, 0, 2, 1, 3).reshape(B, S, D) @ wo

    def _B_ref(x, w_gate, w_up, w_down):
        g = _silu(x @ w_gate)
        u = x @ w_up
        return (g * u) @ w_down

    x = A_x
    xn = _layernorm(x, axis=-1)
    return x + _A_ref(xn, A_wqkv, A_wo) + _B_ref(xn, B_w_gate, B_w_up, B_w_down)
```

```asm
; @launch kernel=gemm1_kernel grid=(256,1,1) block=(512,1,1) lds=152576
; @launch kernel=attn_kernel grid=(512,1,1) block=(256,1,1) lds=57344
; @launch kernel=gemm2_kernel grid=(256,1,1) block=(256,1,1) lds=86016
.amdgcn_target "amdgcn-amd-amdhsa--gfx950"
.text
.globl gemm1_kernel
.p2align 8
.type gemm1_kernel,@function
gemm1_kernel:

    s_cmp_ge_u32 s2, 256
    s_cbranch_scc1 L_k1_done

    s_load_dwordx4 s[4:7], s[0:1], 0
    s_load_dwordx4 s[24:27], s[0:1], 32
    s_load_dwordx4 s[44:47], s[0:1], 64
    s_and_b32 s13, s2, 7
    s_lshl_b32 s13, s13, 2
    s_lshr_b32 s3, s2, 3
    s_and_b32 s3, s3, 3
    s_add_u32 s13, s13, s3
    s_lshr_b32 s12, s2, 5
    v_lshrrev_b32 v1, 6, v0
    v_and_b32 v2, 63, v0
    s_nop 0
    v_readfirstlane_b32 s14, v1
    s_mul_i32 s21, s14, 2560
    s_lshl_b32 s34, s14, 13
    s_add_u32 s34, s34, 81920
    s_lshl_b32 s22, s12, 8
    s_lshl_b32 s23, s14, 5
    s_add_u32 s22, s22, s23
    v_and_b32 v3, 31, v2
    v_add_u32 v3, s22, v3
    v_lshrrev_b32 v4, 5, v2
    s_lshl_b32 s23, s12, 8
    s_lshl_b32 s35, s13, 3
    s_add_u32 s23, s23, s35
    s_add_u32 s23, s23, s14
    s_lshl_b32 s35, s23, 3
    v_mov_b32 v7, s35
    s_mul_i32 s35, s23, 1280
    v_lshlrev_b32 v5, 2, v2
    v_add_u32 v5, s35, v5
    s_waitcnt lgkmcnt(0)
    s_mov_b32 s16, s6
    s_mov_b32 s17, s7
    s_mov_b32 s6, s46
    s_mov_b32 s7, s47
    s_mov_b32 s38, s4
    s_mov_b32 s39, s5
    s_lshl_b32 s35, s12, 5
    s_add_u32 s36, s44, s35
    s_addc_u32 s37, s45, 0
    s_add_u32 s42, s6, 32505856
    s_addc_u32 s43, s7, 0
    s_mul_i32 s23, s14, 160
    v_add_u32 v36, s23, v2
    s_cmp_ge_u32 s13, 12
    s_cbranch_scc1 L_k1_ffn_addr
    s_mul_i32 s23, s13, 320
    s_add_u32 s16, s16, s23
    s_addc_u32 s17, s17, 0
    s_mov_b32 s20, 245760

    v_add_u32 v37, 0, v36
    v_min_u32 v37, 1279, v37
    v_mul_u32_u24 v38, 3277, v37
    v_lshrrev_b32 v38, 16, v38
    v_mul_u32_u24 v39, 20, v38
    v_sub_u32 v39, v37, v39
    v_mul_u32_u24 v38, 3840, v38
    v_lshl_add_u32 v38, v39, 4, v38
    v_mov_b32 v41, s17
    v_add_co_u32 v40, vcc, s16, v38
    v_addc_co_u32 v41, vcc, 0, v41, vcc

    v_add_u32 v37, 64, v36
    v_min_u32 v37, 1279, v37
    v_mul_u32_u24 v38, 3277, v37
    v_lshrrev_b32 v38, 16, v38
    v_mul_u32_u24 v39, 20, v38
    v_sub_u32 v39, v37, v39
    v_mul_u32_u24 v38, 3840, v38
    v_lshl_add_u32 v38, v39, 4, v38
    v_mov_b32 v43, s17
    v_add_co_u32 v42, vcc, s16, v38
    v_addc_co_u32 v43, vcc, 0, v43, vcc

    v_add_u32 v37, 128, v36
    v_min_u32 v37, 1279, v37
    v_mul_u32_u24 v38, 3277, v37
    v_lshrrev_b32 v38, 16, v38
    v_mul_u32_u24 v39, 20, v38
    v_sub_u32 v39, v37, v39
    v_mul_u32_u24 v38, 3840, v38
    v_lshl_add_u32 v38, v39, 4, v38
    v_mov_b32 v45, s17
    v_add_co_u32 v44, vcc, s16, v38
    v_addc_co_u32 v45, vcc, 0, v45, vcc

    s_branch L_k1_addr_done
L_k1_ffn_addr:
    s_sub_u32 s28, s13, 12
    s_mul_i32 s29, s28, 5
    s_lshl_b32 s30, s28, 2
    s_add_u32 s30, s30, 15
    s_cmp_ge_u32 s28, 16
    s_cselect_b32 s29, s30, s29
    s_cselect_b32 s31, 1, 0
    s_lshl_b32 s29, s29, 5
    s_add_u32 s24, s24, s29
    s_addc_u32 s25, s25, 0
    s_add_u32 s26, s26, s29
    s_addc_u32 s27, s27, 0
    s_sub_u32 s26, s26, 160
    s_subb_u32 s27, s27, 0
    s_mov_b32 s20, 196608
    v_mov_b32 v32, s24
    v_mov_b32 v33, s25
    v_mov_b32 v34, s26
    v_mov_b32 v35, s27

    v_add_u32 v37, 0, v36
    v_min_u32 v37, 1279, v37
    v_mul_u32_u24 v38, 3277, v37
    v_lshrrev_b32 v38, 16, v38
    v_mul_u32_u24 v39, 20, v38
    v_sub_u32 v39, v37, v39
    v_mul_u32_u24 v38, 3072, v38
    v_lshl_add_u32 v38, v39, 4, v38
    v_cmp_le_u32 vcc, 10, v39
    s_nop 1
    v_cndmask_b32 v37, v32, v34, vcc
    v_cndmask_b32 v41, v33, v35, vcc
    v_add_co_u32 v40, vcc, v37, v38
    v_addc_co_u32 v41, vcc, 0, v41, vcc

    v_add_u32 v37, 64, v36
    v_min_u32 v37, 1279, v37
    v_mul_u32_u24 v38, 3277, v37
    v_lshrrev_b32 v38, 16, v38
    v_mul_u32_u24 v39, 20, v38
    v_sub_u32 v39, v37, v39
    v_mul_u32_u24 v38, 3072, v38
    v_lshl_add_u32 v38, v39, 4, v38
    v_cmp_le_u32 vcc, 10, v39
    s_nop 1
    v_cndmask_b32 v37, v32, v34, vcc
    v_cndmask_b32 v43, v33, v35, vcc
    v_add_co_u32 v42, vcc, v37, v38
    v_addc_co_u32 v43, vcc, 0, v43, vcc

    v_add_u32 v37, 128, v36
    v_min_u32 v37, 1279, v37
    v_mul_u32_u24 v38, 3277, v37
    v_lshrrev_b32 v38, 16, v38
    v_mul_u32_u24 v39, 20, v38
    v_sub_u32 v39, v37, v39
    v_mul_u32_u24 v38, 3072, v38
    v_lshl_add_u32 v38, v39, 4, v38
    v_cmp_le_u32 vcc, 10, v39
    s_nop 1
    v_cndmask_b32 v37, v32, v34, vcc
    v_cndmask_b32 v45, v33, v35, vcc
    v_add_co_u32 v44, vcc, v37, v38
    v_addc_co_u32 v45, vcc, 0, v45, vcc

L_k1_addr_done:
    s_add_u32 m0, s21, 0
    s_nop 0
    global_load_lds_dwordx4 v[40:41], off
    v_add_co_u32 v40, vcc, s20, v40
    v_addc_co_u32 v41, vcc, 0, v41, vcc
    s_add_u32 m0, s21, 1024
    s_nop 0
    global_load_lds_dwordx4 v[42:43], off
    v_add_co_u32 v42, vcc, s20, v42
    v_addc_co_u32 v43, vcc, 0, v43, vcc
    s_add_u32 m0, s21, 2048
    s_mov_b32 exec_hi, 0
    global_load_lds_dwordx4 v[44:45], off
    s_mov_b32 exec_hi, -1
    v_add_co_u32 v44, vcc, s20, v44
    v_addc_co_u32 v45, vcc, 0, v45, vcc
    v_lshrrev_b32 v28, 3, v2
    v_add_u32 v28, s22, v28
    v_mul_u32_u24 v28, 1280, v28
    v_and_b32 v29, 7, v2
    v_lshrrev_b32 v30, 4, v2
    v_xor_b32 v29, v29, v30
    v_lshl_add_u32 v30, v29, 4, v28
    v_xor_b32 v29, 4, v29
    v_lshl_add_u32 v31, v29, 4, v28

    v_add_u32 v46, 0, v30
    v_add_u32 v47, 10240, v31
    v_add_u32 v48, 20480, v30
    v_add_u32 v49, 30720, v31
    s_add_u32 m0, s34, 0
    s_nop 0
    global_load_lds_dwordx4 v46, s[4:5]
    s_add_u32 m0, s34, 1024
    s_nop 0
    global_load_lds_dwordx4 v47, s[4:5]
    s_add_u32 m0, s34, 2048
    s_nop 0
    global_load_lds_dwordx4 v48, s[4:5]
    s_add_u32 m0, s34, 3072
    s_nop 0
    global_load_lds_dwordx4 v49, s[4:5]
    s_add_u32 s4, s4, 128
    s_addc_u32 s5, s5, 0
    global_load_dword a32, v5, s[38:39] offset:0
    global_load_dword a33, v5, s[38:39] offset:256
    global_load_dword a34, v5, s[38:39] offset:512
    global_load_dword a35, v5, s[38:39] offset:768
    global_load_dword a36, v5, s[38:39] offset:1024
    v_min_u32 v26, 399, v0
    v_mul_u32_u24 v27, 820, v26
    v_lshrrev_b32 v27, 16, v27
    v_mul_u32_u24 v28, 80, v27
    v_sub_u32 v26, v26, v28
    s_mul_i32 s23, s12, 80
    v_lshl_add_u32 v27, v27, 4, s23
    s_cmp_ge_u32 s13, 12
    s_movk_i32 s49, 3840
    s_cselect_b32 s49, 3072, s49
    s_cselect_b32 s56, s24, s16
    s_cselect_b32 s57, s25, s17
    s_cselect_b32 s58, s26, s16
    s_cselect_b32 s59, s27, s17
    v_mul_lo_u32 v27, v27, s49
    v_lshl_add_u32 v27, v26, 2, v27
    v_cmp_le_u32 vcc, 40, v26
    v_mov_b32 v10, s56
    v_mov_b32 v11, s57
    v_mov_b32 v12, s58
    v_mov_b32 v13, s59
    v_cndmask_b32 v10, v10, v12, vcc
    v_cndmask_b32 v11, v11, v13, vcc
    v_add_co_u32 v94, vcc, v10, v27
    v_addc_co_u32 v95, vcc, 0, v11, vcc

    global_load_dword v10, v[94:95], off
    v_add_co_u32 v94, vcc, s49, v94
    v_addc_co_u32 v95, vcc, 0, v95, vcc
    global_load_dword v11, v[94:95], off
    v_add_co_u32 v94, vcc, s49, v94
    v_addc_co_u32 v95, vcc, 0, v95, vcc
    global_load_dword v12, v[94:95], off
    v_add_co_u32 v94, vcc, s49, v94
    v_addc_co_u32 v95, vcc, 0, v95, vcc
    global_load_dword v13, v[94:95], off
    v_add_co_u32 v94, vcc, s49, v94
    v_addc_co_u32 v95, vcc, 0, v95, vcc
    global_load_dword v14, v[94:95], off
    v_add_co_u32 v94, vcc, s49, v94
    v_addc_co_u32 v95, vcc, 0, v95, vcc
    global_load_dword v15, v[94:95], off
    v_add_co_u32 v94, vcc, s49, v94
    v_addc_co_u32 v95, vcc, 0, v95, vcc
    global_load_dword v16, v[94:95], off
    v_add_co_u32 v94, vcc, s49, v94
    v_addc_co_u32 v95, vcc, 0, v95, vcc
    global_load_dword v17, v[94:95], off
    v_add_co_u32 v94, vcc, s49, v94
    v_addc_co_u32 v95, vcc, 0, v95, vcc
    global_load_dword v18, v[94:95], off
    v_add_co_u32 v94, vcc, s49, v94
    v_addc_co_u32 v95, vcc, 0, v95, vcc
    global_load_dword v19, v[94:95], off
    v_add_co_u32 v94, vcc, s49, v94
    v_addc_co_u32 v95, vcc, 0, v95, vcc
    global_load_dword v20, v[94:95], off
    v_add_co_u32 v94, vcc, s49, v94
    v_addc_co_u32 v95, vcc, 0, v95, vcc
    global_load_dword v21, v[94:95], off
    v_add_co_u32 v94, vcc, s49, v94
    v_addc_co_u32 v95, vcc, 0, v95, vcc
    global_load_dword v22, v[94:95], off
    v_add_co_u32 v94, vcc, s49, v94
    v_addc_co_u32 v95, vcc, 0, v95, vcc
    global_load_dword v23, v[94:95], off
    v_add_co_u32 v94, vcc, s49, v94
    v_addc_co_u32 v95, vcc, 0, v95, vcc
    global_load_dword v24, v[94:95], off
    v_add_co_u32 v94, vcc, s49, v94
    v_addc_co_u32 v95, vcc, 0, v95, vcc
    global_load_dword v25, v[94:95], off
    v_add_co_u32 v94, vcc, s49, v94
    v_addc_co_u32 v95, vcc, 0, v95, vcc
    v_min_u32 v35, 500, v0
    v_lshlrev_b32 v35, 3, v35
    v_add_u32 v35, 148480, v35
    s_lshl_b32 s23, s13, 3
    s_mul_i32 s35, s23, 640
    s_add_u32 s35, s35, 33030144
    s_add_u32 s54, s6, s35
    s_addc_u32 s55, s7, 0
    s_mul_i32 s35, s12, 640
    s_add_u32 s52, s54, s35
    s_addc_u32 s53, s55, 0
    s_add_u32 s54, s54, 2560
    s_addc_u32 s55, s55, 0
    v_min_u32 v26, 159, v0
    v_lshrrev_b32 v27, 5, v26
    v_and_b32 v26, 31, v26
    v_and_b32 v8, 15, v26
    v_lshl_add_u32 v8, v27, 4, v8
    v_lshrrev_b32 v62, 4, v26
    v_mul_u32_u24 v62, 80, v62
    v_add_u32 v8, v8, v62
    v_lshrrev_b32 v62, 4, v26
    v_lshl_add_u32 v62, v27, 1, v62
    v_mul_u32_u24 v62, 5, v62
    v_bfe_u32 v63, v26, 2, 2
    v_add_u32 v62, v62, v63
    v_lshrrev_b32 v63, 2, v26
    v_mul_u32_u24 v63, 5, v63
    v_add_u32 v63, 4, v63
    v_cmp_eq_u32 vcc, 4, v27
    s_nop 1
    v_cndmask_b32 v62, v62, v63, vcc
    v_and_b32 v63, 3, v26
    v_lshl_add_u32 v62, v62, 2, v63
    s_cmp_lt_u32 s13, 8
    s_cselect_b32 s23, -1, 0
    v_mov_b32 v63, s23
    v_cmp_ne_u32 vcc, 0, v63
    s_nop 1
    v_cndmask_b32 v8, v8, v62, vcc
    v_lshlrev_b32 v8, 2, v8

    s_mov_b32 s8, s6
    s_and_b32 s9, s7, 0xffff
    s_mov_b32 s10, 268435456
    s_mov_b32 s11, 0x00020000

    v_and_b32 v28, 31, v2
    v_lshrrev_b32 v29, 1, v28
    v_and_b32 v29, 7, v29
    v_lshlrev_b32 v28, 7, v28
    v_add_u32 v28, s34, v28
    v_xor_b32 v30, v4, v29
    s_lshl_b32 s23, s14, 1
    s_and_b32 s35, s23, 6
    v_xor_b32 v31, s35, v30
    v_lshl_add_u32 v50, v31, 4, v28
    s_add_u32 s23, s23, 2
    s_and_b32 s35, s23, 6
    v_xor_b32 v31, s35, v30
    v_lshl_add_u32 v51, v31, 4, v28
    s_add_u32 s23, s23, 2
    s_and_b32 s35, s23, 6
    v_xor_b32 v31, s35, v30
    v_lshl_add_u32 v52, v31, 4, v28
    s_add_u32 s23, s23, 2
    s_and_b32 s35, s23, 6
    v_xor_b32 v31, s35, v30
    v_lshl_add_u32 v53, v31, 4, v28
    v_mul_u32_u24 v63, 2560, v4
    v_and_b32 v28, 15, v2
    v_lshrrev_b32 v28, 2, v28
    v_mul_u32_u24 v28, 320, v28
    v_add_u32 v63, v63, v28
    v_lshrrev_b32 v28, 4, v2
    v_and_b32 v28, 1, v28
    s_cmp_lt_u32 s13, 8
    s_cselect_b32 s23, 40, 160
    v_mul_u32_u24 v29, s23, v28
    v_add_u32 v63, v63, v29
    v_mul_u32_u24 v29, 120, v28
    v_and_b32 v28, 3, v2
    v_lshl_add_u32 v63, v28, 3, v63
    v_lshl_add_u32 v29, v28, 5, v29
    v_add_u32 v9, 32, v29
    s_mov_b32 s48, 0

    s_add_u32 s23, s14, 0
    s_and_b32 s23, s23, 3
    s_mul_i32 s23, s23, 5120
    v_add_u32 v54, s23, v63
    v_add_u32 v58, 40960, v54

    s_add_u32 s23, s14, 1
    s_and_b32 s23, s23, 3
    s_mul_i32 s23, s23, 5120
    v_add_u32 v55, s23, v63
    v_add_u32 v59, 40960, v55

    s_add_u32 s23, s14, 2
    s_and_b32 s23, s23, 3
    s_mul_i32 s23, s23, 5120
    v_add_u32 v56, s23, v63
    v_add_u32 v60, 40960, v56

    s_add_u32 s23, s14, 3
    s_and_b32 s23, s23, 3
    s_mul_i32 s23, s23, 5120
    v_add_u32 v57, s23, v63
    v_add_u32 v61, 40960, v57

    s_cmp_ge_u32 s13, 12
    s_cbranch_scc1 L_k1_main_n
    s_cmp_ge_u32 s13, 8
    s_cbranch_scc1 L_k1_main_v

    s_waitcnt vmcnt(25)
    s_barrier
    s_waitcnt vmcnt(21)
    ds_read_b128 a[0:3], v50 offset:0
    ds_read_b128 a[4:7], v51 offset:0
    ds_read_b128 a[8:11], v52 offset:0
    ds_read_b128 a[12:15], v53 offset:0
    ds_read_b64_tr_b16 v[64:65], v54 offset:0
    ds_read_b64_tr_b16 v[66:67], v54 offset:1280
    ds_read_b64_tr_b16 v[68:69], v54 offset:80
    ds_read_b64_tr_b16 v[70:71], v54 offset:1360
    ds_read_b64_tr_b16 v[72:73], v54 offset:160
    ds_read_b64_tr_b16 v[74:75], v54 offset:1440
    ds_read_b64_tr_b16 v[76:77], v54 offset:240
    ds_read_b64_tr_b16 v[78:79], v54 offset:1520
    s_waitcnt lgkmcnt(8)
    v_add_u32 v62, v9, v54
    ds_read_b64_tr_b16 v[80:81], v62 offset:0
    ds_read_b64_tr_b16 v[82:83], v62 offset:1280
    s_waitcnt lgkmcnt(8)
    v_mfma_f32_32x32x16_bf16 v[96:111], v[64:67], a[0:3], 0
    s_add_u32 m0, s21, 20480
    s_nop 0
    global_load_lds_dwordx4 v[40:41], off
    v_add_co_u32 v40, vcc, s20, v40
    v_addc_co_u32 v41, vcc, 0, v41, vcc
    ds_read_b64_tr_b16 v[84:85], v55 offset:0
    ds_read_b64_tr_b16 v[86:87], v55 offset:1280
    s_waitcnt lgkmcnt(8)
    v_mfma_f32_32x32x16_bf16 v[112:127], v[68:71], a[0:3], 0
    s_add_u32 m0, s21, 21504
    s_nop 0
    global_load_lds_dwordx4 v[42:43], off
    v_add_co_u32 v42, vcc, s20, v42
    v_addc_co_u32 v43, vcc, 0, v43, vcc
    ds_read_b64_tr_b16 v[64:65], v55 offset:80
    ds_read_b64_tr_b16 v[66:67], v55 offset:1360
    s_waitcnt lgkmcnt(8)
    v_mfma_f32_32x32x16_bf16 v[128:143], v[72:75], a[0:3], 0
    s_add_u32 m0, s21, 22528
    s_mov_b32 exec_hi, 0
    global_load_lds_dwordx4 v[44:45], off
    s_mov_b32 exec_hi, -1
    v_add_co_u32 v44, vcc, s20, v44
    v_addc_co_u32 v45, vcc, 0, v45, vcc
    ds_read_b64_tr_b16 v[68:69], v55 offset:160
    ds_read_b64_tr_b16 v[70:71], v55 offset:1440
    s_waitcnt lgkmcnt(8)
    v_mfma_f32_32x32x16_bf16 v[144:159], v[76:79], a[0:3], 0
    s_add_u32 m0, s34, 4096
    s_nop 0
    global_load_lds_dwordx4 v46, s[4:5]
    ds_read_b64_tr_b16 v[72:73], v55 offset:240
    ds_read_b64_tr_b16 v[74:75], v55 offset:1520
    s_waitcnt lgkmcnt(8)
    v_mfma_f32_32x32x16_bf16 v[160:175], v[80:83], a[0:3], 0
    s_add_u32 m0, s34, 5120
    s_nop 0
    global_load_lds_dwordx4 v47, s[4:5]
    v_add_u32 v62, v9, v55
    ds_read_b64_tr_b16 v[76:77], v62 offset:0
    ds_read_b64_tr_b16 v[78:79], v62 offset:1280
    s_waitcnt lgkmcnt(8)
    v_mfma_f32_32x32x16_bf16 v[96:111], v[84:87], a[4:7], v[96:111]
    s_add_u32 m0, s34, 6144
    s_nop 0
    global_load_lds_dwordx4 v48, s[4:5]
    ds_read_b64_tr_b16 v[80:81], v56 offset:0
    ds_read_b64_tr_b16 v[82:83], v56 offset:1280
    s_waitcnt lgkmcnt(8)
    v_mfma_f32_32x32x16_bf16 v[112:127], v[64:67], a[4:7], v[112:127]
    s_add_u32 m0, s34, 7168
    s_nop 0
    global_load_lds_dwordx4 v49, s[4:5]
    s_add_u32 s4, s4, 128
    s_addc_u32 s5, s5, 0
    ds_read_b64_tr_b16 v[84:85], v56 offset:80
    ds_read_b64_tr_b16 v[86:87], v56 offset:1360
    s_waitcnt lgkmcnt(8)
    v_mfma_f32_32x32x16_bf16 v[128:143], v[68:71], a[4:7], v[128:143]
    s_add_u32 m0, s21, 40960
    s_nop 0
    global_load_lds_dwordx4 v[40:41], off
    v_add_co_u32 v40, vcc, s20, v40
    v_addc_co_u32 v41, vcc, 0, v41, vcc
    ds_read_b64_tr_b16 v[64:65], v56 offset:160
    ds_read_b64_tr_b16 v[66:67], v56 offset:1440
    s_waitcnt lgkmcnt(8)
    v_mfma_f32_32x32x16_bf16 v[144:159], v[72:75], a[4:7], v[144:159]
    s_add_u32 m0, s21, 41984
    s_nop 0
    global_load_lds_dwordx4 v[42:43], off
    v_add_co_u32 v42, vcc, s20, v42
    v_addc_co_u32 v43, vcc, 0, v43, vcc
    ds_read_b64_tr_b16 v[68:69], v56 offset:240
    ds_read_b64_tr_b16 v[70:71], v56 offset:1520
    s_waitcnt lgkmcnt(8)
    v_mfma_f32_32x32x16_bf16 v[160:175], v[76:79], a[4:7], v[160:175]
    s_add_u32 m0, s21, 43008
    s_mov_b32 exec_hi, 0
    global_load_lds_dwordx4 v[44:45], off
    s_mov_b32 exec_hi, -1
    v_add_co_u32 v44, vcc, s20, v44
    v_addc_co_u32 v45, vcc, 0, v45, vcc
    v_add_u32 v62, v9, v56
    ds_read_b64_tr_b16 v[72:73], v62 offset:0
    ds_read_b64_tr_b16 v[74:75], v62 offset:1280
    s_waitcnt lgkmcnt(8)
    v_mfma_f32_32x32x16_bf16 v[96:111], v[80:83], a[8:11], v[96:111]
    s_add_u32 m0, s34, 0
    s_nop 0
    global_load_lds_dwordx4 v46, s[4:5]
    ds_read_b64_tr_b16 v[76:77], v57 offset:0
    ds_read_b64_tr_b16 v[78:79], v57 offset:1280
    s_waitcnt lgkmcnt(8)
    v_mfma_f32_32x32x16_bf16 v[112:127], v[84:87], a[8:11], v[112:127]
    s_add_u32 m0, s34, 1024
    s_nop 0
    global_load_lds_dwordx4 v47, s[4:5]
    ds_read_b64_tr_b16 v[80:81], v57 offset:80
    ds_read_b64_tr_b16 v[82:83], v57 offset:1360
    s_waitcnt lgkmcnt(8)
    v_mfma_f32_32x32x16_bf16 v[128:143], v[64:67], a[8:11], v[128:143]
    s_add_u32 m0, s34, 2048
    s_nop 0
    global_load_lds_dwordx4 v48, s[4:5]
    ds_read_b64_tr_b16 v[84:85], v57 offset:160
    ds_read_b64_tr_b16 v[86:87], v57 offset:1440
    s_waitcnt lgkmcnt(8)
    v_mfma_f32_32x32x16_bf16 v[144:159], v[68:71], a[8:11], v[144:159]
    s_add_u32 m0, s34, 3072
    s_nop 0
    global_load_lds_dwordx4 v49, s[4:5]
    s_add_u32 s4, s4, 128
    s_addc_u32 s5, s5, 0
    ds_read_b64_tr_b16 v[64:65], v57 offset:240
    ds_read_b64_tr_b16 v[66:67], v57 offset:1520
    s_waitcnt vmcnt(7)
    s_barrier
    s_waitcnt lgkmcnt(8)
    v_mfma_f32_32x32x16_bf16 v[160:175], v[72:75], a[8:11], v[160:175]
    v_add_u32 v62, v9, v57
    ds_read_b64_tr_b16 v[68:69], v62 offset:0
    ds_read_b64_tr_b16 v[70:71], v62 offset:1280
    s_waitcnt lgkmcnt(8)
    v_mfma_f32_32x32x16_bf16 v[96:111], v[76:79], a[12:15], v[96:111]
    ds_read_b128 a[16:19], v50 offset:4096
    s_add_u32 m0, s21, 61440
    s_nop 0
    global_load_lds_dwordx4 v[40:41], off
    v_add_co_u32 v40, vcc, s20, v40
    v_addc_co_u32 v41, vcc, 0, v41, vcc
    ds_read_b64_tr_b16 v[72:73], v54 offset:20480
    ds_read_b64_tr_b16 v[74:75], v54 offset:21760
    s_waitcnt lgkmcnt(9)
    v_mfma_f32_32x32x16_bf16 v[112:127], v[80:83], a[12:15], v[112:127]
    ds_read_b128 a[20:23], v51 offset:4096
    ds_read_b64_tr_b16 v[76:77], v54 offset:20560
    ds_read_b64_tr_b16 v[78:79], v54 offset:21840
    s_waitcnt lgkmcnt(10)
    v_mfma_f32_32x32x16_bf16 v[128:143], v[84:87], a[12:15], v[128:143]
    ds_read_b128 a[24:27], v52 offset:4096
    s_add_u32 m0, s21, 62464
    s_nop 0
    global_load_lds_dwordx4 v[42:43], off
    v_add_co_u32 v42, vcc, s20, v42
    v_addc_co_u32 v43, vcc, 0, v43, vcc
    ds_read_b64_tr_b16 v[80:81], v54 offset:20640
    ds_read_b64_tr_b16 v[82:83], v54 offset:21920
    s_waitcnt lgkmcnt(11)
    v_mfma_f32_32x32x16_bf16 v[144:159], v[64:67], a[12:15], v[144:159]
    ds_read_b128 a[28:31], v53 offset:4096
    ds_read_b64_tr_b16 v[84:85], v54 offset:20720
    ds_read_b64_tr_b16 v[86:87], v54 offset:22000
    s_waitcnt lgkmcnt(12)
    v_mfma_f32_32x32x16_bf16 v[160:175], v[68:71], a[12:15], v[160:175]
    s_add_u32 m0, s21, 63488
    s_mov_b32 exec_hi, 0
    global_load_lds_dwordx4 v[44:45], off
    s_mov_b32 exec_hi, -1
    v_add_co_u32 v44, vcc, s20, v44
    v_addc_co_u32 v45, vcc, 0, v45, vcc
    v_add_u32 v62, v9, v54
    ds_read_b64_tr_b16 v[64:65], v62 offset:20480
    ds_read_b64_tr_b16 v[66:67], v62 offset:21760
    s_waitcnt lgkmcnt(4)
    v_mfma_f32_32x32x16_bf16 v[96:111], v[72:75], a[16:19], v[96:111]
    s_add_u32 m0, s34, 4096
    s_nop 0
    global_load_lds_dwordx4 v46, s[4:5]
    ds_read_b64_tr_b16 v[68:69], v55 offset:20480
    ds_read_b64_tr_b16 v[70:71], v55 offset:21760
    v_mfma_f32_32x32x16_bf16 v[112:127], v[76:79], a[16:19], v[112:127]
    s_add_u32 m0, s34, 5120
    s_nop 0
    global_load_lds_dwordx4 v47, s[4:5]
    ds_read_b64_tr_b16 v[72:73], v55 offset:20560
    ds_read_b64_tr_b16 v[74:75], v55 offset:21840
    v_mfma_f32_32x32x16_bf16 v[128:143], v[80:83], a[16:19], v[128:143]
    s_add_u32 m0, s34, 6144
    s_nop 0
    global_load_lds_dwordx4 v48, s[4:5]
    ds_read_b64_tr_b16 v[76:77], v55 offset:20640
    ds_read_b64_tr_b16 v[78:79], v55 offset:21920
    s_waitcnt lgkmcnt(8)
    v_mfma_f32_32x32x16_bf16 v[144:159], v[84:87], a[16:19], v[144:159]
    s_add_u32 m0, s34, 7168
    s_nop 0
    global_load_lds_dwordx4 v49, s[4:5]
    s_add_u32 s4, s4, 128
    s_addc_u32 s5, s5, 0
    ds_read_b64_tr_b16 v[80:81], v55 offset:20720
    ds_read_b64_tr_b16 v[82:83], v55 offset:22000
    s_waitcnt vmcnt(7)
    s_barrier
    s_waitcnt lgkmcnt(8)
    v_mfma_f32_32x32x16_bf16 v[160:175], v[64:67], a[16:19], v[160:175]
    v_add_u32 v62, v9, v55
    ds_read_b64_tr_b16 v[84:85], v62 offset:20480
    ds_read_b64_tr_b16 v[86:87], v62 offset:21760
    s_waitcnt lgkmcnt(8)
    v_mfma_f32_32x32x16_bf16 v[96:111], v[68:71], a[20:23], v[96:111]
    ds_read_b128 a[0:3], v50 offset:0
    v_mov_b32 v30, 0
    v_mov_b32 v31, 0
    v_accvgpr_read_b32 v5, a32
    v_lshlrev_b32 v6, 16, v5
    v_and_b32 v5, 0xffff0000, v5
    ds_read_b64_tr_b16 v[64:65], v56 offset:20480
    ds_read_b64_tr_b16 v[66:67], v56 offset:21760
    s_waitcnt lgkmcnt(9)
    v_mfma_f32_32x32x16_bf16 v[112:127], v[72:75], a[20:23], v[112:127]
    ds_read_b128 a[4:7], v51 offset:0
    s_add_u32 m0, s21, 0
    s_nop 0
    global_load_lds_dwordx4 v[40:41], off
    v_add_co_u32 v40, vcc, s20, v40
    v_addc_co_u32 v41, vcc, 0, v41, vcc
    v_add_f32 v30, v30, v6
    v_add_f32 v31, v31, v5
    v_accvgpr_read_b32 v5, a33
    v_lshlrev_b32 v6, 16, v5
    v_and_b32 v5, 0xffff0000, v5
    ds_read_b64_tr_b16 v[68:69], v56 offset:20560
    ds_read_b64_tr_b16 v[70:71], v56 offset:21840
    s_waitcnt lgkmcnt(10)
    v_mfma_f32_32x32x16_bf16 v[128:143], v[76:79], a[20:23], v[128:143]
    ds_read_b128 a[8:11], v52 offset:0
    v_add_f32 v30, v30, v6
    v_add_f32 v31, v31, v5
    v_accvgpr_read_b32 v5, a34
    v_lshlrev_b32 v6, 16, v5
    v_and_b32 v5, 0xffff0000, v5
    ds_read_b64_tr_b16 v[72:73], v56 offset:20640
    ds_read_b64_tr_b16 v[74:75], v56 offset:21920
    s_waitcnt lgkmcnt(11)
    v_mfma_f32_32x32x16_bf16 v[144:159], v[80:83], a[20:23], v[144:159]
    ds_read_b128 a[12:15], v53 offset:0
    v_add_f32 v30, v30, v6
    v_add_f32 v31, v31, v5
    v_accvgpr_read_b32 v5, a35
    v_lshlrev_b32 v6, 16, v5
    v_and_b32 v5, 0xffff0000, v5
    ds_read_b64_tr_b16 v[76:77], v56 offset:20720
    ds_read_b64_tr_b16 v[78:79], v56 offset:22000
    s_waitcnt lgkmcnt(12)
    v_mfma_f32_32x32x16_bf16 v[160:175], v[84:87], a[20:23], v[160:175]
    s_add_u32 m0, s21, 1024
    s_nop 0
    global_load_lds_dwordx4 v[42:43], off
    v_add_co_u32 v42, vcc, s20, v42
    v_addc_co_u32 v43, vcc, 0, v43, vcc
    v_add_f32 v30, v30, v6
    v_add_f32 v31, v31, v5
    v_accvgpr_read_b32 v5, a36
    v_lshlrev_b32 v6, 16, v5
    v_and_b32 v5, 0xffff0000, v5
    v_add_u32 v62, v9, v56
    ds_read_b64_tr_b16 v[80:81], v62 offset:20480
    ds_read_b64_tr_b16 v[82:83], v62 offset:21760
    s_waitcnt lgkmcnt(11)
    v_mfma_f32_32x32x16_bf16 v[96:111], v[64:67], a[24:27], v[96:111]
    v_add_f32 v30, v30, v6
    v_add_f32 v31, v31, v5
    v_add_f32 v30, v30, v31
    s_nop 1
    v_add_f32_dpp v30, v30, v30 row_ror:8 row_mask:0xf bank_mask:0xf
    ds_read_b64_tr_b16 v[84:85], v57 offset:20480
    ds_read_b64_tr_b16 v[86:87], v57 offset:21760
    s_waitcnt lgkmcnt(10)
    v_mfma_f32_32x32x16_bf16 v[112:127], v[68:71], a[24:27], v[112:127]
    s_nop 1
    v_add_f32_dpp v30, v30, v30 row_ror:4 row_mask:0xf bank_mask:0xf
    s_nop 1
    v_add_f32_dpp v30, v30, v30 row_ror:2 row_mask:0xf bank_mask:0xf
    s_nop 1
    ds_read_b64_tr_b16 v[64:65], v57 offset:20560
    ds_read_b64_tr_b16 v[66:67], v57 offset:21840
    s_waitcnt lgkmcnt(8)
    v_mfma_f32_32x32x16_bf16 v[128:143], v[72:75], a[24:27], v[128:143]
    s_add_u32 m0, s21, 2048
    s_mov_b32 exec_hi, 0
    global_load_lds_dwordx4 v[44:45], off
    s_mov_b32 exec_hi, -1
    v_add_co_u32 v44, vcc, s20, v44
    v_addc_co_u32 v45, vcc, 0, v45, vcc
    v_add_f32_dpp v30, v30, v30 row_ror:1 row_mask:0xf bank_mask:0xf
    v_mov_b32 v5, v30
    s_nop 1
    v_permlane32_swap_b32 v5, v30
    s_nop 1
    ds_read_b64_tr_b16 v[68:69], v57 offset:20640
    ds_read_b64_tr_b16 v[70:71], v57 offset:21920
    s_waitcnt lgkmcnt(8)
    v_mfma_f32_32x32x16_bf16 v[144:159], v[76:79], a[24:27], v[144:159]
    s_add_u32 m0, s34, 0
    s_nop 0
    global_load_lds_dwordx4 v46, s[4:5]
    v_add_f32 v30, v30, v5
    v_mov_b32 v5, v30
    s_nop 1
    v_permlane16_swap_b32 v5, v30
    s_nop 1
    ds_read_b64_tr_b16 v[72:73], v57 offset:20720
    ds_read_b64_tr_b16 v[74:75], v57 offset:22000
    s_waitcnt lgkmcnt(8)
    v_mfma_f32_32x32x16_bf16 v[160:175], v[80:83], a[24:27], v[160:175]
    v_add_f32 v30, v30, v5
    v_mul_f32 v30, 0x3acccccd, v30
    v_mov_b32 v31, 0
    v_mov_b32 v33, 0
    v_accvgpr_read_b32 v5, a32
    v_add_u32 v62, v9, v57
    ds_read_b64_tr_b16 v[76:77], v62 offset:20480
    ds_read_b64_tr_b16 v[78:79], v62 offset:21760
    s_waitcnt lgkmcnt(8)
    v_mfma_f32_32x32x16_bf16 v[96:111], v[84:87], a[28:31], v[96:111]
    s_add_u32 m0, s34, 1024
    s_nop 0
    global_load_lds_dwordx4 v47, s[4:5]
    v_lshlrev_b32 v6, 16, v5
    v_and_b32 v5, 0xffff0000, v5
    v_sub_f32 v6, v6, v30
    v_sub_f32 v5, v5, v30
    v_fmac_f32 v31, v6, v6
    ds_read_b64_tr_b16 v[80:81], v58 offset:0
    ds_read_b64_tr_b16 v[82:83], v58 offset:1280
    s_waitcnt lgkmcnt(8)
    v_mfma_f32_32x32x16_bf16 v[112:127], v[64:67], a[28:31], v[112:127]
    v_fmac_f32 v33, v5, v5
    v_accvgpr_read_b32 v5, a33
    v_lshlrev_b32 v6, 16, v5
    v_and_b32 v5, 0xffff0000, v5
    v_sub_f32 v6, v6, v30
    ds_read_b64_tr_b16 v[84:85], v58 offset:80
    ds_read_b64_tr_b16 v[86:87], v58 offset:1360
    s_waitcnt lgkmcnt(8)
    v_mfma_f32_32x32x16_bf16 v[128:143], v[68:71], a[28:31], v[128:143]
    s_add_u32 m0, s34, 2048
    s_nop 0
    global_load_lds_dwordx4 v48, s[4:5]
    v_sub_f32 v5, v5, v30
    v_fmac_f32 v31, v6, v6
    v_fmac_f32 v33, v5, v5
    v_accvgpr_read_b32 v5, a34
    v_lshlrev_b32 v6, 16, v5
    ds_read_b64_tr_b16 v[64:65], v58 offset:160
    ds_read_b64_tr_b16 v[66:67], v58 offset:1440
    s_waitcnt lgkmcnt(8)
    v_mfma_f32_32x32x16_bf16 v[144:159], v[72:75], a[28:31], v[144:159]
    v_and_b32 v5, 0xffff0000, v5
    v_sub_f32 v6, v6, v30
    v_sub_f32 v5, v5, v30
    v_fmac_f32 v31, v6, v6
    v_fmac_f32 v33, v5, v5
    ds_read_b64_tr_b16 v[68:69], v58 offset:240
    ds_read_b64_tr_b16 v[70:71], v58 offset:1520
    s_waitcnt lgkmcnt(8)
    v_mfma_f32_32x32x16_bf16 v[160:175], v[76:79], a[28:31], v[160:175]
    s_add_u32 m0, s34, 3072
    s_nop 0
    global_load_lds_dwordx4 v49, s[4:5]
    s_add_u32 s4, s4, 128
    s_addc_u32 s5, s5, 0
    v_accvgpr_read_b32 v5, a35
    v_lshlrev_b32 v6, 16, v5
    v_and_b32 v5, 0xffff0000, v5
    v_sub_f32 v6, v6, v30
    v_sub_f32 v5, v5, v30
    v_add_u32 v62, v9, v58
    ds_read_b64_tr_b16 v[72:73], v62 offset:0
    ds_read_b64_tr_b16 v[74:75], v62 offset:1280
    s_waitcnt lgkmcnt(8)
    v_mfma_f32_32x32x16_bf16 v[96:111], v[80:83], a[0:3], v[96:111]
    v_fmac_f32 v31, v6, v6
    v_fmac_f32 v33, v5, v5
    v_accvgpr_read_b32 v5, a36
    v_lshlrev_b32 v6, 16, v5
    v_and_b32 v5, 0xffff0000, v5
    ds_read_b64_tr_b16 v[76:77], v59 offset:0
    ds_read_b64_tr_b16 v[78:79], v59 offset:1280
    s_waitcnt lgkmcnt(8)
    v_mfma_f32_32x32x16_bf16 v[112:127], v[84:87], a[0:3], v[112:127]
    v_sub_f32 v6, v6, v30
    v_sub_f32 v5, v5, v30
    v_fmac_f32 v31, v6, v6
    v_fmac_f32 v33, v5, v5
    v_add_f32 v31, v31, v33
    ds_read_b64_tr_b16 v[80:81], v59 offset:80
    ds_read_b64_tr_b16 v[82:83], v59 offset:1360
    s_waitcnt lgkmcnt(8)
    v_mfma_f32_32x32x16_bf16 v[128:143], v[64:67], a[0:3], v[128:143]
    s_nop 1
    v_add_f32_dpp v31, v31, v31 row_ror:8 row_mask:0xf bank_mask:0xf
    s_nop 1
    v_add_f32_dpp v31, v31, v31 row_ror:4 row_mask:0xf bank_mask:0xf
    s_nop 1
    ds_read_b64_tr_b16 v[84:85], v59 offset:160
    ds_read_b64_tr_b16 v[86:87], v59 offset:1440
    s_waitcnt lgkmcnt(8)
    v_mfma_f32_32x32x16_bf16 v[144:159], v[68:71], a[0:3], v[144:159]
    v_add_f32_dpp v31, v31, v31 row_ror:2 row_mask:0xf bank_mask:0xf
    s_nop 1
    v_add_f32_dpp v31, v31, v31 row_ror:1 row_mask:0xf bank_mask:0xf
    v_mov_b32 v5, v31
    s_nop 1
    ds_read_b64_tr_b16 v[64:65], v59 offset:240
    ds_read_b64_tr_b16 v[66:67], v59 offset:1520
    s_waitcnt vmcnt(7)
    s_barrier
    s_waitcnt lgkmcnt(8)
    v_mfma_f32_32x32x16_bf16 v[160:175], v[72:75], a[0:3], v[160:175]
    v_permlane32_swap_b32 v5, v31
    s_nop 1
    v_add_f32 v31, v31, v5
    v_mov_b32 v5, v31
    s_nop 1
    v_add_u32 v62, v9, v59
    ds_read_b64_tr_b16 v[68:69], v62 offset:0
    ds_read_b64_tr_b16 v[70:71], v62 offset:1280
    s_waitcnt lgkmcnt(8)
    v_mfma_f32_32x32x16_bf16 v[96:111], v[76:79], a[4:7], v[96:111]
    ds_read_b128 a[16:19], v50 offset:4096
    v_permlane16_swap_b32 v5, v31
    s_nop 1
    v_add_f32 v31, v31, v5
    v_mul_f32 v31, 0x3acccccd, v31
    v_cvt_pk_bf16_f32 v5, v30, v31
    ds_read_b64_tr_b16 v[72:73], v60 offset:0
    ds_read_b64_tr_b16 v[74:75], v60 offset:1280
    s_waitcnt lgkmcnt(9)
    v_mfma_f32_32x32x16_bf16 v[112:127], v[80:83], a[4:7], v[112:127]
    ds_read_b128 a[20:23], v51 offset:4096
    s_add_u32 m0, s21, 20480
    s_nop 0
    global_load_lds_dwordx4 v[40:41], off
    v_add_co_u32 v40, vcc, s20, v40
    v_addc_co_u32 v41, vcc, 0, v41, vcc
    v_lshlrev_b32 v30, 16, v5
    v_and_b32 v31, 0xffff0000, v5
    v_add_f32 v31, 0x3727c5ac, v31
    v_cvt_pk_bf16_f32 v5, v31, v31
    v_lshlrev_b32 v31, 16, v5
    ds_read_b64_tr_b16 v[76:77], v60 offset:80
    ds_read_b64_tr_b16 v[78:79], v60 offset:1360
    s_waitcnt lgkmcnt(10)
    v_mfma_f32_32x32x16_bf16 v[128:143], v[84:87], a[4:7], v[128:143]
    ds_read_b128 a[24:27], v52 offset:4096
    v_sqrt_f32 v31, v31
    s_nop 0
    v_cvt_pk_bf16_f32 v5, v31, v31
    v_lshlrev_b32 v31, 16, v5
    v_rcp_f32 v31, v31
    ds_read_b64_tr_b16 v[80:81], v60 offset:160
    ds_read_b64_tr_b16 v[82:83], v60 offset:1440
    s_waitcnt lgkmcnt(11)
    v_mfma_f32_32x32x16_bf16 v[144:159], v[64:67], a[4:7], v[144:159]
    ds_read_b128 a[28:31], v53 offset:4096
    s_nop 0
    v_lshlrev_b32 v26, 16, v10
    v_and_b32 v27, 0xffff0000, v10
    v_lshlrev_b32 v36, 16, v11
    v_and_b32 v37, 0xffff0000, v11
    v_add_f32 v26, v26, v36
    v_add_f32 v27, v27, v37
    ds_read_b64_tr_b16 v[84:85], v60 offset:240
    ds_read_b64_tr_b16 v[86:87], v60 offset:1520
    s_waitcnt lgkmcnt(12)
    v_mfma_f32_32x32x16_bf16 v[160:175], v[68:71], a[4:7], v[160:175]
    s_add_u32 m0, s21, 21504
    s_nop 0
    global_load_lds_dwordx4 v[42:43], off
    v_add_co_u32 v42, vcc, s20, v42
    v_addc_co_u32 v43, vcc, 0, v43, vcc
    v_lshlrev_b32 v36, 16, v12
    v_and_b32 v37, 0xffff0000, v12
    v_add_f32 v26, v26, v36
    v_add_f32 v27, v27, v37
    v_lshlrev_b32 v36, 16, v13
    v_and_b32 v37, 0xffff0000, v13
    v_add_u32 v62, v9, v60
    ds_read_b64_tr_b16 v[64:65], v62 offset:0
    ds_read_b64_tr_b16 v[66:67], v62 offset:1280
    s_waitcnt lgkmcnt(11)
    v_mfma_f32_32x32x16_bf16 v[96:111], v[72:75], a[8:11], v[96:111]
    v_add_f32 v26, v26, v36
    v_add_f32 v27, v27, v37
    v_lshlrev_b32 v36, 16, v14
    v_and_b32 v37, 0xffff0000, v14
    v_add_f32 v26, v26, v36
    v_add_f32 v27, v27, v37
    ds_read_b64_tr_b16 v[68:69], v61 offset:0
    ds_read_b64_tr_b16 v[70:71], v61 offset:1280
    s_waitcnt lgkmcnt(10)
    v_mfma_f32_32x32x16_bf16 v[112:127], v[76:79], a[8:11], v[112:127]
    v_lshlrev_b32 v36, 16, v15
    v_and_b32 v37, 0xffff0000, v15
    v_add_f32 v26, v26, v36
    v_add_f32 v27, v27, v37
    v_lshlrev_b32 v36, 16, v16
    v_and_b32 v37, 0xffff0000, v16
    ds_read_b64_tr_b16 v[72:73], v61 offset:80
    ds_read_b64_tr_b16 v[74:75], v61 offset:1360
    s_waitcnt lgkmcnt(8)
    v_mfma_f32_32x32x16_bf16 v[128:143], v[80:83], a[8:11], v[128:143]
    s_add_u32 m0, s21, 22528
    s_mov_b32 exec_hi, 0
    global_load_lds_dwordx4 v[44:45], off
    s_mov_b32 exec_hi, -1
    v_add_co_u32 v44, vcc, s20, v44
    v_addc_co_u32 v45, vcc, 0, v45, vcc
    v_add_f32 v26, v26, v36
    v_add_f32 v27, v27, v37
    v_lshlrev_b32 v36, 16, v17
    v_and_b32 v37, 0xffff0000, v17
    v_add_f32 v26, v26, v36
    v_add_f32 v27, v27, v37
    ds_read_b64_tr_b16 v[76:77], v61 offset:160
    ds_read_b64_tr_b16 v[78:79], v61 offset:1440
    s_waitcnt lgkmcnt(8)
    v_mfma_f32_32x32x16_bf16 v[144:159], v[84:87], a[8:11], v[144:159]
    s_add_u32 m0, s34, 4096
    s_nop 0
    global_load_lds_dwordx4 v46, s[4:5]
    v_lshlrev_b32 v36, 16, v18
    v_and_b32 v37, 0xffff0000, v18
    v_add_f32 v26, v26, v36
    v_add_f32 v27, v27, v37
    v_lshlrev_b32 v36, 16, v19
    v_and_b32 v37, 0xffff0000, v19
    ds_read_b64_tr_b16 v[80:81], v61 offset:240
    ds_read_b64_tr_b16 v[82:83], v61 offset:1520
    s_waitcnt lgkmcnt(8)
    v_mfma_f32_32x32x16_bf16 v[160:175], v[64:67], a[8:11], v[160:175]
    v_add_f32 v26, v26, v36
    v_add_f32 v27, v27, v37
    v_lshlrev_b32 v36, 16, v20
    v_and_b32 v37, 0xffff0000, v20
    v_add_f32 v26, v26, v36
    v_add_f32 v27, v27, v37
    v_add_u32 v62, v9, v61
    ds_read_b64_tr_b16 v[84:85], v62 offset:0
    ds_read_b64_tr_b16 v[86:87], v62 offset:1280
    s_waitcnt lgkmcnt(8)
    v_mfma_f32_32x32x16_bf16 v[96:111], v[68:71], a[12:15], v[96:111]
    s_add_u32 m0, s34, 5120
    s_nop 0
    global_load_lds_dwordx4 v47, s[4:5]
    v_lshlrev_b32 v36, 16, v21
    v_and_b32 v37, 0xffff0000, v21
    v_add_f32 v26, v26, v36
    v_add_f32 v27, v27, v37
    v_lshlrev_b32 v36, 16, v22
    v_and_b32 v37, 0xffff0000, v22
    ds_read_b64_tr_b16 v[64:65], v58 offset:20480
    ds_read_b64_tr_b16 v[66:67], v58 offset:21760
    s_waitcnt lgkmcnt(8)
    v_mfma_f32_32x32x16_bf16 v[112:127], v[72:75], a[12:15], v[112:127]
    v_add_f32 v26, v26, v36
    v_add_f32 v27, v27, v37
    v_lshlrev_b32 v36, 16, v23
    v_and_b32 v37, 0xffff0000, v23
    v_add_f32 v26, v26, v36
    v_add_f32 v27, v27, v37
    ds_read_b64_tr_b16 v[68:69], v58 offset:20560
    ds_read_b64_tr_b16 v[70:71], v58 offset:21840
    s_waitcnt lgkmcnt(8)
    v_mfma_f32_32x32x16_bf16 v[128:143], v[76:79], a[12:15], v[128:143]
    s_add_u32 m0, s34, 6144
    s_nop 0
    global_load_lds_dwordx4 v48, s[4:5]
    v_lshlrev_b32 v36, 16, v24
    v_and_b32 v37, 0xffff0000, v24
    v_add_f32 v26, v26, v36
    v_add_f32 v27, v27, v37
    v_lshlrev_b32 v36, 16, v25
    v_and_b32 v37, 0xffff0000, v25
    ds_read_b64_tr_b16 v[72:73], v58 offset:20640
    ds_read_b64_tr_b16 v[74:75], v58 offset:21920
    s_waitcnt lgkmcnt(8)
    v_mfma_f32_32x32x16_bf16 v[144:159], v[80:83], a[12:15], v[144:159]
    v_add_f32 v26, v26, v36
    v_add_f32 v27, v27, v37
    ds_read_b64_tr_b16 v[76:77], v58 offset:20720
    ds_read_b64_tr_b16 v[78:79], v58 offset:22000
    s_waitcnt lgkmcnt(8)
    v_mfma_f32_32x32x16_bf16 v[160:175], v[84:87], a[12:15], v[160:175]
    s_add_u32 m0, s34, 7168
    s_nop 0
    global_load_lds_dwordx4 v49, s[4:5]
    s_add_u32 s4, s4, 128
    s_addc_u32 s5, s5, 0
    v_add_u32 v62, v9, v58
    ds_read_b64_tr_b16 v[80:81], v62 offset:20480
    ds_read_b64_tr_b16 v[82:83], v62 offset:21760
    ds_write_b64 v35, v[26:27]
    s_waitcnt lgkmcnt(9)
    v_mfma_f32_32x32x16_bf16 v[96:111], v[64:67], a[16:19], v[96:111]
    ds_read_b64_tr_b16 v[84:85], v59 offset:20480
    ds_read_b64_tr_b16 v[86:87], v59 offset:21760
    s_waitcnt lgkmcnt(9)
    v_mfma_f32_32x32x16_bf16 v[112:127], v[68:71], a[16:19], v[112:127]
    ds_read_b64_tr_b16 v[64:65], v59 offset:20560
    ds_read_b64_tr_b16 v[66:67], v59 offset:21840
    s_waitcnt lgkmcnt(9)
    v_mfma_f32_32x32x16_bf16 v[128:143], v[72:75], a[16:19], v[128:143]
    ds_read_b64_tr_b16 v[68:69], v59 offset:20640
    ds_read_b64_tr_b16 v[70:71], v59 offset:21920
    s_waitcnt lgkmcnt(9)
    v_mfma_f32_32x32x16_bf16 v[144:159], v[76:79], a[16:19], v[144:159]
    ds_read_b64_tr_b16 v[72:73], v59 offset:20720
    ds_read_b64_tr_b16 v[74:75], v59 offset:22000
    s_waitcnt vmcnt(7)
    s_waitcnt lgkmcnt(8)
    s_barrier
    v_mfma_f32_32x32x16_bf16 v[160:175], v[80:83], a[16:19], v[160:175]
    v_add_u32 v62, v9, v59
    ds_read_b64_tr_b16 v[76:77], v62 offset:20480
    ds_read_b64_tr_b16 v[78:79], v62 offset:21760
    s_waitcnt lgkmcnt(8)
    v_mfma_f32_32x32x16_bf16 v[96:111], v[84:87], a[20:23], v[96:111]
    ds_read_b128 a[0:3], v50 offset:0
    ds_read_b64_tr_b16 v[80:81], v60 offset:20480
    ds_read_b64_tr_b16 v[82:83], v60 offset:21760
    v_and_b32 v38, 127, v0
    v_lshlrev_b32 v38, 3, v38
    v_add_u32 v39, 148480, v38
    ds_read_b64 v[10:11], v39 offset:0
    ds_read_b64 v[12:13], v39 offset:640
    ds_read_b64 v[14:15], v39 offset:1280
    ds_read_b64 v[16:17], v39 offset:1920
    ds_read_b64 v[18:19], v39 offset:2560
    s_waitcnt lgkmcnt(14)
    v_mfma_f32_32x32x16_bf16 v[112:127], v[64:67], a[20:23], v[112:127]
    ds_read_b128 a[4:7], v51 offset:0
    s_add_u32 m0, s21, 40960
    s_nop 0
    global_load_lds_dwordx4 v[40:41], off
    v_add_co_u32 v40, vcc, s20, v40
    v_addc_co_u32 v41, vcc, 0, v41, vcc
    ds_read_b64_tr_b16 v[84:85], v60 offset:20560
    ds_read_b64_tr_b16 v[86:87], v60 offset:21840
    s_waitcnt lgkmcnt(15)
    v_mfma_f32_32x32x16_bf16 v[128:143], v[68:71], a[20:23], v[128:143]
    ds_read_b128 a[8:11], v52 offset:0
    ds_read_b64_tr_b16 v[64:65], v60 offset:20640
    ds_read_b64_tr_b16 v[66:67], v60 offset:21920
    s_waitcnt lgkmcnt(15)
    v_mfma_f32_32x32x16_bf16 v[144:159], v[72:75], a[20:23], v[144:159]
    ds_read_b128 a[12:15], v53 offset:0
    ds_read_b64_tr_b16 v[68:69], v60 offset:20720
    ds_read_b64_tr_b16 v[70:71], v60 offset:22000
    s_waitcnt lgkmcnt(15)
    v_mfma_f32_32x32x16_bf16 v[160:175], v[76:79], a[20:23], v[160:175]
    s_add_u32 m0, s21, 41984
    s_nop 0
    global_load_lds_dwordx4 v[42:43], off
    v_add_co_u32 v42, vcc, s20, v42
    v_addc_co_u32 v43, vcc, 0, v43, vcc
    v_add_u32 v62, v9, v60
    ds_read_b64_tr_b16 v[72:73], v62 offset:20480
    ds_read_b64_tr_b16 v[74:75], v62 offset:21760
    s_waitcnt lgkmcnt(11)
    v_add_f32 v10, v10, v12
    v_add_f32 v11, v11, v13
    v_add_f32 v10, v10, v14
    v_add_f32 v11, v11, v15
    v_add_f32 v10, v10, v16
    v_add_f32 v11, v11, v17
    v_add_f32 v10, v10, v18
    v_add_f32 v11, v11, v19
    v_cmp_gt_u32 vcc, 80, v0
    s_nop 1
    s_and_saveexec_b64 s[50:51], vcc
    s_cbranch_execz L_nocp_a5e0_1
    global_store_dwordx2 v38, v[10:11], s[52:53] sc0 sc1
L_nocp_a5e0_1:
    s_mov_b64 exec, -1
    v_mfma_f32_32x32x16_bf16 v[96:111], v[80:83], a[24:27], v[96:111]
    ds_read_b64_tr_b16 v[76:77], v61 offset:20480
    ds_read_b64_tr_b16 v[78:79], v61 offset:21760
    s_waitcnt lgkmcnt(10)
    v_mfma_f32_32x32x16_bf16 v[112:127], v[84:87], a[24:27], v[112:127]
    ds_read_b64_tr_b16 v[80:81], v61 offset:20560
    ds_read_b64_tr_b16 v[82:83], v61 offset:21840
    s_waitcnt lgkmcnt(8)
    s_mov_b64 exec, 1
    global_store_dwordx2 v7, v[30:31], s[42:43] sc0 sc1
    s_mov_b64 exec, -1
    v_mfma_f32_32x32x16_bf16 v[128:143], v[64:67], a[24:27], v[128:143]
    s_add_u32 m0, s21, 43008
    s_mov_b32 exec_hi, 0
    global_load_lds_dwordx4 v[44:45], off
    s_mov_b32 exec_hi, -1
    v_add_co_u32 v44, vcc, s20, v44
    v_addc_co_u32 v45, vcc, 0, v45, vcc
    ds_read_b64_tr_b16 v[84:85], v61 offset:20640
    ds_read_b64_tr_b16 v[86:87], v61 offset:21920
    s_waitcnt lgkmcnt(8)
    v_mfma_f32_32x32x16_bf16 v[144:159], v[68:71], a[24:27], v[144:159]
    s_add_u32 m0, s34, 0
    s_nop 0
    global_load_lds_dwordx4 v46, s[4:5]
    ds_read_b64_tr_b16 v[64:65], v61 offset:20720
    ds_read_b64_tr_b16 v[66:67], v61 offset:22000
    s_waitcnt lgkmcnt(8)
    v_mfma_f32_32x32x16_bf16 v[160:175], v[72:75], a[24:27], v[160:175]
    v_add_u32 v62, v9, v61
    ds_read_b64_tr_b16 v[68:69], v62 offset:20480
    ds_read_b64_tr_b16 v[70:71], v62 offset:21760
    s_waitcnt lgkmcnt(8)
    v_mfma_f32_32x32x16_bf16 v[96:111], v[76:79], a[28:31], v[96:111]
    s_add_u32 m0, s34, 1024
    s_nop 0
    global_load_lds_dwordx4 v47, s[4:5]
    ds_read_b64_tr_b16 v[72:73], v54 offset:0
    ds_read_b64_tr_b16 v[74:75], v54 offset:1280
    s_waitcnt lgkmcnt(8)
    v_mfma_f32_32x32x16_bf16 v[112:127], v[80:83], a[28:31], v[112:127]
    ds_read_b64_tr_b16 v[76:77], v54 offset:80
    ds_read_b64_tr_b16 v[78:79], v54 offset:1360
    s_waitcnt lgkmcnt(8)
    v_mfma_f32_32x32x16_bf16 v[128:143], v[84:87], a[28:31], v[128:143]
    s_add_u32 m0, s34, 2048
    s_nop 0
    global_load_lds_dwordx4 v48, s[4:5]
    ds_read_b64_tr_b16 v[80:81], v54 offset:160
    ds_read_b64_tr_b16 v[82:83], v54 offset:1440
    s_waitcnt lgkmcnt(8)
    v_mfma_f32_32x32x16_bf16 v[144:159], v[64:67], a[28:31], v[144:159]
    ds_read_b64_tr_b16 v[84:85], v54 offset:240
    ds_read_b64_tr_b16 v[86:87], v54 offset:1520
    s_waitcnt lgkmcnt(8)
    v_mfma_f32_32x32x16_bf16 v[160:175], v[68:71], a[28:31], v[160:175]
    s_add_u32 m0, s34, 3072
    s_nop 0
    global_load_lds_dwordx4 v49, s[4:5]
    s_add_u32 s4, s4, 128
    s_addc_u32 s5, s5, 0
    v_add_u32 v62, v9, v54
    ds_read_b64_tr_b16 v[64:65], v62 offset:0
    ds_read_b64_tr_b16 v[66:67], v62 offset:1280
    s_waitcnt lgkmcnt(8)
    v_mfma_f32_32x32x16_bf16 v[96:111], v[72:75], a[0:3], v[96:111]
    ds_read_b64_tr_b16 v[68:69], v55 offset:0
    ds_read_b64_tr_b16 v[70:71], v55 offset:1280
    s_waitcnt lgkmcnt(8)
    v_mfma_f32_32x32x16_bf16 v[112:127], v[76:79], a[0:3], v[112:127]
    ds_read_b64_tr_b16 v[72:73], v55 offset:80
    ds_read_b64_tr_b16 v[74:75], v55 offset:1360
    s_waitcnt lgkmcnt(8)
    v_mfma_f32_32x32x16_bf16 v[128:143], v[80:83], a[0:3], v[128:143]
    ds_read_b64_tr_b16 v[76:77], v55 offset:160
    ds_read_b64_tr_b16 v[78:79], v55 offset:1440
    s_waitcnt lgkmcnt(8)
    v_mfma_f32_32x32x16_bf16 v[144:159], v[84:87], a[0:3], v[144:159]
    ds_read_b64_tr_b16 v[80:81], v55 offset:240
    ds_read_b64_tr_b16 v[82:83], v55 offset:1520
    s_waitcnt vmcnt(8)
    s_waitcnt vmcnt(5)
    s_barrier
    s_cmp_lg_u32 s14, 0
    s_cbranch_scc1 L_flag_a5e0_2
    v_mov_b32 v38, s13
    v_mov_b32 v39, 1
    s_mov_b64 exec, 1
    global_store_byte v38, v39, s[36:37] sc0 sc1
    s_mov_b64 exec, -1

L_flag_a5e0_2:
    s_waitcnt lgkmcnt(8)
    v_mfma_f32_32x32x16_bf16 v[160:175], v[64:67], a[0:3], v[160:175]
    v_add_u32 v62, v9, v55
    ds_read_b64_tr_b16 v[84:85], v62 offset:0
    ds_read_b64_tr_b16 v[86:87], v62 offset:1280
    s_waitcnt lgkmcnt(8)
    v_mfma_f32_32x32x16_bf16 v[96:111], v[68:71], a[4:7], v[96:111]
    ds_read_b128 a[16:19], v50 offset:4096
    ds_read_b64_tr_b16 v[64:65], v56 offset:0
    ds_read_b64_tr_b16 v[66:67], v56 offset:1280
    s_waitcnt lgkmcnt(9)
    v_mfma_f32_32x32x16_bf16 v[112:127], v[72:75], a[4:7], v[112:127]
    ds_read_b128 a[20:23], v51 offset:4096
    s_add_u32 m0, s21, 61440
    s_nop 0
    global_load_lds_dwordx4 v[40:41], off
    v_add_co_u32 v40, vcc, s20, v40
    v_addc_co_u32 v41, vcc, 0, v41, vcc
    ds_read_b64_tr_b16 v[68:69], v56 offset:80
    ds_read_b64_tr_b16 v[70:71], v56 offset:1360
    s_waitcnt lgkmcnt(10)
    v_mfma_f32_32x32x16_bf16 v[128:143], v[76:79], a[4:7], v[128:143]
    ds_read_b128 a[24:27], v52 offset:4096
    ds_read_b64_tr_b16 v[72:73], v56 offset:160
    ds_read_b64_tr_b16 v[74:75], v56 offset:1440
    s_waitcnt lgkmcnt(11)
    v_mfma_f32_32x32x16_bf16 v[144:159], v[80:83], a[4:7], v[144:159]
    ds_read_b128 a[28:31], v53 offset:4096
    ds_read_b64_tr_b16 v[76:77], v56 offset:240
    ds_read_b64_tr_b16 v[78:79], v56 offset:1520
    s_waitcnt lgkmcnt(12)
    v_mfma_f32_32x32x16_bf16 v[160:175], v[84:87], a[4:7], v[160:175]
    s_add_u32 m0, s21, 62464
    s_nop 0
    global_load_lds_dwordx4 v[42:43], off
    v_add_co_u32 v42, vcc, s20, v42
    v_addc_co_u32 v43, vcc, 0, v43, vcc
    v_add_u32 v62, v9, v56
    ds_read_b64_tr_b16 v[80:81], v62 offset:0
    ds_read_b64_tr_b16 v[82:83], v62 offset:1280
    s_waitcnt lgkmcnt(11)
    v_mfma_f32_32x32x16_bf16 v[96:111], v[64:67], a[8:11], v[96:111]
    ds_read_b64_tr_b16 v[84:85], v57 offset:0
    ds_read_b64_tr_b16 v[86:87], v57 offset:1280
    s_waitcnt lgkmcnt(10)
    v_mfma_f32_32x32x16_bf16 v[112:127], v[68:71], a[8:11], v[112:127]
    ds_read_b64_tr_b16 v[64:65], v57 offset:80
    ds_read_b64_tr_b16 v[66:67], v57 offset:1360
    s_waitcnt lgkmcnt(8)
    v_mfma_f32_32x32x16_bf16 v[128:143], v[72:75], a[8:11], v[128:143]
    s_add_u32 m0, s21, 63488
    s_mov_b32 exec_hi, 0
    global_load_lds_dwordx4 v[44:45], off
    s_mov_b32 exec_hi, -1
    v_add_co_u32 v44, vcc, s20, v44
    v_addc_co_u32 v45, vcc, 0, v45, vcc
    ds_read_b64_tr_b16 v[68:69], v57 offset:160
    ds_read_b64_tr_b16 v[70:71], v57 offset:1440
    s_waitcnt lgkmcnt(8)
    v_mfma_f32_32x32x16_bf16 v[144:159], v[76:79], a[8:11], v[144:159]
    s_add_u32 m0, s34, 4096
    s_nop 0
    global_load_lds_dwordx4 v46, s[4:5]
    ds_read_b64_tr_b16 v[72:73], v57 offset:240
    ds_read_b64_tr_b16 v[74:75], v57 offset:1520
    s_waitcnt lgkmcnt(8)
    v_mfma_f32_32x32x16_bf16 v[160:175], v[80:83], a[8:11], v[160:175]
    v_add_u32 v62, v9, v57
    ds_read_b64_tr_b16 v[76:77], v62 offset:0
    ds_read_b64_tr_b16 v[78:79], v62 offset:1280
    s_waitcnt lgkmcnt(8)
    v_mfma_f32_32x32x16_bf16 v[96:111], v[84:87], a[12:15], v[96:111]
    s_add_u32 m0, s34, 5120
    s_nop 0
    global_load_lds_dwordx4 v47, s[4:5]
    ds_read_b64_tr_b16 v[80:81], v54 offset:20480
    ds_read_b64_tr_b16 v[82:83], v54 offset:21760
    s_waitcnt lgkmcnt(8)
    v_mfma_f32_32x32x16_bf16 v[112:127], v[64:67], a[12:15], v[112:127]
    ds_read_b64_tr_b16 v[84:85], v54 offset:20560
    ds_read_b64_tr_b16 v[86:87], v54 offset:21840
    s_waitcnt lgkmcnt(8)
    v_mfma_f32_32x32x16_bf16 v[128:143], v[68:71], a[12:15], v[128:143]
    s_add_u32 m0, s34, 6144
    s_nop 0
    global_load_lds_dwordx4 v48, s[4:5]
    ds_read_b64_tr_b16 v[64:65], v54 offset:20640
    ds_read_b64_tr_b16 v[66:67], v54 offset:21920
    s_waitcnt lgkmcnt(8)
    v_mfma_f32_32x32x16_bf16 v[144:159], v[72:75], a[12:15], v[144:159]
    ds_read_b64_tr_b16 v[68:69], v54 offset:20720
    ds_read_b64_tr_b16 v[70:71], v54 offset:22000
    s_waitcnt lgkmcnt(8)
    v_mfma_f32_32x32x16_bf16 v[160:175], v[76:79], a[12:15], v[160:175]
    s_add_u32 m0, s34, 7168
    s_nop 0
    global_load_lds_dwordx4 v49, s[4:5]
    s_add_u32 s4, s4, 128
    s_addc_u32 s5, s5, 0
    v_add_u32 v62, v9, v54
    ds_read_b64_tr_b16 v[72:73], v62 offset:20480
    ds_read_b64_tr_b16 v[74:75], v62 offset:21760
    s_waitcnt lgkmcnt(8)
    v_mfma_f32_32x32x16_bf16 v[96:111], v[80:83], a[16:19], v[96:111]
    ds_read_b64_tr_b16 v[76:77], v55 offset:20480
    ds_read_b64_tr_b16 v[78:79], v55 offset:21760
    s_waitcnt lgkmcnt(8)
    v_mfma_f32_32x32x16_bf16 v[112:127], v[84:87], a[16:19], v[112:127]
    ds_read_b64_tr_b16 v[80:81], v55 offset:20560
    ds_read_b64_tr_b16 v[82:83], v55 offset:21840
    s_waitcnt lgkmcnt(8)
    v_mfma_f32_32x32x16_bf16 v[128:143], v[64:67], a[16:19], v[128:143]
    ds_read_b64_tr_b16 v[84:85], v55 offset:20640
    ds_read_b64_tr_b16 v[86:87], v55 offset:21920
    s_waitcnt lgkmcnt(8)
    v_mfma_f32_32x32x16_bf16 v[144:159], v[68:71], a[16:19], v[144:159]
    ds_read_b64_tr_b16 v[64:65], v55 offset:20720
    ds_read_b64_tr_b16 v[66:67], v55 offset:22000
    s_waitcnt vmcnt(7)
    s_barrier
    s_waitcnt lgkmcnt(8)
    v_mfma_f32_32x32x16_bf16 v[160:175], v[72:75], a[16:19], v[160:175]
    v_add_u32 v62, v9, v55
    ds_read_b64_tr_b16 v[68:69], v62 offset:20480
    ds_read_b64_tr_b16 v[70:71], v62 offset:21760
    s_waitcnt lgkmcnt(8)
    v_mfma_f32_32x32x16_bf16 v[96:111], v[76:79], a[20:23], v[96:111]
    ds_read_b128 a[0:3], v50 offset:0
    ds_read_b64_tr_b16 v[72:73], v56 offset:20480
    ds_read_b64_tr_b16 v[74:75], v56 offset:21760
    s_waitcnt lgkmcnt(9)
    v_mfma_f32_32x32x16_bf16 v[112:127], v[80:83], a[20:23], v[112:127]
    ds_read_b128 a[4:7], v51 offset:0
    s_add_u32 m0, s21, 0
    s_nop 0
    global_load_lds_dwordx4 v[40:41], off
    v_add_co_u32 v40, vcc, s20, v40
    v_addc_co_u32 v41, vcc, 0, v41, vcc
    ds_read_b64_tr_b16 v[76:77], v56 offset:20560
    ds_read_b64_tr_b16 v[78:79], v56 offset:21840
    s_waitcnt lgkmcnt(10)
    v_mfma_f32_32x32x16_bf16 v[128:143], v[84:87], a[20:23], v[128:143]
    ds_read_b128 a[8:11], v52 offset:0
    ds_read_b64_tr_b16 v[80:81], v56 offset:20640
    ds_read_b64_tr_b16 v[82:83], v56 offset:21920
    s_waitcnt lgkmcnt(11)
    v_mfma_f32_32x32x16_bf16 v[144:159], v[64:67], a[20:23], v[144:159]
    ds_read_b128 a[12:15], v53 offset:0
    ds_read_b64_tr_b16 v[84:85], v56 offset:20720
    ds_read_b64_tr_b16 v[86:87], v56 offset:22000
    s_waitcnt lgkmcnt(12)
    v_mfma_f32_32x32x16_bf16 v[160:175], v[68:71], a[20:23], v[160:175]
    s_add_u32 m0, s21, 1024
    s_nop 0
    global_load_lds_dwordx4 v[42:43], off
    v_add_co_u32 v42, vcc, s20, v42
    v_addc_co_u32 v43, vcc, 0, v43, vcc
    v_add_u32 v62, v9, v56
    ds_read_b64_tr_b16 v[64:65], v62 offset:20480
    ds_read_b64_tr_b16 v[66:67], v62 offset:21760
    s_waitcnt lgkmcnt(11)
    v_mfma_f32_32x32x16_bf16 v[96:111], v[72:75], a[24:27], v[96:111]
    ds_read_b64_tr_b16 v[68:69], v57 offset:20480
    ds_read_b64_tr_b16 v[70:71], v57 offset:21760
    s_waitcnt lgkmcnt(10)
    v_mfma_f32_32x32x16_bf16 v[112:127], v[76:79], a[24:27], v[112:127]
    ds_read_b64_tr_b16 v[72:73], v57 offset:20560
    ds_read_b64_tr_b16 v[74:75], v57 offset:21840
    s_waitcnt lgkmcnt(8)
    v_mfma_f32_32x32x16_bf16 v[128:143], v[80:83], a[24:27], v[128:143]
    s_add_u32 m0, s21, 2048
    s_mov_b32 exec_hi, 0
    global_load_lds_dwordx4 v[44:45], off
    s_mov_b32 exec_hi, -1
    v_add_co_u32 v44, vcc, s20, v44
    v_addc_co_u32 v45, vcc, 0, v45, vcc
    ds_read_b64_tr_b16 v[76:77], v57 offset:20640
    ds_read_b64_tr_b16 v[78:79], v57 offset:21920
    s_waitcnt lgkmcnt(8)
    v_mfma_f32_32x32x16_bf16 v[144:159], v[84:87], a[24:27], v[144:159]
    s_add_u32 m0, s34, 0
    s_nop 0
    global_load_lds_dwordx4 v46, s[4:5]
    ds_read_b64_tr_b16 v[80:81], v57 offset:20720
    ds_read_b64_tr_b16 v[82:83], v57 offset:22000
    s_waitcnt lgkmcnt(8)
    v_mfma_f32_32x32x16_bf16 v[160:175], v[64:67], a[24:27], v[160:175]
    v_add_u32 v62, v9, v57
    ds_read_b64_tr_b16 v[84:85], v62 offset:20480
    ds_read_b64_tr_b16 v[86:87], v62 offset:21760
    s_waitcnt lgkmcnt(8)
    v_mfma_f32_32x32x16_bf16 v[96:111], v[68:71], a[28:31], v[96:111]
    s_add_u32 m0, s34, 1024
    s_nop 0
    global_load_lds_dwordx4 v47, s[4:5]
    ds_read_b64_tr_b16 v[64:65], v58 offset:0
    ds_read_b64_tr_b16 v[66:67], v58 offset:1280
    s_waitcnt lgkmcnt(8)
    v_mfma_f32_32x32x16_bf16 v[112:127], v[72:75], a[28:31], v[112:127]
    ds_read_b64_tr_b16 v[68:69], v58 offset:80
    ds_read_b64_tr_b16 v[70:71], v58 offset:1360
    s_waitcnt lgkmcnt(8)
    v_mfma_f32_32x32x16_bf16 v[128:143], v[76:79], a[28:31], v[128:143]
    s_add_u32 m0, s34, 2048
    s_nop 0
    global_load_lds_dwordx4 v48, s[4:5]
    ds_read_b64_tr_b16 v[72:73], v58 offset:160
    ds_read_b64_tr_b16 v[74:75], v58 offset:1440
    s_waitcnt lgkmcnt(8)
    v_mfma_f32_32x32x16_bf16 v[144:159], v[80:83], a[28:31], v[144:159]
    ds_read_b64_tr_b16 v[76:77], v58 offset:240
    ds_read_b64_tr_b16 v[78:79], v58 offset:1520
    s_waitcnt lgkmcnt(8)
    v_mfma_f32_32x32x16_bf16 v[160:175], v[84:87], a[28:31], v[160:175]
    s_add_u32 m0, s34, 3072
    s_nop 0
    global_load_lds_dwordx4 v49, s[4:5]
    s_add_u32 s4, s4, 128
    s_addc_u32 s5, s5, 0
    v_add_u32 v62, v9, v58
    ds_read_b64_tr_b16 v[80:81], v62 offset:0
    ds_read_b64_tr_b16 v[82:83], v62 offset:1280
    s_waitcnt lgkmcnt(8)
    v_mfma_f32_32x32x16_bf16 v[96:111], v[64:67], a[0:3], v[96:111]
    ds_read_b64_tr_b16 v[84:85], v59 offset:0
    ds_read_b64_tr_b16 v[86:87], v59 offset:1280
    s_waitcnt lgkmcnt(8)
    v_mfma_f32_32x32x16_bf16 v[112:127], v[68:71], a[0:3], v[112:127]
    ds_read_b64_tr_b16 v[64:65], v59 offset:80
    ds_read_b64_tr_b16 v[66:67], v59 offset:1360
    s_waitcnt lgkmcnt(8)
    v_mfma_f32_32x32x16_bf16 v[128:143], v[72:75], a[0:3], v[128:143]
    ds_read_b64_tr_b16 v[68:69], v59 offset:160
    ds_read_b64_tr_b16 v[70:71], v59 offset:1440
    s_waitcnt lgkmcnt(8)
    v_mfma_f32_32x32x16_bf16 v[144:159], v[76:79], a[0:3], v[144:159]
    ds_read_b64_tr_b16 v[72:73], v59 offset:240
    ds_read_b64_tr_b16 v[74:75], v59 offset:1520
    s_waitcnt vmcnt(7)
    s_barrier
    s_waitcnt lgkmcnt(8)
    v_mfma_f32_32x32x16_bf16 v[160:175], v[80:83], a[0:3], v[160:175]
    v_add_u32 v62, v9, v59
    ds_read_b64_tr_b16 v[76:77], v62 offset:0
    ds_read_b64_tr_b16 v[78:79], v62 offset:1280
    s_waitcnt lgkmcnt(8)
    v_mfma_f32_32x32x16_bf16 v[96:111], v[84:87], a[4:7], v[96:111]
    ds_read_b128 a[16:19], v50 offset:4096
    ds_read_b64_tr_b16 v[80:81], v60 offset:0
    ds_read_b64_tr_b16 v[82:83], v60 offset:1280
    s_waitcnt lgkmcnt(9)
    v_mfma_f32_32x32x16_bf16 v[112:127], v[64:67], a[4:7], v[112:127]
    ds_read_b128 a[20:23], v51 offset:4096
    s_add_u32 m0, s21, 20480
    s_nop 0
    global_load_lds_dwordx4 v[40:41], off
    v_add_co_u32 v40, vcc, s20, v40
    v_addc_co_u32 v41, vcc, 0, v41, vcc
    ds_read_b64_tr_b16 v[84:85], v60 offset:80
    ds_read_b64_tr_b16 v[86:87], v60 offset:1360
    s_waitcnt lgkmcnt(10)
    v_mfma_f32_32x32x16_bf16 v[128:143], v[68:71], a[4:7], v[128:143]
    ds_read_b128 a[24:27], v52 offset:4096
    ds_read_b64_tr_b16 v[64:65], v60 offset:160
    ds_read_b64_tr_b16 v[66:67], v60 offset:1440
    s_waitcnt lgkmcnt(11)
    v_mfma_f32_32x32x16_bf16 v[144:159], v[72:75], a[4:7], v[144:159]
    ds_read_b128 a[28:31], v53 offset:4096
    ds_read_b64_tr_b16 v[68:69], v60 offset:240
    ds_read_b64_tr_b16 v[70:71], v60 offset:1520
    s_waitcnt lgkmcnt(12)
    v_mfma_f32_32x32x16_bf16 v[160:175], v[76:79], a[4:7], v[160:175]
    s_add_u32 m0, s21, 21504
    s_nop 0
    global_load_lds_dwordx4 v[42:43], off
    v_add_co_u32 v42, vcc, s20, v42
    v_addc_co_u32 v43, vcc, 0, v43, vcc
    v_add_u32 v62, v9, v60
    ds_read_b64_tr_b16 v[72:73], v62 offset:0
    ds_read_b64_tr_b16 v[74:75], v62 offset:1280
    s_waitcnt lgkmcnt(11)
    v_mfma_f32_32x32x16_bf16 v[96:111], v[80:83], a[8:11], v[96:111]
    ds_read_b64_tr_b16 v[76:77], v61 offset:0
    ds_read_b64_tr_b16 v[78:79], v61 offset:1280
    s_waitcnt lgkmcnt(10)
    v_mfma_f32_32x32x16_bf16 v[112:127], v[84:87], a[8:11], v[112:127]
    ds_read_b64_tr_b16 v[80:81], v61 offset:80
    ds_read_b64_tr_b16 v[82:83], v61 offset:1360
    s_waitcnt lgkmcnt(8)
    v_mfma_f32_32x32x16_bf16 v[128:143], v[64:67], a[8:11], v[128:143]
    s_add_u32 m0, s21, 22528
    s_mov_b32 exec_hi, 0
    global_load_lds_dwordx4 v[44:45], off
    s_mov_b32 exec_hi, -1
    v_add_co_u32 v44, vcc, s20, v44
    v_addc_co_u32 v45, vcc, 0, v45, vcc
    ds_read_b64_tr_b16 v[84:85], v61 offset:160
    ds_read_b64_tr_b16 v[86:87], v61 offset:1440
    s_waitcnt lgkmcnt(8)
    v_mfma_f32_32x32x16_bf16 v[144:159], v[68:71], a[8:11], v[144:159]
    s_add_u32 m0, s34, 4096
    s_nop 0
    global_load_lds_dwordx4 v46, s[4:5]
    ds_read_b64_tr_b16 v[64:65], v61 offset:240
    ds_read_b64_tr_b16 v[66:67], v61 offset:1520
    s_waitcnt lgkmcnt(8)
    v_mfma_f32_32x32x16_bf16 v[160:175], v[72:75], a[8:11], v[160:175]
    v_add_u32 v62, v9, v61
    ds_read_b64_tr_b16 v[68:69], v62 offset:0
    ds_read_b64_tr_b16 v[70:71], v62 offset:1280
    s_waitcnt lgkmcnt(8)
    v_mfma_f32_32x32x16_bf16 v[96:111], v[76:79], a[12:15], v[96:111]
    s_add_u32 m0, s34, 5120
    s_nop 0
    global_load_lds_dwordx4 v47, s[4:5]
    ds_read_b64_tr_b16 v[72:73], v58 offset:20480
    ds_read_b64_tr_b16 v[74:75], v58 offset:21760
    s_waitcnt lgkmcnt(8)
    v_mfma_f32_32x32x16_bf16 v[112:127], v[80:83], a[12:15], v[112:127]
    ds_read_b64_tr_b16 v[76:77], v58 offset:20560
    ds_read_b64_tr_b16 v[78:79], v58 offset:21840
    s_waitcnt lgkmcnt(8)
    v_mfma_f32_32x32x16_bf16 v[128:143], v[84:87], a[12:15], v[128:143]
    s_add_u32 m0, s34, 6144
    s_nop 0
    global_load_lds_dwordx4 v48, s[4:5]
    ds_read_b64_tr_b16 v[80:81], v58 offset:20640
    ds_read_b64_tr_b16 v[82:83], v58 offset:21920
    s_waitcnt lgkmcnt(8)
    v_mfma_f32_32x32x16_bf16 v[144:159], v[64:67], a[12:15], v[144:159]
    ds_read_b64_tr_b16 v[84:85], v58 offset:20720
    ds_read_b64_tr_b16 v[86:87], v58 offset:22000
    s_waitcnt lgkmcnt(8)
    v_mfma_f32_32x32x16_bf16 v[160:175], v[68:71], a[12:15], v[160:175]
    s_add_u32 m0, s34, 7168
    s_nop 0
    global_load_lds_dwordx4 v49, s[4:5]
    s_add_u32 s4, s4, 128
    s_addc_u32 s5, s5, 0
    v_add_u32 v62, v9, v58
    ds_read_b64_tr_b16 v[64:65], v62 offset:20480
    ds_read_b64_tr_b16 v[66:67], v62 offset:21760
    s_waitcnt lgkmcnt(8)
    v_mfma_f32_32x32x16_bf16 v[96:111], v[72:75], a[16:19], v[96:111]
    ds_read_b64_tr_b16 v[68:69], v59 offset:20480
    ds_read_b64_tr_b16 v[70:71], v59 offset:21760
    s_waitcnt lgkmcnt(8)
    v_mfma_f32_32x32x16_bf16 v[112:127], v[76:79], a[16:19], v[112:127]
    ds_read_b64_tr_b16 v[72:73], v59 offset:20560
    ds_read_b64_tr_b16 v[74:75], v59 offset:21840
    s_waitcnt lgkmcnt(8)
    v_mfma_f32_32x32x16_bf16 v[128:143], v[80:83], a[16:19], v[128:143]
    ds_read_b64_tr_b16 v[76:77], v59 offset:20640
    ds_read_b64_tr_b16 v[78:79], v59 offset:21920
    s_waitcnt lgkmcnt(8)
    v_mfma_f32_32x32x16_bf16 v[144:159], v[84:87], a[16:19], v[144:159]
    ds_read_b64_tr_b16 v[80:81], v59 offset:20720
    ds_read_b64_tr_b16 v[82:83], v59 offset:22000
    s_waitcnt vmcnt(7)
    s_barrier
    s_waitcnt lgkmcnt(8)
    v_mfma_f32_32x32x16_bf16 v[160:175], v[64:67], a[16:19], v[160:175]
    v_add_u32 v62, v9, v59
    ds_read_b64_tr_b16 v[84:85], v62 offset:20480
    ds_read_b64_tr_b16 v[86:87], v62 offset:21760
    s_waitcnt lgkmcnt(8)
    v_mfma_f32_32x32x16_bf16 v[96:111], v[68:71], a[20:23], v[96:111]
    ds_read_b128 a[0:3], v50 offset:0
    ds_read_b64_tr_b16 v[64:65], v60 offset:20480
    ds_read_b64_tr_b16 v[66:67], v60 offset:21760
    s_waitcnt lgkmcnt(9)
    v_mfma_f32_32x32x16_bf16 v[112:127], v[72:75], a[20:23], v[112:127]
    ds_read_b128 a[4:7], v51 offset:0
    ds_read_b64_tr_b16 v[68:69], v60 offset:20560
    ds_read_b64_tr_b16 v[70:71], v60 offset:21840
    s_waitcnt lgkmcnt(10)
    v_mfma_f32_32x32x16_bf16 v[128:143], v[76:79], a[20:23], v[128:143]
    ds_read_b128 a[8:11], v52 offset:0
    ds_read_b64_tr_b16 v[72:73], v60 offset:20640
    ds_read_b64_tr_b16 v[74:75], v60 offset:21920
    s_waitcnt lgkmcnt(11)
    v_mfma_f32_32x32x16_bf16 v[144:159], v[80:83], a[20:23], v[144:159]
    ds_read_b128 a[12:15], v53 offset:0
    ds_read_b64_tr_b16 v[76:77], v60 offset:20720
    ds_read_b64_tr_b16 v[78:79], v60 offset:22000
    s_waitcnt lgkmcnt(12)
    v_mfma_f32_32x32x16_bf16 v[160:175], v[84:87], a[20:23], v[160:175]
    v_add_u32 v62, v9, v60
    ds_read_b64_tr_b16 v[80:81], v62 offset:20480
    ds_read_b64_tr_b16 v[82:83], v62 offset:21760
    s_waitcnt lgkmcnt(11)
    v_mfma_f32_32x32x16_bf16 v[96:111], v[64:67], a[24:27], v[96:111]
    ds_read_b64_tr_b16 v[84:85], v61 offset:20480
    ds_read_b64_tr_b16 v[86:87], v61 offset:21760
    s_waitcnt lgkmcnt(10)
    v_mfma_f32_32x32x16_bf16 v[112:127], v[68:71], a[24:27], v[112:127]
    ds_read_b64_tr_b16 v[64:65], v61 offset:20560
    ds_read_b64_tr_b16 v[66:67], v61 offset:21840
    s_waitcnt lgkmcnt(9)
    v_mfma_f32_32x32x16_bf16 v[128:143], v[72:75], a[24:27], v[128:143]
    ds_read_b64_tr_b16 v[68:69], v61 offset:20640
    ds_read_b64_tr_b16 v[70:71], v61 offset:21920
    s_waitcnt lgkmcnt(8)
    v_mfma_f32_32x32x16_bf16 v[144:159], v[76:79], a[24:27], v[144:159]
    ds_read_b64_tr_b16 v[72:73], v61 offset:20720
    ds_read_b64_tr_b16 v[74:75], v61 offset:22000
    s_waitcnt lgkmcnt(8)
    v_mfma_f32_32x32x16_bf16 v[160:175], v[80:83], a[24:27], v[160:175]
    v_add_u32 v62, v9, v61
    ds_read_b64_tr_b16 v[76:77], v62 offset:20480
    ds_read_b64_tr_b16 v[78:79], v62 offset:21760
    s_waitcnt lgkmcnt(8)
    v_mfma_f32_32x32x16_bf16 v[96:111], v[84:87], a[28:31], v[96:111]
    ds_read_b64_tr_b16 v[80:81], v54 offset:0
    ds_read_b64_tr_b16 v[82:83], v54 offset:1280
    s_waitcnt lgkmcnt(8)
    v_mfma_f32_32x32x16_bf16 v[112:127], v[64:67], a[28:31], v[112:127]
    ds_read_b64_tr_b16 v[84:85], v54 offset:80
    ds_read_b64_tr_b16 v[86:87], v54 offset:1360
    s_waitcnt lgkmcnt(8)
    v_mfma_f32_32x32x16_bf16 v[128:143], v[68:71], a[28:31], v[128:143]
    ds_read_b64_tr_b16 v[64:65], v54 offset:160
    ds_read_b64_tr_b16 v[66:67], v54 offset:1440
    s_waitcnt lgkmcnt(8)
    v_mfma_f32_32x32x16_bf16 v[144:159], v[72:75], a[28:31], v[144:159]
    ds_read_b64_tr_b16 v[68:69], v54 offset:240
    ds_read_b64_tr_b16 v[70:71], v54 offset:1520
    s_waitcnt lgkmcnt(8)
    v_mfma_f32_32x32x16_bf16 v[160:175], v[76:79], a[28:31], v[160:175]
    v_add_u32 v62, v9, v54
    ds_read_b64_tr_b16 v[72:73], v62 offset:0
    ds_read_b64_tr_b16 v[74:75], v62 offset:1280
    s_waitcnt lgkmcnt(8)
    v_mfma_f32_32x32x16_bf16 v[96:111], v[80:83], a[0:3], v[96:111]
    ds_read_b64_tr_b16 v[76:77], v55 offset:0
    ds_read_b64_tr_b16 v[78:79], v55 offset:1280
    s_waitcnt lgkmcnt(8)
    v_mfma_f32_32x32x16_bf16 v[112:127], v[84:87], a[0:3], v[112:127]
    ds_read_b64_tr_b16 v[80:81], v55 offset:80
    ds_read_b64_tr_b16 v[82:83], v55 offset:1360
    s_waitcnt lgkmcnt(8)
    v_mfma_f32_32x32x16_bf16 v[128:143], v[64:67], a[0:3], v[128:143]
    ds_read_b64_tr_b16 v[84:85], v55 offset:160
    ds_read_b64_tr_b16 v[86:87], v55 offset:1440
    s_waitcnt lgkmcnt(8)
    v_mfma_f32_32x32x16_bf16 v[144:159], v[68:71], a[0:3], v[144:159]
    ds_read_b64_tr_b16 v[64:65], v55 offset:240
    ds_read_b64_tr_b16 v[66:67], v55 offset:1520
    s_waitcnt vmcnt(0)
    s_barrier
    s_waitcnt lgkmcnt(8)
    v_mfma_f32_32x32x16_bf16 v[160:175], v[72:75], a[0:3], v[160:175]
    v_add_u32 v62, v9, v55
    ds_read_b64_tr_b16 v[68:69], v62 offset:0
    ds_read_b64_tr_b16 v[70:71], v62 offset:1280
    s_waitcnt lgkmcnt(8)
    v_mfma_f32_32x32x16_bf16 v[96:111], v[76:79], a[4:7], v[96:111]
    ds_read_b128 a[16:19], v50 offset:4096
    ds_read_b64_tr_b16 v[72:73], v56 offset:0
    ds_read_b64_tr_b16 v[74:75], v56 offset:1280
    s_waitcnt lgkmcnt(9)
    v_mfma_f32_32x32x16_bf16 v[112:127], v[80:83], a[4:7], v[112:127]
    ds_read_b128 a[20:23], v51 offset:4096
    ds_read_b64_tr_b16 v[76:77], v56 offset:80
    ds_read_b64_tr_b16 v[78:79], v56 offset:1360
    s_waitcnt lgkmcnt(10)
    v_mfma_f32_32x32x16_bf16 v[128:143], v[84:87], a[4:7], v[128:143]
    ds_read_b128 a[24:27], v52 offset:4096
    ds_read_b64_tr_b16 v[80:81], v56 offset:160
    ds_read_b64_tr_b16 v[82:83], v56 offset:1440
    s_waitcnt lgkmcnt(11)
    v_mfma_f32_32x32x16_bf16 v[144:159], v[64:67], a[4:7], v[144:159]
    ds_read_b128 a[28:31], v53 offset:4096
    ds_read_b64_tr_b16 v[84:85], v56 offset:240
    ds_read_b64_tr_b16 v[86:87], v56 offset:1520
    s_waitcnt lgkmcnt(12)
    v_mfma_f32_32x32x16_bf16 v[160:175], v[68:71], a[4:7], v[160:175]
    v_add_u32 v62, v9, v56
    ds_read_b64_tr_b16 v[64:65], v62 offset:0
    ds_read_b64_tr_b16 v[66:67], v62 offset:1280
    s_waitcnt lgkmcnt(11)
    v_mfma_f32_32x32x16_bf16 v[96:111], v[72:75], a[8:11], v[96:111]
    ds_read_b64_tr_b16 v[68:69], v57 offset:0
    ds_read_b64_tr_b16 v[70:71], v57 offset:1280
    s_waitcnt lgkmcnt(10)
    v_mfma_f32_32x32x16_bf16 v[112:127], v[76:79], a[8:11], v[112:127]
    ds_read_b64_tr_b16 v[72:73], v57 offset:80
    ds_read_b64_tr_b16 v[74:75], v57 offset:1360
    v_lshlrev_b32 v38, 2, v2
    global_load_dword v32, v38, s[44:45] sc0 sc1
    s_waitcnt lgkmcnt(9)
    v_mfma_f32_32x32x16_bf16 v[128:143], v[80:83], a[8:11], v[128:143]
    ds_read_b64_tr_b16 v[76:77], v57 offset:160
    ds_read_b64_tr_b16 v[78:79], v57 offset:1440
    s_waitcnt lgkmcnt(8)
    v_mfma_f32_32x32x16_bf16 v[144:159], v[84:87], a[8:11], v[144:159]
    ds_read_b64_tr_b16 v[80:81], v57 offset:240
    ds_read_b64_tr_b16 v[82:83], v57 offset:1520
    s_waitcnt lgkmcnt(8)
    v_mfma_f32_32x32x16_bf16 v[160:175], v[64:67], a[8:11], v[160:175]
    v_add_u32 v62, v9, v57
    ds_read_b64_tr_b16 v[84:85], v62 offset:0
    ds_read_b64_tr_b16 v[86:87], v62 offset:1280
    s_waitcnt lgkmcnt(8)
    v_mfma_f32_32x32x16_bf16 v[96:111], v[68:71], a[12:15], v[96:111]
    ds_read_b64_tr_b16 v[64:65], v54 offset:20480
    ds_read_b64_tr_b16 v[66:67], v54 offset:21760
    s_waitcnt lgkmcnt(8)
    v_mfma_f32_32x32x16_bf16 v[112:127], v[72:75], a[12:15], v[112:127]
    ds_read_b64_tr_b16 v[68:69], v54 offset:20560
    ds_read_b64_tr_b16 v[70:71], v54 offset:21840
    s_waitcnt lgkmcnt(8)
    v_mfma_f32_32x32x16_bf16 v[128:143], v[76:79], a[12:15], v[128:143]
    ds_read_b64_tr_b16 v[72:73], v54 offset:20640
    ds_read_b64_tr_b16 v[74:75], v54 offset:21920
    s_waitcnt lgkmcnt(8)
    v_mfma_f32_32x32x16_bf16 v[144:159], v[80:83], a[12:15], v[144:159]
    ds_read_b64_tr_b16 v[76:77], v54 offset:20720
    ds_read_b64_tr_b16 v[78:79], v54 offset:22000
    s_waitcnt lgkmcnt(8)
    v_mfma_f32_32x32x16_bf16 v[160:175], v[84:87], a[12:15], v[160:175]
    v_add_u32 v62, v9, v54
    ds_read_b64_tr_b16 v[80:81], v62 offset:20480
    ds_read_b64_tr_b16 v[82:83], v62 offset:21760
    s_waitcnt lgkmcnt(8)
    v_mfma_f32_32x32x16_bf16 v[96:111], v[64:67], a[16:19], v[96:111]
    ds_read_b64_tr_b16 v[84:85], v55 offset:20480
    ds_read_b64_tr_b16 v[86:87], v55 offset:21760
    s_waitcnt lgkmcnt(8)
    v_mfma_f32_32x32x16_bf16 v[112:127], v[68:71], a[16:19], v[112:127]
    ds_read_b64_tr_b16 v[64:65], v55 offset:20560
    ds_read_b64_tr_b16 v[66:67], v55 offset:21840
    s_waitcnt lgkmcnt(8)
    v_mfma_f32_32x32x16_bf16 v[128:143], v[72:75], a[16:19], v[128:143]
    ds_read_b64_tr_b16 v[68:69], v55 offset:20640
    ds_read_b64_tr_b16 v[70:71], v55 offset:21920
    s_waitcnt lgkmcnt(8)
    v_mfma_f32_32x32x16_bf16 v[144:159], v[76:79], a[16:19], v[144:159]
    ds_read_b64_tr_b16 v[72:73], v55 offset:20720
    ds_read_b64_tr_b16 v[74:75], v55 offset:22000
    s_waitcnt lgkmcnt(8)
    v_mfma_f32_32x32x16_bf16 v[160:175], v[80:83], a[16:19], v[160:175]
    v_add_u32 v62, v9, v55
    ds_read_b64_tr_b16 v[76:77], v62 offset:20480
    ds_read_b64_tr_b16 v[78:79], v62 offset:21760
    s_waitcnt lgkmcnt(8)
    v_mfma_f32_32x32x16_bf16 v[96:111], v[84:87], a[20:23], v[96:111]
    ds_read_b64_tr_b16 v[80:81], v56 offset:20480
    ds_read_b64_tr_b16 v[82:83], v56 offset:21760
    s_waitcnt lgkmcnt(8)
    v_mfma_f32_32x32x16_bf16 v[112:127], v[64:67], a[20:23], v[112:127]
    ds_read_b64_tr_b16 v[84:85], v56 offset:20560
    ds_read_b64_tr_b16 v[86:87], v56 offset:21840
    s_waitcnt lgkmcnt(8)
    v_mfma_f32_32x32x16_bf16 v[128:143], v[68:71], a[20:23], v[128:143]
    ds_read_b64_tr_b16 v[64:65], v56 offset:20640
    ds_read_b64_tr_b16 v[66:67], v56 offset:21920
    s_waitcnt lgkmcnt(8)
    v_mfma_f32_32x32x16_bf16 v[144:159], v[72:75], a[20:23], v[144:159]
    ds_read_b64_tr_b16 v[68:69], v56 offset:20720
    ds_read_b64_tr_b16 v[70:71], v56 offset:22000
    s_waitcnt lgkmcnt(8)
    v_mfma_f32_32x32x16_bf16 v[160:175], v[76:79], a[20:23], v[160:175]
    v_add_u32 v62, v9, v56
    ds_read_b64_tr_b16 v[72:73], v62 offset:20480
    ds_read_b64_tr_b16 v[74:75], v62 offset:21760
    s_waitcnt vmcnt(0)
    v_cmp_ne_u32 vcc, 0x01010101, v32
    v_lshlrev_b32 v38, 3, v3
    s_nop 2
    s_cmp_eq_u64 vcc, 0
    s_cselect_b32 s48, 1, 0
    s_cbranch_scc0 L_nopre_a5e0_3
    global_load_dwordx2 v[30:31], v38, s[42:43] sc0 sc1
    global_load_dword v10, v8, s[54:55] offset:-2560 sc0 sc1
    global_load_dword v11, v8, s[54:55] offset:-1920 sc0 sc1
    global_load_dword v12, v8, s[54:55] offset:-1280 sc0 sc1
    global_load_dword v13, v8, s[54:55] offset:-640 sc0 sc1
    global_load_dword v14, v8, s[54:55] offset:0 sc0 sc1
    global_load_dword v15, v8, s[54:55] offset:640 sc0 sc1
    global_load_dword v16, v8, s[54:55] offset:1280 sc0 sc1
    global_load_dword v17, v8, s[54:55] offset:1920 sc0 sc1
L_nopre_a5e0_3:
    s_waitcnt lgkmcnt(8)
    v_mfma_f32_32x32x16_bf16 v[96:111], v[80:83], a[24:27], v[96:111]
    ds_read_b64_tr_b16 v[76:77], v57 offset:20480
    ds_read_b64_tr_b16 v[78:79], v57 offset:21760
    s_waitcnt lgkmcnt(8)
    v_mfma_f32_32x32x16_bf16 v[112:127], v[84:87], a[24:27], v[112:127]
    ds_read_b64_tr_b16 v[80:81], v57 offset:20560
    ds_read_b64_tr_b16 v[82:83], v57 offset:21840
    s_waitcnt lgkmcnt(8)
    v_mfma_f32_32x32x16_bf16 v[128:143], v[64:67], a[24:27], v[128:143]
    ds_read_b64_tr_b16 v[84:85], v57 offset:20640
    ds_read_b64_tr_b16 v[86:87], v57 offset:21920
    s_waitcnt lgkmcnt(8)
    v_mfma_f32_32x32x16_bf16 v[144:159], v[68:71], a[24:27], v[144:159]
    ds_read_b64_tr_b16 v[64:65], v57 offset:20720
    ds_read_b64_tr_b16 v[66:67], v57 offset:22000
    s_waitcnt lgkmcnt(8)
    v_mfma_f32_32x32x16_bf16 v[160:175], v[72:75], a[24:27], v[160:175]
    v_add_u32 v62, v9, v57
    ds_read_b64_tr_b16 v[68:69], v62 offset:20480
    ds_read_b64_tr_b16 v[70:71], v62 offset:21760
    s_waitcnt lgkmcnt(8)
    v_mfma_f32_32x32x16_bf16 v[96:111], v[76:79], a[28:31], v[96:111]
    s_waitcnt lgkmcnt(6)
    v_mfma_f32_32x32x16_bf16 v[112:127], v[80:83], a[28:31], v[112:127]
    s_cmp_eq_u32 s48, 1
    s_cbranch_scc0 L_nocs_a5e0_4
    s_waitcnt vmcnt(0)
    v_add_f32 v10, v10, v11
    v_add_f32 v12, v12, v13
    v_add_f32 v14, v14, v15
    v_add_f32 v16, v16, v17
    v_add_f32 v10, v10, v12
    v_add_f32 v14, v14, v16
    v_add_f32 v10, v10, v14
    v_min_u32 v5, 255, v0
    v_lshlrev_b32 v5, 2, v5
    v_add_u32 v5, 147456, v5
    ds_write_b32 v5, v10
    s_waitcnt lgkmcnt(0)

L_nocs_a5e0_4:
    s_waitcnt lgkmcnt(4)
    v_mfma_f32_32x32x16_bf16 v[128:143], v[84:87], a[28:31], v[128:143]
    s_waitcnt lgkmcnt(2)
    v_mfma_f32_32x32x16_bf16 v[144:159], v[64:67], a[28:31], v[144:159]
    s_waitcnt lgkmcnt(0)
    v_mfma_f32_32x32x16_bf16 v[160:175], v[68:71], a[28:31], v[160:175]
    s_cmp_eq_u32 s48, 1
    s_cbranch_scc1 L_k1_bar0
    s_mov_b32 s40, 4096
    v_lshlrev_b32 v5, 2, v2
    s_mov_b32 s41, 0x01010101

L_k1_poll0:
    global_load_dword v6, v5, s[44:45] sc0 sc1
    s_waitcnt vmcnt(0)
    v_cmp_ne_u32 vcc, s41, v6
    s_nop 3
    s_cmp_eq_u64 vcc, 0
    s_cbranch_scc1 L_k1_ok0
    s_sleep 4
    s_sub_u32 s40, s40, 1
    s_cmp_lg_u32 s40, 0
    s_cbranch_scc1 L_k1_poll0
    v_lshrrev_b32 v9, 4, v2
    v_add_u32 v9, s22, v9
    v_lshlrev_b32 v7, 3, v9
    v_mul_u32_u24 v9, 1280, v9
    v_and_b32 v6, 15, v2
    v_lshl_add_u32 v9, v6, 4, v9
    s_mov_b32 s40, 8

L_k1_fb0:
    global_load_dwordx4 v[64:67], v9, s[38:39] offset:0
    global_load_dwordx4 v[68:71], v9, s[38:39] offset:256
    global_load_dwordx4 v[72:75], v9, s[38:39] offset:512
    global_load_dwordx4 v[76:79], v9, s[38:39] offset:768
    global_load_dwordx4 v[80:83], v9, s[38:39] offset:1024
    s_waitcnt vmcnt(0)
    v_mov_b32 v30, 0
    v_mov_b32 v31, 0
    v_mov_b32 v33, 0
    v_mov_b32 v34, 0
    v_mov_b32 v5, v64
    v_lshlrev_b32 v6, 16, v5
    v_and_b32 v5, 0xffff0000, v5
    v_add_f32 v30, v30, v6
    v_add_f32 v31, v31, v5
    v_mov_b32 v5, v65
    v_lshlrev_b32 v6, 16, v5
    v_and_b32 v5, 0xffff0000, v5
    v_add_f32 v33, v33, v6
    v_add_f32 v34, v34, v5
    v_mov_b32 v5, v66
    v_lshlrev_b32 v6, 16, v5
    v_and_b32 v5, 0xffff0000, v5
    v_add_f32 v30, v30, v6
    v_add_f32 v31, v31, v5
    v_mov_b32 v5, v67
    v_lshlrev_b32 v6, 16, v5
    v_and_b32 v5, 0xffff0000, v5
    v_add_f32 v33, v33, v6
    v_add_f32 v34, v34, v5
    v_mov_b32 v5, v68
    v_lshlrev_b32 v6, 16, v5
    v_and_b32 v5, 0xffff0000, v5
    v_add_f32 v30, v30, v6
    v_add_f32 v31, v31, v5
    v_mov_b32 v5, v69
    v_lshlrev_b32 v6, 16, v5
    v_and_b32 v5, 0xffff0000, v5
    v_add_f32 v33, v33, v6
    v_add_f32 v34, v34, v5
    v_mov_b32 v5, v70
    v_lshlrev_b32 v6, 16, v5
    v_and_b32 v5, 0xffff0000, v5
    v_add_f32 v30, v30, v6
    v_add_f32 v31, v31, v5
    v_mov_b32 v5, v71
    v_lshlrev_b32 v6, 16, v5
    v_and_b32 v5, 0xffff0000, v5
    v_add_f32 v33, v33, v6
    v_add_f32 v34, v34, v5
    v_mov_b32 v5, v72
    v_lshlrev_b32 v6, 16, v5
    v_and_b32 v5, 0xffff0000, v5
    v_add_f32 v30, v30, v6
    v_add_f32 v31, v31, v5
    v_mov_b32 v5, v73
    v_lshlrev_b32 v6, 16, v5
    v_and_b32 v5, 0xffff0000, v5
    v_add_f32 v33, v33, v6
    v_add_f32 v34, v34, v5
    v_mov_b32 v5, v74
    v_lshlrev_b32 v6, 16, v5
    v_and_b32 v5, 0xffff0000, v5
    v_add_f32 v30, v30, v6
    v_add_f32 v31, v31, v5
    v_mov_b32 v5, v75
    v_lshlrev_b32 v6, 16, v5
    v_and_b32 v5, 0xffff0000, v5
    v_add_f32 v33, v33, v6
    v_add_f32 v34, v34, v5
    v_mov_b32 v5, v76
    v_lshlrev_b32 v6, 16, v5
    v_and_b32 v5, 0xffff0000, v5
    v_add_f32 v30, v30, v6
    v_add_f32 v31, v31, v5
    v_mov_b32 v5, v77
    v_lshlrev_b32 v6, 16, v5
    v_and_b32 v5, 0xffff0000, v5
    v_add_f32 v33, v33, v6
    v_add_f32 v34, v34, v5
    v_mov_b32 v5, v78
    v_lshlrev_b32 v6, 16, v5
    v_and_b32 v5, 0xffff0000, v5
    v_add_f32 v30, v30, v6
    v_add_f32 v31, v31, v5
    v_mov_b32 v5, v79
    v_lshlrev_b32 v6, 16, v5
    v_and_b32 v5, 0xffff0000, v5
    v_add_f32 v33, v33, v6
    v_add_f32 v34, v34, v5
    v_mov_b32 v5, v80
    v_lshlrev_b32 v6, 16, v5
    v_and_b32 v5, 0xffff0000, v5
    v_add_f32 v30, v30, v6
    v_add_f32 v31, v31, v5
    v_mov_b32 v5, v81
    v_lshlrev_b32 v6, 16, v5
    v_and_b32 v5, 0xffff0000, v5
    v_add_f32 v33, v33, v6
    v_add_f32 v34, v34, v5
    v_mov_b32 v5, v82
    v_lshlrev_b32 v6, 16, v5
    v_and_b32 v5, 0xffff0000, v5
    v_add_f32 v30, v30, v6
    v_add_f32 v31, v31, v5
    v_mov_b32 v5, v83
    v_lshlrev_b32 v6, 16, v5
    v_and_b32 v5, 0xffff0000, v5
    v_add_f32 v33, v33, v6
    v_add_f32 v34, v34, v5
    v_add_f32 v30, v30, v31
    v_add_f32 v33, v33, v34
    v_add_f32 v30, v30, v33
    s_nop 1
    v_add_f32_dpp v30, v30, v30 row_ror:8 row_mask:0xf bank_mask:0xf
    s_nop 1
    v_add_f32_dpp v30, v30, v30 row_ror:4 row_mask:0xf bank_mask:0xf
    s_nop 1
    v_add_f32_dpp v30, v30, v30 row_ror:2 row_mask:0xf bank_mask:0xf
    s_nop 1
    v_add_f32_dpp v30, v30, v30 row_ror:1 row_mask:0xf bank_mask:0xf
    v_mul_f32 v30, 0x3acccccd, v30
    v_mov_b32 v31, 0
    v_mov_b32 v33, 0
    v_mov_b32 v5, v64
    v_lshlrev_b32 v6, 16, v5
    v_and_b32 v5, 0xffff0000, v5
    v_sub_f32 v6, v6, v30
    v_sub_f32 v5, v5, v30
    v_fmac_f32 v31, v6, v6
    v_fmac_f32 v33, v5, v5
    v_mov_b32 v5, v65
    v_lshlrev_b32 v6, 16, v5
    v_and_b32 v5, 0xffff0000, v5
    v_sub_f32 v6, v6, v30
    v_sub_f32 v5, v5, v30
    v_fmac_f32 v31, v6, v6
    v_fmac_f32 v33, v5, v5
    v_mov_b32 v5, v66
    v_lshlrev_b32 v6, 16, v5
    v_and_b32 v5, 0xffff0000, v5
    v_sub_f32 v6, v6, v30
    v_sub_f32 v5, v5, v30
    v_fmac_f32 v31, v6, v6
    v_fmac_f32 v33, v5, v5
    v_mov_b32 v5, v67
    v_lshlrev_b32 v6, 16, v5
    v_and_b32 v5, 0xffff0000, v5
    v_sub_f32 v6, v6, v30
    v_sub_f32 v5, v5, v30
    v_fmac_f32 v31, v6, v6
    v_fmac_f32 v33, v5, v5
    v_mov_b32 v5, v68
    v_lshlrev_b32 v6, 16, v5
    v_and_b32 v5, 0xffff0000, v5
    v_sub_f32 v6, v6, v30
    v_sub_f32 v5, v5, v30
    v_fmac_f32 v31, v6, v6
    v_fmac_f32 v33, v5, v5
    v_mov_b32 v5, v69
    v_lshlrev_b32 v6, 16, v5
    v_and_b32 v5, 0xffff0000, v5
    v_sub_f32 v6, v6, v30
    v_sub_f32 v5, v5, v30
    v_fmac_f32 v31, v6, v6
    v_fmac_f32 v33, v5, v5
    v_mov_b32 v5, v70
    v_lshlrev_b32 v6, 16, v5
    v_and_b32 v5, 0xffff0000, v5
    v_sub_f32 v6, v6, v30
    v_sub_f32 v5, v5, v30
    v_fmac_f32 v31, v6, v6
    v_fmac_f32 v33, v5, v5
    v_mov_b32 v5, v71
    v_lshlrev_b32 v6, 16, v5
    v_and_b32 v5, 0xffff0000, v5
    v_sub_f32 v6, v6, v30
    v_sub_f32 v5, v5, v30
    v_fmac_f32 v31, v6, v6
    v_fmac_f32 v33, v5, v5
    v_mov_b32 v5, v72
    v_lshlrev_b32 v6, 16, v5
    v_and_b32 v5, 0xffff0000, v5
    v_sub_f32 v6, v6, v30
    v_sub_f32 v5, v5, v30
    v_fmac_f32 v31, v6, v6
    v_fmac_f32 v33, v5, v5
    v_mov_b32 v5, v73
    v_lshlrev_b32 v6, 16, v5
    v_and_b32 v5, 0xffff0000, v5
    v_sub_f32 v6, v6, v30
    v_sub_f32 v5, v5, v30
    v_fmac_f32 v31, v6, v6
    v_fmac_f32 v33, v5, v5
    v_mov_b32 v5, v74
    v_lshlrev_b32 v6, 16, v5
    v_and_b32 v5, 0xffff0000, v5
    v_sub_f32 v6, v6, v30
    v_sub_f32 v5, v5, v30
    v_fmac_f32 v31, v6, v6
    v_fmac_f32 v33, v5, v5
    v_mov_b32 v5, v75
    v_lshlrev_b32 v6, 16, v5
    v_and_b32 v5, 0xffff0000, v5
    v_sub_f32 v6, v6, v30
    v_sub_f32 v5, v5, v30
    v_fmac_f32 v31, v6, v6
    v_fmac_f32 v33, v5, v5
    v_mov_b32 v5, v76
    v_lshlrev_b32 v6, 16, v5
    v_and_b32 v5, 0xffff0000, v5
    v_sub_f32 v6, v6, v30
    v_sub_f32 v5, v5, v30
    v_fmac_f32 v31, v6, v6
    v_fmac_f32 v33, v5, v5
    v_mov_b32 v5, v77
    v_lshlrev_b32 v6, 16, v5
    v_and_b32 v5, 0xffff0000, v5
    v_sub_f32 v6, v6, v30
    v_sub_f32 v5, v5, v30
    v_fmac_f32 v31, v6, v6
    v_fmac_f32 v33, v5, v5
    v_mov_b32 v5, v78
    v_lshlrev_b32 v6, 16, v5
    v_and_b32 v5, 0xffff0000, v5
    v_sub_f32 v6, v6, v30
    v_sub_f32 v5, v5, v30
    v_fmac_f32 v31, v6, v6
    v_fmac_f32 v33, v5, v5
    v_mov_b32 v5, v79
    v_lshlrev_b32 v6, 16, v5
    v_and_b32 v5, 0xffff0000, v5
    v_sub_f32 v6, v6, v30
    v_sub_f32 v5, v5, v30
    v_fmac_f32 v31, v6, v6
    v_fmac_f32 v33, v5, v5
    v_mov_b32 v5, v80
    v_lshlrev_b32 v6, 16, v5
    v_and_b32 v5, 0xffff0000, v5
    v_sub_f32 v6, v6, v30
    v_sub_f32 v5, v5, v30
    v_fmac_f32 v31, v6, v6
    v_fmac_f32 v33, v5, v5
    v_mov_b32 v5, v81
    v_lshlrev_b32 v6, 16, v5
    v_and_b32 v5, 0xffff0000, v5
    v_sub_f32 v6, v6, v30
    v_sub_f32 v5, v5, v30
    v_fmac_f32 v31, v6, v6
    v_fmac_f32 v33, v5, v5
    v_mov_b32 v5, v82
    v_lshlrev_b32 v6, 16, v5
    v_and_b32 v5, 0xffff0000, v5
    v_sub_f32 v6, v6, v30
    v_sub_f32 v5, v5, v30
    v_fmac_f32 v31, v6, v6
    v_fmac_f32 v33, v5, v5
    v_mov_b32 v5, v83
    v_lshlrev_b32 v6, 16, v5
    v_and_b32 v5, 0xffff0000, v5
    v_sub_f32 v6, v6, v30
    v_sub_f32 v5, v5, v30
    v_fmac_f32 v31, v6, v6
    v_fmac_f32 v33, v5, v5
    v_add_f32 v31, v31, v33
    s_nop 1
    v_add_f32_dpp v31, v31, v31 row_ror:8 row_mask:0xf bank_mask:0xf
    s_nop 1
    v_add_f32_dpp v31, v31, v31 row_ror:4 row_mask:0xf bank_mask:0xf
    s_nop 1
    v_add_f32_dpp v31, v31, v31 row_ror:2 row_mask:0xf bank_mask:0xf
    s_nop 1
    v_add_f32_dpp v31, v31, v31 row_ror:1 row_mask:0xf bank_mask:0xf
    v_mul_f32 v31, 0x3acccccd, v31
    v_cvt_pk_bf16_f32 v5, v30, v31
    v_lshlrev_b32 v30, 16, v5
    v_and_b32 v31, 0xffff0000, v5
    v_add_f32 v31, 0x3727c5ac, v31
    v_cvt_pk_bf16_f32 v5, v31, v31
    v_lshlrev_b32 v31, 16, v5
    v_sqrt_f32 v31, v31
    s_nop 0
    v_cvt_pk_bf16_f32 v5, v31, v31
    v_lshlrev_b32 v31, 16, v5
    v_rcp_f32 v31, v31
    s_nop 0
    s_mov_b32 exec_lo, 0x00010001
    s_mov_b32 exec_hi, 0x00010001
    global_store_dwordx2 v7, v[30:31], s[42:43] sc0 sc1
    s_mov_b64 exec, -1
    v_add_u32 v9, 5120, v9
    v_add_u32 v7, 32, v7
    s_sub_u32 s40, s40, 1
    s_cmp_lg_u32 s40, 0
    s_cbranch_scc1 L_k1_fb0
    v_lshrrev_b32 v6, 1, v8
    v_cmp_le_u32 vcc, 160, v6
    v_mov_b32 v11, s56
    v_mov_b32 v12, s57
    v_mov_b32 v13, s58
    v_mov_b32 v14, s59
    v_cndmask_b32 v11, v11, v13, vcc
    v_cndmask_b32 v12, v12, v14, vcc
    v_add_co_u32 v28, vcc, v11, v6
    v_addc_co_u32 v29, vcc, 0, v12, vcc
    v_mov_b32 v10, 0
    s_mov_b32 s40, 640

L_k1_fc0:
    global_load_ushort v11, v[28:29], off
    v_add_co_u32 v28, vcc, s49, v28
    v_addc_co_u32 v29, vcc, 0, v29, vcc
    s_waitcnt vmcnt(0)
    v_lshlrev_b32 v11, 16, v11
    v_add_f32 v10, v10, v11
    s_sub_u32 s40, s40, 1
    s_cmp_lg_u32 s40, 0
    s_cbranch_scc1 L_k1_fc0
    v_lshlrev_b32 v5, 3, v3
    global_load_dwordx2 v[30:31], v5, s[42:43] sc0 sc1
    s_waitcnt vmcnt(0)
    s_branch L_k1_csd0

L_k1_ok0:
    v_lshlrev_b32 v5, 3, v3
    global_load_dwordx2 v[30:31], v5, s[42:43] sc0 sc1

    global_load_dword v10, v8, s[54:55] offset:-2560 sc0 sc1
    global_load_dword v11, v8, s[54:55] offset:-1920 sc0 sc1
    global_load_dword v12, v8, s[54:55] offset:-1280 sc0 sc1
    global_load_dword v13, v8, s[54:55] offset:-640 sc0 sc1
    global_load_dword v14, v8, s[54:55] offset:0 sc0 sc1
    global_load_dword v15, v8, s[54:55] offset:640 sc0 sc1
    global_load_dword v16, v8, s[54:55] offset:1280 sc0 sc1
    global_load_dword v17, v8, s[54:55] offset:1920 sc0 sc1
L_k1_fast0:
    s_waitcnt vmcnt(0)
    v_add_f32 v10, v10, v11
    v_add_f32 v12, v12, v13
    v_add_f32 v14, v14, v15
    v_add_f32 v16, v16, v17
    v_add_f32 v10, v10, v12
    v_add_f32 v14, v14, v16
    v_add_f32 v10, v10, v14

L_k1_csd0:
    v_min_u32 v5, 255, v0
    v_lshlrev_b32 v5, 2, v5
    v_add_u32 v5, 147456, v5
    ds_write_b32 v5, v10
    s_waitcnt lgkmcnt(0)

L_k1_bar0:
    s_barrier
    v_lshlrev_b32 v5, 4, v4
    v_add_u32 v5, 147456, v5

    ds_read_b128 v[40:43], v5 offset:0
    ds_read_b128 v[44:47], v5 offset:32
    ds_read_b128 v[48:51], v5 offset:64
    ds_read_b128 v[52:55], v5 offset:96
    ds_read_b128 v[56:59], v5 offset:128
    ds_read_b128 v[60:63], v5 offset:160
    ds_read_b128 v[64:67], v5 offset:192
    ds_read_b128 v[68:71], v5 offset:224
    ds_read_b128 v[72:75], v5 offset:256
    ds_read_b128 v[76:79], v5 offset:288
    ds_read_b128 v[80:83], v5 offset:320
    ds_read_b128 v[84:87], v5 offset:352
    ds_read_b128 v[88:91], v5 offset:384
    ds_read_b128 v[92:95], v5 offset:416
    ds_read_b128 v[12:15], v5 offset:448
    ds_read_b128 v[16:19], v5 offset:480
    ds_read_b128 v[20:23], v5 offset:512
    ds_read_b128 v[24:27], v5 offset:544
    ds_read_b128 v[32:35], v5 offset:576
    ds_read_b128 v[36:39], v5 offset:608
    s_waitcnt lgkmcnt(0)
    s_mov_b32 s28, 4194304
    s_mov_b32 s29, 8388608
    s_cmp_ge_u32 s13, 4
    s_cselect_b32 s28, s29, s28
    s_and_b32 s29, s13, 3
    s_mul_i32 s29, s29, 786432
    s_add_u32 s28, s28, s29
    v_lshrrev_b32 v5, 4, v3
    v_mul_u32_u24 v5, 768, v5
    v_and_b32 v6, 15, v3
    v_lshl_add_u32 v5, v6, 4, v5
    v_lshl_add_u32 v6, v4, 8, v5
    v_mul_u32_u24 v7, 98304, v4
    v_add_u32 v7, v7, v5

    v_pk_fma_f32 v[96:97], v[30:31], v[40:41], v[96:97] op_sel:[0,0,0] op_sel_hi:[0,1,1] neg_lo:[1,0,0] neg_hi:[1,0,0]
    v_pk_mul_f32 v[96:97], v[96:97], v[30:31] op_sel:[0,1] op_sel_hi:[1,1]
    v_pk_fma_f32 v[98:99], v[30:31], v[42:43], v[98:99] op_sel:[0,0,0] op_sel_hi:[0,1,1] neg_lo:[1,0,0] neg_hi:[1,0,0]
    v_pk_mul_f32 v[98:99], v[98:99], v[30:31] op_sel:[0,1] op_sel_hi:[1,1]
    v_pk_fma_f32 v[100:101], v[30:31], v[44:45], v[100:101] op_sel:[0,0,0] op_sel_hi:[0,1,1] neg_lo:[1,0,0] neg_hi:[1,0,0]
    v_pk_mul_f32 v[100:101], v[100:101], v[30:31] op_sel:[0,1] op_sel_hi:[1,1]
    v_pk_fma_f32 v[102:103], v[30:31], v[46:47], v[102:103] op_sel:[0,0,0] op_sel_hi:[0,1,1] neg_lo:[1,0,0] neg_hi:[1,0,0]
    v_pk_mul_f32 v[102:103], v[102:103], v[30:31] op_sel:[0,1] op_sel_hi:[1,1]
    v_pk_fma_f32 v[104:105], v[30:31], v[48:49], v[104:105] op_sel:[0,0,0] op_sel_hi:[0,1,1] neg_lo:[1,0,0] neg_hi:[1,0,0]
    v_pk_mul_f32 v[104:105], v[104:105], v[30:31] op_sel:[0,1] op_sel_hi:[1,1]
    v_pk_fma_f32 v[106:107], v[30:31], v[50:51], v[106:107] op_sel:[0,0,0] op_sel_hi:[0,1,1] neg_lo:[1,0,0] neg_hi:[1,0,0]
    v_pk_mul_f32 v[106:107], v[106:107], v[30:31] op_sel:[0,1] op_sel_hi:[1,1]
    v_pk_fma_f32 v[108:109], v[30:31], v[52:53], v[108:109] op_sel:[0,0,0] op_sel_hi:[0,1,1] neg_lo:[1,0,0] neg_hi:[1,0,0]
    v_pk_mul_f32 v[108:109], v[108:109], v[30:31] op_sel:[0,1] op_sel_hi:[1,1]
    v_pk_fma_f32 v[110:111], v[30:31], v[54:55], v[110:111] op_sel:[0,0,0] op_sel_hi:[0,1,1] neg_lo:[1,0,0] neg_hi:[1,0,0]
    v_pk_mul_f32 v[110:111], v[110:111], v[30:31] op_sel:[0,1] op_sel_hi:[1,1]
    v_cvt_pk_bf16_f32 v96, v96, v97
    v_cvt_pk_bf16_f32 v97, v98, v99
    v_cvt_pk_bf16_f32 v98, v100, v101
    v_cvt_pk_bf16_f32 v99, v102, v103
    s_add_u32 s29, s28, 0
    s_nop 0
    v_permlane32_swap_b32 v96, v98
    v_permlane32_swap_b32 v97, v99
    buffer_store_dwordx4 v[96:99], v6, s[8:11], s29 offen sc1
    v_cvt_pk_bf16_f32 v104, v104, v105
    v_cvt_pk_bf16_f32 v105, v106, v107
    v_cvt_pk_bf16_f32 v106, v108, v109
    v_cvt_pk_bf16_f32 v107, v110, v111
    s_add_u32 s29, s28, 98304
    s_nop 0
    v_permlane32_swap_b32 v104, v106
    v_permlane32_swap_b32 v105, v107
    buffer_store_dwordx4 v[104:107], v6, s[8:11], s29 offen sc1
    v_pk_fma_f32 v[112:113], v[30:31], v[56:57], v[112:113] op_sel:[0,0,0] op_sel_hi:[0,1,1] neg_lo:[1,0,0] neg_hi:[1,0,0]
    v_pk_mul_f32 v[112:113], v[112:113], v[30:31] op_sel:[0,1] op_sel_hi:[1,1]
    v_pk_fma_f32 v[114:115], v[30:31], v[58:59], v[114:115] op_sel:[0,0,0] op_sel_hi:[0,1,1] neg_lo:[1,0,0] neg_hi:[1,0,0]
    v_pk_mul_f32 v[114:115], v[114:115], v[30:31] op_sel:[0,1] op_sel_hi:[1,1]
    v_pk_fma_f32 v[116:117], v[30:31], v[60:61], v[116:117] op_sel:[0,0,0] op_sel_hi:[0,1,1] neg_lo:[1,0,0] neg_hi:[1,0,0]
    v_pk_mul_f32 v[116:117], v[116:117], v[30:31] op_sel:[0,1] op_sel_hi:[1,1]
    v_pk_fma_f32 v[118:119], v[30:31], v[62:63], v[118:119] op_sel:[0,0,0] op_sel_hi:[0,1,1] neg_lo:[1,0,0] neg_hi:[1,0,0]
    v_pk_mul_f32 v[118:119], v[118:119], v[30:31] op_sel:[0,1] op_sel_hi:[1,1]
    v_pk_fma_f32 v[120:121], v[30:31], v[64:65], v[120:121] op_sel:[0,0,0] op_sel_hi:[0,1,1] neg_lo:[1,0,0] neg_hi:[1,0,0]
    v_pk_mul_f32 v[120:121], v[120:121], v[30:31] op_sel:[0,1] op_sel_hi:[1,1]
    v_pk_fma_f32 v[122:123], v[30:31], v[66:67], v[122:123] op_sel:[0,0,0] op_sel_hi:[0,1,1] neg_lo:[1,0,0] neg_hi:[1,0,0]
    v_pk_mul_f32 v[122:123], v[122:123], v[30:31] op_sel:[0,1] op_sel_hi:[1,1]
    v_pk_fma_f32 v[124:125], v[30:31], v[68:69], v[124:125] op_sel:[0,0,0] op_sel_hi:[0,1,1] neg_lo:[1,0,0] neg_hi:[1,0,0]
    v_pk_mul_f32 v[124:125], v[124:125], v[30:31] op_sel:[0,1] op_sel_hi:[1,1]
    v_pk_fma_f32 v[126:127], v[30:31], v[70:71], v[126:127] op_sel:[0,0,0] op_sel_hi:[0,1,1] neg_lo:[1,0,0] neg_hi:[1,0,0]
    v_pk_mul_f32 v[126:127], v[126:127], v[30:31] op_sel:[0,1] op_sel_hi:[1,1]
    v_cvt_pk_bf16_f32 v112, v112, v113
    v_cvt_pk_bf16_f32 v113, v114, v115
    v_cvt_pk_bf16_f32 v114, v116, v117
    v_cvt_pk_bf16_f32 v115, v118, v119
    s_add_u32 s29, s28, 196608
    s_nop 0
    v_permlane32_swap_b32 v112, v114
    v_permlane32_swap_b32 v113, v115
    buffer_store_dwordx4 v[112:115], v6, s[8:11], s29 offen sc1
    v_cvt_pk_bf16_f32 v120, v120, v121
    v_cvt_pk_bf16_f32 v121, v122, v123
    v_cvt_pk_bf16_f32 v122, v124, v125
    v_cvt_pk_bf16_f32 v123, v126, v127
    s_add_u32 s29, s28, 294912
    s_nop 0
    v_permlane32_swap_b32 v120, v122
    v_permlane32_swap_b32 v121, v123
    buffer_store_dwordx4 v[120:123], v6, s[8:11], s29 offen sc1
    v_pk_fma_f32 v[128:129], v[30:31], v[72:73], v[128:129] op_sel:[0,0,0] op_sel_hi:[0,1,1] neg_lo:[1,0,0] neg_hi:[1,0,0]
    v_pk_mul_f32 v[128:129], v[128:129], v[30:31] op_sel:[0,1] op_sel_hi:[1,1]
    v_pk_fma_f32 v[130:131], v[30:31], v[74:75], v[130:131] op_sel:[0,0,0] op_sel_hi:[0,1,1] neg_lo:[1,0,0] neg_hi:[1,0,0]
    v_pk_mul_f32 v[130:131], v[130:131], v[30:31] op_sel:[0,1] op_sel_hi:[1,1]
    v_pk_fma_f32 v[132:133], v[30:31], v[76:77], v[132:133] op_sel:[0,0,0] op_sel_hi:[0,1,1] neg_lo:[1,0,0] neg_hi:[1,0,0]
    v_pk_mul_f32 v[132:133], v[132:133], v[30:31] op_sel:[0,1] op_sel_hi:[1,1]
    v_pk_fma_f32 v[134:135], v[30:31], v[78:79], v[134:135] op_sel:[0,0,0] op_sel_hi:[0,1,1] neg_lo:[1,0,0] neg_hi:[1,0,0]
    v_pk_mul_f32 v[134:135], v[134:135], v[30:31] op_sel:[0,1] op_sel_hi:[1,1]
    v_pk_fma_f32 v[136:137], v[30:31], v[80:81], v[136:137] op_sel:[0,0,0] op_sel_hi:[0,1,1] neg_lo:[1,0,0] neg_hi:[1,0,0]
    v_pk_mul_f32 v[136:137], v[136:137], v[30:31] op_sel:[0,1] op_sel_hi:[1,1]
    v_pk_fma_f32 v[138:139], v[30:31], v[82:83], v[138:139] op_sel:[0,0,0] op_sel_hi:[0,1,1] neg_lo:[1,0,0] neg_hi:[1,0,0]
    v_pk_mul_f32 v[138:139], v[138:139], v[30:31] op_sel:[0,1] op_sel_hi:[1,1]
    v_pk_fma_f32 v[140:141], v[30:31], v[84:85], v[140:141] op_sel:[0,0,0] op_sel_hi:[0,1,1] neg_lo:[1,0,0] neg_hi:[1,0,0]
    v_pk_mul_f32 v[140:141], v[140:141], v[30:31] op_sel:[0,1] op_sel_hi:[1,1]
    v_pk_fma_f32 v[142:143], v[30:31], v[86:87], v[142:143] op_sel:[0,0,0] op_sel_hi:[0,1,1] neg_lo:[1,0,0] neg_hi:[1,0,0]
    v_pk_mul_f32 v[142:143], v[142:143], v[30:31] op_sel:[0,1] op_sel_hi:[1,1]
    v_cvt_pk_bf16_f32 v128, v128, v129
    v_cvt_pk_bf16_f32 v129, v130, v131
    v_cvt_pk_bf16_f32 v130, v132, v133
    v_cvt_pk_bf16_f32 v131, v134, v135
    s_add_u32 s29, s28, 393216
    s_nop 0
    v_permlane32_swap_b32 v128, v130
    v_permlane32_swap_b32 v129, v131
    buffer_store_dwordx4 v[128:131], v6, s[8:11], s29 offen sc1
    v_cvt_pk_bf16_f32 v136, v136, v137
    v_cvt_pk_bf16_f32 v137, v138, v139
    v_cvt_pk_bf16_f32 v138, v140, v141
    v_cvt_pk_bf16_f32 v139, v142, v143
    s_add_u32 s29, s28, 491520
    s_nop 0
    v_permlane32_swap_b32 v136, v138
    v_permlane32_swap_b32 v137, v139
    buffer_store_dwordx4 v[136:139], v6, s[8:11], s29 offen sc1
    v_pk_fma_f32 v[144:145], v[30:31], v[88:89], v[144:145] op_sel:[0,0,0] op_sel_hi:[0,1,1] neg_lo:[1,0,0] neg_hi:[1,0,0]
    v_pk_mul_f32 v[144:145], v[144:145], v[30:31] op_sel:[0,1] op_sel_hi:[1,1]
    v_pk_fma_f32 v[146:147], v[30:31], v[90:91], v[146:147] op_sel:[0,0,0] op_sel_hi:[0,1,1] neg_lo:[1,0,0] neg_hi:[1,0,0]
    v_pk_mul_f32 v[146:147], v[146:147], v[30:31] op_sel:[0,1] op_sel_hi:[1,1]
    v_pk_fma_f32 v[148:149], v[30:31], v[92:93], v[148:149] op_sel:[0,0,0] op_sel_hi:[0,1,1] neg_lo:[1,0,0] neg_hi:[1,0,0]
    v_pk_mul_f32 v[148:149], v[148:149], v[30:31] op_sel:[0,1] op_sel_hi:[1,1]
    v_pk_fma_f32 v[150:151], v[30:31], v[94:95], v[150:151] op_sel:[0,0,0] op_sel_hi:[0,1,1] neg_lo:[1,0,0] neg_hi:[1,0,0]
    v_pk_mul_f32 v[150:151], v[150:151], v[30:31] op_sel:[0,1] op_sel_hi:[1,1]
    v_pk_fma_f32 v[152:153], v[30:31], v[12:13], v[152:153] op_sel:[0,0,0] op_sel_hi:[0,1,1] neg_lo:[1,0,0] neg_hi:[1,0,0]
    v_pk_mul_f32 v[152:153], v[152:153], v[30:31] op_sel:[0,1] op_sel_hi:[1,1]
    v_pk_fma_f32 v[154:155], v[30:31], v[14:15], v[154:155] op_sel:[0,0,0] op_sel_hi:[0,1,1] neg_lo:[1,0,0] neg_hi:[1,0,0]
    v_pk_mul_f32 v[154:155], v[154:155], v[30:31] op_sel:[0,1] op_sel_hi:[1,1]
    v_pk_fma_f32 v[156:157], v[30:31], v[16:17], v[156:157] op_sel:[0,0,0] op_sel_hi:[0,1,1] neg_lo:[1,0,0] neg_hi:[1,0,0]
    v_pk_mul_f32 v[156:157], v[156:157], v[30:31] op_sel:[0,1] op_sel_hi:[1,1]
    v_pk_fma_f32 v[158:159], v[30:31], v[18:19], v[158:159] op_sel:[0,0,0] op_sel_hi:[0,1,1] neg_lo:[1,0,0] neg_hi:[1,0,0]
    v_pk_mul_f32 v[158:159], v[158:159], v[30:31] op_sel:[0,1] op_sel_hi:[1,1]
    v_cvt_pk_bf16_f32 v144, v144, v145
    v_cvt_pk_bf16_f32 v145, v146, v147
    v_cvt_pk_bf16_f32 v146, v148, v149
    v_cvt_pk_bf16_f32 v147, v150, v151
    s_add_u32 s29, s28, 589824
    s_nop 0
    v_permlane32_swap_b32 v144, v146
    v_permlane32_swap_b32 v145, v147
    buffer_store_dwordx4 v[144:147], v6, s[8:11], s29 offen sc1
    v_cvt_pk_bf16_f32 v152, v152, v153
    v_cvt_pk_bf16_f32 v153, v154, v155
    v_cvt_pk_bf16_f32 v154, v156, v157
    v_cvt_pk_bf16_f32 v155, v158, v159
    s_add_u32 s29, s28, 688128
    s_nop 0
    v_permlane32_swap_b32 v152, v154
    v_permlane32_swap_b32 v153, v155
    buffer_store_dwordx4 v[152:155], v6, s[8:11], s29 offen sc1
    v_pk_fma_f32 v[160:161], v[30:31], v[20:21], v[160:161] op_sel:[0,0,0] op_sel_hi:[0,1,1] neg_lo:[1,0,0] neg_hi:[1,0,0]
    v_pk_mul_f32 v[160:161], v[160:161], v[30:31] op_sel:[0,1] op_sel_hi:[1,1]
    v_pk_fma_f32 v[162:163], v[30:31], v[22:23], v[162:163] op_sel:[0,0,0] op_sel_hi:[0,1,1] neg_lo:[1,0,0] neg_hi:[1,0,0]
    v_pk_mul_f32 v[162:163], v[162:163], v[30:31] op_sel:[0,1] op_sel_hi:[1,1]
    v_pk_fma_f32 v[164:165], v[30:31], v[24:25], v[164:165] op_sel:[0,0,0] op_sel_hi:[0,1,1] neg_lo:[1,0,0] neg_hi:[1,0,0]
    v_pk_mul_f32 v[164:165], v[164:165], v[30:31] op_sel:[0,1] op_sel_hi:[1,1]
    v_pk_fma_f32 v[166:167], v[30:31], v[26:27], v[166:167] op_sel:[0,0,0] op_sel_hi:[0,1,1] neg_lo:[1,0,0] neg_hi:[1,0,0]
    v_pk_mul_f32 v[166:167], v[166:167], v[30:31] op_sel:[0,1] op_sel_hi:[1,1]
    v_pk_fma_f32 v[168:169], v[30:31], v[32:33], v[168:169] op_sel:[0,0,0] op_sel_hi:[0,1,1] neg_lo:[1,0,0] neg_hi:[1,0,0]
    v_pk_mul_f32 v[168:169], v[168:169], v[30:31] op_sel:[0,1] op_sel_hi:[1,1]
    v_pk_fma_f32 v[170:171], v[30:31], v[34:35], v[170:171] op_sel:[0,0,0] op_sel_hi:[0,1,1] neg_lo:[1,0,0] neg_hi:[1,0,0]
    v_pk_mul_f32 v[170:171], v[170:171], v[30:31] op_sel:[0,1] op_sel_hi:[1,1]
    v_pk_fma_f32 v[172:173], v[30:31], v[36:37], v[172:173] op_sel:[0,0,0] op_sel_hi:[0,1,1] neg_lo:[1,0,0] neg_hi:[1,0,0]
    v_pk_mul_f32 v[172:173], v[172:173], v[30:31] op_sel:[0,1] op_sel_hi:[1,1]
    v_pk_fma_f32 v[174:175], v[30:31], v[38:39], v[174:175] op_sel:[0,0,0] op_sel_hi:[0,1,1] neg_lo:[1,0,0] neg_hi:[1,0,0]
    v_pk_mul_f32 v[174:175], v[174:175], v[30:31] op_sel:[0,1] op_sel_hi:[1,1]
    v_cvt_pk_bf16_f32 v160, v160, v161
    v_cvt_pk_bf16_f32 v161, v162, v163
    v_mov_b32 v162, 0
    v_mov_b32 v163, 0
    s_add_u32 s29, s28, 0
    buffer_store_dwordx4 v[160:163], v7, s[8:11], s29 offen offset:512 sc1
    v_cvt_pk_bf16_f32 v164, v164, v165
    v_cvt_pk_bf16_f32 v165, v166, v167
    v_mov_b32 v166, 0
    v_mov_b32 v167, 0
    s_add_u32 s29, s28, 196608
    buffer_store_dwordx4 v[164:167], v7, s[8:11], s29 offen offset:512 sc1
    v_cvt_pk_bf16_f32 v168, v168, v169
    v_cvt_pk_bf16_f32 v169, v170, v171
    v_mov_b32 v170, 0
    v_mov_b32 v171, 0
    s_add_u32 s29, s28, 393216
    buffer_store_dwordx4 v[168:171], v7, s[8:11], s29 offen offset:512 sc1
    v_cvt_pk_bf16_f32 v172, v172, v173
    v_cvt_pk_bf16_f32 v173, v174, v175
    v_mov_b32 v174, 0
    v_mov_b32 v175, 0
    s_add_u32 s29, s28, 589824
    buffer_store_dwordx4 v[172:175], v7, s[8:11], s29 offen offset:512 sc1
    s_branch L_k1_end
L_k1_main_n:
    s_waitcnt vmcnt(25)
    s_barrier
    s_waitcnt vmcnt(21)
    ds_read_b128 a[0:3], v50 offset:0
    ds_read_b128 a[4:7], v51 offset:0
    ds_read_b128 a[8:11], v52 offset:0
    ds_read_b128 a[12:15], v53 offset:0
    ds_read_b64_tr_b16 v[64:65], v54 offset:0
    ds_read_b64_tr_b16 v[66:67], v54 offset:1280
    ds_read_b64_tr_b16 v[68:69], v54 offset:32
    ds_read_b64_tr_b16 v[70:71], v54 offset:1312
    ds_read_b64_tr_b16 v[72:73], v54 offset:64
    ds_read_b64_tr_b16 v[74:75], v54 offset:1344
    ds_read_b64_tr_b16 v[76:77], v54 offset:96
    ds_read_b64_tr_b16 v[78:79], v54 offset:1376
    s_waitcnt lgkmcnt(8)
    ds_read_b64_tr_b16 v[80:81], v54 offset:128
    ds_read_b64_tr_b16 v[82:83], v54 offset:1408
    s_waitcnt lgkmcnt(8)
    v_mfma_f32_32x32x16_bf16 v[96:111], v[64:67], a[0:3], 0
    s_add_u32 m0, s21, 20480
    s_nop 0
    global_load_lds_dwordx4 v[40:41], off
    v_add_co_u32 v40, vcc, s20, v40
    v_addc_co_u32 v41, vcc, 0, v41, vcc
    ds_read_b64_tr_b16 v[84:85], v55 offset:0
    ds_read_b64_tr_b16 v[86:87], v55 offset:1280
    s_waitcnt lgkmcnt(8)
    v_mfma_f32_32x32x16_bf16 v[112:127], v[68:71], a[0:3], 0
    s_add_u32 m0, s21, 21504
    s_nop 0
    global_load_lds_dwordx4 v[42:43], off
    v_add_co_u32 v42, vcc, s20, v42
    v_addc_co_u32 v43, vcc, 0, v43, vcc
    ds_read_b64_tr_b16 v[64:65], v55 offset:32
    ds_read_b64_tr_b16 v[66:67], v55 offset:1312
    s_waitcnt lgkmcnt(8)
    v_mfma_f32_32x32x16_bf16 v[128:143], v[72:75], a[0:3], 0
    s_add_u32 m0, s21, 22528
    s_mov_b32 exec_hi, 0
    global_load_lds_dwordx4 v[44:45], off
    s_mov_b32 exec_hi, -1
    v_add_co_u32 v44, vcc, s20, v44
    v_addc_co_u32 v45, vcc, 0, v45, vcc
    ds_read_b64_tr_b16 v[68:69], v55 offset:64
    ds_read_b64_tr_b16 v[70:71], v55 offset:1344
    s_waitcnt lgkmcnt(8)
    v_mfma_f32_32x32x16_bf16 v[144:159], v[76:79], a[0:3], 0
    s_add_u32 m0, s34, 4096
    s_nop 0
    global_load_lds_dwordx4 v46, s[4:5]
    ds_read_b64_tr_b16 v[72:73], v55 offset:96
    ds_read_b64_tr_b16 v[74:75], v55 offset:1376
    s_waitcnt lgkmcnt(8)
    v_mfma_f32_32x32x16_bf16 v[160:175], v[80:83], a[0:3], 0
    s_add_u32 m0, s34, 5120
    s_nop 0
    global_load_lds_dwordx4 v47, s[4:5]
    ds_read_b64_tr_b16 v[76:77], v55 offset:128
    ds_read_b64_tr_b16 v[78:79], v55 offset:1408
    s_waitcnt lgkmcnt(8)
    v_mfma_f32_32x32x16_bf16 v[96:111], v[84:87], a[4:7], v[96:111]
    s_add_u32 m0, s34, 6144
    s_nop 0
    global_load_lds_dwordx4 v48, s[4:5]
    ds_read_b64_tr_b16 v[80:81], v56 offset:0
    ds_read_b64_tr_b16 v[82:83], v56 offset:1280
    s_waitcnt lgkmcnt(8)
    v_mfma_f32_32x32x16_bf16 v[112:127], v[64:67], a[4:7], v[112:127]
    s_add_u32 m0, s34, 7168
    s_nop 0
    global_load_lds_dwordx4 v49, s[4:5]
    s_add_u32 s4, s4, 128
    s_addc_u32 s5, s5, 0
    ds_read_b64_tr_b16 v[84:85], v56 offset:32
    ds_read_b64_tr_b16 v[86:87], v56 offset:1312
    s_waitcnt lgkmcnt(8)
    v_mfma_f32_32x32x16_bf16 v[128:143], v[68:71], a[4:7], v[128:143]
    s_add_u32 m0, s21, 40960
    s_nop 0
    global_load_lds_dwordx4 v[40:41], off
    v_add_co_u32 v40, vcc, s20, v40
    v_addc_co_u32 v41, vcc, 0, v41, vcc
    ds_read_b64_tr_b16 v[64:65], v56 offset:64
    ds_read_b64_tr_b16 v[66:67], v56 offset:1344
    s_waitcnt lgkmcnt(8)
    v_mfma_f32_32x32x16_bf16 v[144:159], v[72:75], a[4:7], v[144:159]
    s_add_u32 m0, s21, 41984
    s_nop 0
    global_load_lds_dwordx4 v[42:43], off
    v_add_co_u32 v42, vcc, s20, v42
    v_addc_co_u32 v43, vcc, 0, v43, vcc
    ds_read_b64_tr_b16 v[68:69], v56 offset:96
    ds_read_b64_tr_b16 v[70:71], v56 offset:1376
    s_waitcnt lgkmcnt(8)
    v_mfma_f32_32x32x16_bf16 v[160:175], v[76:79], a[4:7], v[160:175]
    s_add_u32 m0, s21, 43008
    s_mov_b32 exec_hi, 0
    global_load_lds_dwordx4 v[44:45], off
    s_mov_b32 exec_hi, -1
    v_add_co_u32 v44, vcc, s20, v44
    v_addc_co_u32 v45, vcc, 0, v45, vcc
    ds_read_b64_tr_b16 v[72:73], v56 offset:128
    ds_read_b64_tr_b16 v[74:75], v56 offset:1408
    s_waitcnt lgkmcnt(8)
    v_mfma_f32_32x32x16_bf16 v[96:111], v[80:83], a[8:11], v[96:111]
    s_add_u32 m0, s34, 0
    s_nop 0
    global_load_lds_dwordx4 v46, s[4:5]
    ds_read_b64_tr_b16 v[76:77], v57 offset:0
    ds_read_b64_tr_b16 v[78:79], v57 offset:1280
    s_waitcnt lgkmcnt(8)
    v_mfma_f32_32x32x16_bf16 v[112:127], v[84:87], a[8:11], v[112:127]
    s_add_u32 m0, s34, 1024
    s_nop 0
    global_load_lds_dwordx4 v47, s[4:5]
    ds_read_b64_tr_b16 v[80:81], v57 offset:32
    ds_read_b64_tr_b16 v[82:83], v57 offset:1312
    s_waitcnt lgkmcnt(8)
    v_mfma_f32_32x32x16_bf16 v[128:143], v[64:67], a[8:11], v[128:143]
    s_add_u32 m0, s34, 2048
    s_nop 0
    global_load_lds_dwordx4 v48, s[4:5]
    ds_read_b64_tr_b16 v[84:85], v57 offset:64
    ds_read_b64_tr_b16 v[86:87], v57 offset:1344
    s_waitcnt lgkmcnt(8)
    v_mfma_f32_32x32x16_bf16 v[144:159], v[68:71], a[8:11], v[144:159]
    s_add_u32 m0, s34, 3072
    s_nop 0
    global_load_lds_dwordx4 v49, s[4:5]
    s_add_u32 s4, s4, 128
    s_addc_u32 s5, s5, 0
    ds_read_b64_tr_b16 v[64:65], v57 offset:96
    ds_read_b64_tr_b16 v[66:67], v57 offset:1376
    s_waitcnt vmcnt(7)
    s_barrier
    s_waitcnt lgkmcnt(8)
    v_mfma_f32_32x32x16_bf16 v[160:175], v[72:75], a[8:11], v[160:175]
    ds_read_b64_tr_b16 v[68:69], v57 offset:128
    ds_read_b64_tr_b16 v[70:71], v57 offset:1408
    s_waitcnt lgkmcnt(8)
    v_mfma_f32_32x32x16_bf16 v[96:111], v[76:79], a[12:15], v[96:111]
    ds_read_b128 a[16:19], v50 offset:4096
    s_add_u32 m0, s21, 61440
    s_nop 0
    global_load_lds_dwordx4 v[40:41], off
    v_add_co_u32 v40, vcc, s20, v40
    v_addc_co_u32 v41, vcc, 0, v41, vcc
    ds_read_b64_tr_b16 v[72:73], v54 offset:20480
    ds_read_b64_tr_b16 v[74:75], v54 offset:21760
    s_waitcnt lgkmcnt(9)
    v_mfma_f32_32x32x16_bf16 v[112:127], v[80:83], a[12:15], v[112:127]
    ds_read_b128 a[20:23], v51 offset:4096
    ds_read_b64_tr_b16 v[76:77], v54 offset:20512
    ds_read_b64_tr_b16 v[78:79], v54 offset:21792
    s_waitcnt lgkmcnt(10)
    v_mfma_f32_32x32x16_bf16 v[128:143], v[84:87], a[12:15], v[128:143]
    ds_read_b128 a[24:27], v52 offset:4096
    s_add_u32 m0, s21, 62464
    s_nop 0
    global_load_lds_dwordx4 v[42:43], off
    v_add_co_u32 v42, vcc, s20, v42
    v_addc_co_u32 v43, vcc, 0, v43, vcc
    ds_read_b64_tr_b16 v[80:81], v54 offset:20544
    ds_read_b64_tr_b16 v[82:83], v54 offset:21824
    s_waitcnt lgkmcnt(11)
    v_mfma_f32_32x32x16_bf16 v[144:159], v[64:67], a[12:15], v[144:159]
    ds_read_b128 a[28:31], v53 offset:4096
    ds_read_b64_tr_b16 v[84:85], v54 offset:20576
    ds_read_b64_tr_b16 v[86:87], v54 offset:21856
    s_waitcnt lgkmcnt(12)
    v_mfma_f32_32x32x16_bf16 v[160:175], v[68:71], a[12:15], v[160:175]
    s_add_u32 m0, s21, 63488
    s_mov_b32 exec_hi, 0
    global_load_lds_dwordx4 v[44:45], off
    s_mov_b32 exec_hi, -1
    v_add_co_u32 v44, vcc, s20, v44
    v_addc_co_u32 v45, vcc, 0, v45, vcc
    ds_read_b64_tr_b16 v[64:65], v54 offset:20608
    ds_read_b64_tr_b16 v[66:67], v54 offset:21888
    s_waitcnt lgkmcnt(4)
    v_mfma_f32_32x32x16_bf16 v[96:111], v[72:75], a[16:19], v[96:111]
    s_add_u32 m0, s34, 4096
    s_nop 0
    global_load_lds_dwordx4 v46, s[4:5]
    ds_read_b64_tr_b16 v[68:69], v55 offset:20480
    ds_read_b64_tr_b16 v[70:71], v55 offset:21760
    v_mfma_f32_32x32x16_bf16 v[112:127], v[76:79], a[16:19], v[112:127]
    s_add_u32 m0, s34, 5120
    s_nop 0
    global_load_lds_dwordx4 v47, s[4:5]
    ds_read_b64_tr_b16 v[72:73], v55 offset:20512
    ds_read_b64_tr_b16 v[74:75], v55 offset:21792
    v_mfma_f32_32x32x16_bf16 v[128:143], v[80:83], a[16:19], v[128:143]
    s_add_u32 m0, s34, 6144
    s_nop 0
    global_load_lds_dwordx4 v48, s[4:5]
    ds_read_b64_tr_b16 v[76:77], v55 offset:20544
    ds_read_b64_tr_b16 v[78:79], v55 offset:21824
    s_waitcnt lgkmcnt(8)
    v_mfma_f32_32x32x16_bf16 v[144:159], v[84:87], a[16:19], v[144:159]
    s_add_u32 m0, s34, 7168
    s_nop 0
    global_load_lds_dwordx4 v49, s[4:5]
    s_add_u32 s4, s4, 128
    s_addc_u32 s5, s5, 0
    ds_read_b64_tr_b16 v[80:81], v55 offset:20576
    ds_read_b64_tr_b16 v[82:83], v55 offset:21856
    s_waitcnt vmcnt(7)
    s_barrier
    s_waitcnt lgkmcnt(8)
    v_mfma_f32_32x32x16_bf16 v[160:175], v[64:67], a[16:19], v[160:175]
    ds_read_b64_tr_b16 v[84:85], v55 offset:20608
    ds_read_b64_tr_b16 v[86:87], v55 offset:21888
    s_waitcnt lgkmcnt(8)
    v_mfma_f32_32x32x16_bf16 v[96:111], v[68:71], a[20:23], v[96:111]
    ds_read_b128 a[0:3], v50 offset:0
    v_mov_b32 v30, 0
    v_mov_b32 v31, 0
    v_accvgpr_read_b32 v5, a32
    v_lshlrev_b32 v6, 16, v5
    v_and_b32 v5, 0xffff0000, v5
    ds_read_b64_tr_b16 v[64:65], v56 offset:20480
    ds_read_b64_tr_b16 v[66:67], v56 offset:21760
    s_waitcnt lgkmcnt(9)
    v_mfma_f32_32x32x16_bf16 v[112:127], v[72:75], a[20:23], v[112:127]
    ds_read_b128 a[4:7], v51 offset:0
    s_add_u32 m0, s21, 0
    s_nop 0
    global_load_lds_dwordx4 v[40:41], off
    v_add_co_u32 v40, vcc, s20, v40
    v_addc_co_u32 v41, vcc, 0, v41, vcc
    v_add_f32 v30, v30, v6
    v_add_f32 v31, v31, v5
    v_accvgpr_read_b32 v5, a33
    v_lshlrev_b32 v6, 16, v5
    v_and_b32 v5, 0xffff0000, v5
    ds_read_b64_tr_b16 v[68:69], v56 offset:20512
    ds_read_b64_tr_b16 v[70:71], v56 offset:21792
    s_waitcnt lgkmcnt(10)
    v_mfma_f32_32x32x16_bf16 v[128:143], v[76:79], a[20:23], v[128:143]
    ds_read_b128 a[8:11], v52 offset:0
    v_add_f32 v30, v30, v6
    v_add_f32 v31, v31, v5
    v_accvgpr_read_b32 v5, a34
    v_lshlrev_b32 v6, 16, v5
    v_and_b32 v5, 0xffff0000, v5
    ds_read_b64_tr_b16 v[72:73], v56 offset:20544
    ds_read_b64_tr_b16 v[74:75], v56 offset:21824
    s_waitcnt lgkmcnt(11)
    v_mfma_f32_32x32x16_bf16 v[144:159], v[80:83], a[20:23], v[144:159]
    ds_read_b128 a[12:15], v53 offset:0
    v_add_f32 v30, v30, v6
    v_add_f32 v31, v31, v5
    v_accvgpr_read_b32 v5, a35
    v_lshlrev_b32 v6, 16, v5
    v_and_b32 v5, 0xffff0000, v5
    ds_read_b64_tr_b16 v[76:77], v56 offset:20576
    ds_read_b64_tr_b16 v[78:79], v56 offset:21856
    s_waitcnt lgkmcnt(12)
    v_mfma_f32_32x32x16_bf16 v[160:175], v[84:87], a[20:23], v[160:175]
    s_add_u32 m0, s21, 1024
    s_nop 0
    global_load_lds_dwordx4 v[42:43], off
    v_add_co_u32 v42, vcc, s20, v42
    v_addc_co_u32 v43, vcc, 0, v43, vcc
    v_add_f32 v30, v30, v6
    v_add_f32 v31, v31, v5
    v_accvgpr_read_b32 v5, a36
    v_lshlrev_b32 v6, 16, v5
    v_and_b32 v5, 0xffff0000, v5
    ds_read_b64_tr_b16 v[80:81], v56 offset:20608
    ds_read_b64_tr_b16 v[82:83], v56 offset:21888
    s_waitcnt lgkmcnt(11)
    v_mfma_f32_32x32x16_bf16 v[96:111], v[64:67], a[24:27], v[96:111]
    v_add_f32 v30, v30, v6
    v_add_f32 v31, v31, v5
    v_add_f32 v30, v30, v31
    s_nop 1
    v_add_f32_dpp v30, v30, v30 row_ror:8 row_mask:0xf bank_mask:0xf
    ds_read_b64_tr_b16 v[84:85], v57 offset:20480
    ds_read_b64_tr_b16 v[86:87], v57 offset:21760
    s_waitcnt lgkmcnt(10)
    v_mfma_f32_32x32x16_bf16 v[112:127], v[68:71], a[24:27], v[112:127]
    s_nop 1
    v_add_f32_dpp v30, v30, v30 row_ror:4 row_mask:0xf bank_mask:0xf
    s_nop 1
    v_add_f32_dpp v30, v30, v30 row_ror:2 row_mask:0xf bank_mask:0xf
    s_nop 1
    ds_read_b64_tr_b16 v[64:65], v57 offset:20512
    ds_read_b64_tr_b16 v[66:67], v57 offset:21792
    s_waitcnt lgkmcnt(8)
    v_mfma_f32_32x32x16_bf16 v[128:143], v[72:75], a[24:27], v[128:143]
    s_add_u32 m0, s21, 2048
    s_mov_b32 exec_hi, 0
    global_load_lds_dwordx4 v[44:45], off
    s_mov_b32 exec_hi, -1
    v_add_co_u32 v44, vcc, s20, v44
    v_addc_co_u32 v45, vcc, 0, v45, vcc
    v_add_f32_dpp v30, v30, v30 row_ror:1 row_mask:0xf bank_mask:0xf
    v_mov_b32 v5, v30
    s_nop 1
    v_permlane32_swap_b32 v5, v30
    s_nop 1
    ds_read_b64_tr_b16 v[68:69], v57 offset:20544
    ds_read_b64_tr_b16 v[70:71], v57 offset:21824
    s_waitcnt lgkmcnt(8)
    v_mfma_f32_32x32x16_bf16 v[144:159], v[76:79], a[24:27], v[144:159]
    s_add_u32 m0, s34, 0
    s_nop 0
    global_load_lds_dwordx4 v46, s[4:5]
    v_add_f32 v30, v30, v5
    v_mov_b32 v5, v30
    s_nop 1
    v_permlane16_swap_b32 v5, v30
    s_nop 1
    ds_read_b64_tr_b16 v[72:73], v57 offset:20576
    ds_read_b64_tr_b16 v[74:75], v57 offset:21856
    s_waitcnt lgkmcnt(8)
    v_mfma_f32_32x32x16_bf16 v[160:175], v[80:83], a[24:27], v[160:175]
    v_add_f32 v30, v30, v5
    v_mul_f32 v30, 0x3acccccd, v30
    v_mov_b32 v31, 0
    v_mov_b32 v33, 0
    v_accvgpr_read_b32 v5, a32
    ds_read_b64_tr_b16 v[76:77], v57 offset:20608
    ds_read_b64_tr_b16 v[78:79], v57 offset:21888
    s_waitcnt lgkmcnt(8)
    v_mfma_f32_32x32x16_bf16 v[96:111], v[84:87], a[28:31], v[96:111]
    s_add_u32 m0, s34, 1024
    s_nop 0
    global_load_lds_dwordx4 v47, s[4:5]
    v_lshlrev_b32 v6, 16, v5
    v_and_b32 v5, 0xffff0000, v5
    v_sub_f32 v6, v6, v30
    v_sub_f32 v5, v5, v30
    v_fmac_f32 v31, v6, v6
    ds_read_b64_tr_b16 v[80:81], v58 offset:0
    ds_read_b64_tr_b16 v[82:83], v58 offset:1280
    s_waitcnt lgkmcnt(8)
    v_mfma_f32_32x32x16_bf16 v[112:127], v[64:67], a[28:31], v[112:127]
    v_fmac_f32 v33, v5, v5
    v_accvgpr_read_b32 v5, a33
    v_lshlrev_b32 v6, 16, v5
    v_and_b32 v5, 0xffff0000, v5
    v_sub_f32 v6, v6, v30
    ds_read_b64_tr_b16 v[84:85], v58 offset:32
    ds_read_b64_tr_b16 v[86:87], v58 offset:1312
    s_waitcnt lgkmcnt(8)
    v_mfma_f32_32x32x16_bf16 v[128:143], v[68:71], a[28:31], v[128:143]
    s_add_u32 m0, s34, 2048
    s_nop 0
    global_load_lds_dwordx4 v48, s[4:5]
    v_sub_f32 v5, v5, v30
    v_fmac_f32 v31, v6, v6
    v_fmac_f32 v33, v5, v5
    v_accvgpr_read_b32 v5, a34
    v_lshlrev_b32 v6, 16, v5
    ds_read_b64_tr_b16 v[64:65], v58 offset:64
    ds_read_b64_tr_b16 v[66:67], v58 offset:1344
    s_waitcnt lgkmcnt(8)
    v_mfma_f32_32x32x16_bf16 v[144:159], v[72:75], a[28:31], v[144:159]
    v_and_b32 v5, 0xffff0000, v5
    v_sub_f32 v6, v6, v30
    v_sub_f32 v5, v5, v30
    v_fmac_f32 v31, v6, v6
    v_fmac_f32 v33, v5, v5
    ds_read_b64_tr_b16 v[68:69], v58 offset:96
    ds_read_b64_tr_b16 v[70:71], v58 offset:1376
    s_waitcnt lgkmcnt(8)
    v_mfma_f32_32x32x16_bf16 v[160:175], v[76:79], a[28:31], v[160:175]
    s_add_u32 m0, s34, 3072
    s_nop 0
    global_load_lds_dwordx4 v49, s[4:5]
    s_add_u32 s4, s4, 128
    s_addc_u32 s5, s5, 0
    v_accvgpr_read_b32 v5, a35
    v_lshlrev_b32 v6, 16, v5
    v_and_b32 v5, 0xffff0000, v5
    v_sub_f32 v6, v6, v30
    v_sub_f32 v5, v5, v30
    ds_read_b64_tr_b16 v[72:73], v58 offset:128
    ds_read_b64_tr_b16 v[74:75], v58 offset:1408
    s_waitcnt lgkmcnt(8)
    v_mfma_f32_32x32x16_bf16 v[96:111], v[80:83], a[0:3], v[96:111]
    v_fmac_f32 v31, v6, v6
    v_fmac_f32 v33, v5, v5
    v_accvgpr_read_b32 v5, a36
    v_lshlrev_b32 v6, 16, v5
    v_and_b32 v5, 0xffff0000, v5
    ds_read_b64_tr_b16 v[76:77], v59 offset:0
    ds_read_b64_tr_b16 v[78:79], v59 offset:1280
    s_waitcnt lgkmcnt(8)
    v_mfma_f32_32x32x16_bf16 v[112:127], v[84:87], a[0:3], v[112:127]
    v_sub_f32 v6, v6, v30
    v_sub_f32 v5, v5, v30
    v_fmac_f32 v31, v6, v6
    v_fmac_f32 v33, v5, v5
    v_add_f32 v31, v31, v33
    ds_read_b64_tr_b16 v[80:81], v59 offset:32
    ds_read_b64_tr_b16 v[82:83], v59 offset:1312
    s_waitcnt lgkmcnt(8)
    v_mfma_f32_32x32x16_bf16 v[128:143], v[64:67], a[0:3], v[128:143]
    s_nop 1
    v_add_f32_dpp v31, v31, v31 row_ror:8 row_mask:0xf bank_mask:0xf
    s_nop 1
    v_add_f32_dpp v31, v31, v31 row_ror:4 row_mask:0xf bank_mask:0xf
    s_nop 1
    ds_read_b64_tr_b16 v[84:85], v59 offset:64
    ds_read_b64_tr_b16 v[86:87], v59 offset:1344
    s_waitcnt lgkmcnt(8)
    v_mfma_f32_32x32x16_bf16 v[144:159], v[68:71], a[0:3], v[144:159]
    v_add_f32_dpp v31, v31, v31 row_ror:2 row_mask:0xf bank_mask:0xf
    s_nop 1
    v_add_f32_dpp v31, v31, v31 row_ror:1 row_mask:0xf bank_mask:0xf
    v_mov_b32 v5, v31
    s_nop 1
    ds_read_b64_tr_b16 v[64:65], v59 offset:96
    ds_read_b64_tr_b16 v[66:67], v59 offset:1376
    s_waitcnt vmcnt(7)
    s_barrier
    s_waitcnt lgkmcnt(8)
    v_mfma_f32_32x32x16_bf16 v[160:175], v[72:75], a[0:3], v[160:175]
    v_permlane32_swap_b32 v5, v31
    s_nop 1
    v_add_f32 v31, v31, v5
    v_mov_b32 v5, v31
    s_nop 1
    ds_read_b64_tr_b16 v[68:69], v59 offset:128
    ds_read_b64_tr_b16 v[70:71], v59 offset:1408
    s_waitcnt lgkmcnt(8)
    v_mfma_f32_32x32x16_bf16 v[96:111], v[76:79], a[4:7], v[96:111]
    ds_read_b128 a[16:19], v50 offset:4096
    v_permlane16_swap_b32 v5, v31
    s_nop 1
    v_add_f32 v31, v31, v5
    v_mul_f32 v31, 0x3acccccd, v31
    v_cvt_pk_bf16_f32 v5, v30, v31
    ds_read_b64_tr_b16 v[72:73], v60 offset:0
    ds_read_b64_tr_b16 v[74:75], v60 offset:1280
    s_waitcnt lgkmcnt(9)
    v_mfma_f32_32x32x16_bf16 v[112:127], v[80:83], a[4:7], v[112:127]
    ds_read_b128 a[20:23], v51 offset:4096
    s_add_u32 m0, s21, 20480
    s_nop 0
    global_load_lds_dwordx4 v[40:41], off
    v_add_co_u32 v40, vcc, s20, v40
    v_addc_co_u32 v41, vcc, 0, v41, vcc
    v_lshlrev_b32 v30, 16, v5
    v_and_b32 v31, 0xffff0000, v5
    v_add_f32 v31, 0x3727c5ac, v31
    v_cvt_pk_bf16_f32 v5, v31, v31
    v_lshlrev_b32 v31, 16, v5
    ds_read_b64_tr_b16 v[76:77], v60 offset:32
    ds_read_b64_tr_b16 v[78:79], v60 offset:1312
    s_waitcnt lgkmcnt(10)
    v_mfma_f32_32x32x16_bf16 v[128:143], v[84:87], a[4:7], v[128:143]
    ds_read_b128 a[24:27], v52 offset:4096
    v_sqrt_f32 v31, v31
    s_nop 0
    v_cvt_pk_bf16_f32 v5, v31, v31
    v_lshlrev_b32 v31, 16, v5
    v_rcp_f32 v31, v31
    ds_read_b64_tr_b16 v[80:81], v60 offset:64
    ds_read_b64_tr_b16 v[82:83], v60 offset:1344
    s_waitcnt lgkmcnt(11)
    v_mfma_f32_32x32x16_bf16 v[144:159], v[64:67], a[4:7], v[144:159]
    ds_read_b128 a[28:31], v53 offset:4096
    s_nop 0
    v_lshlrev_b32 v26, 16, v10
    v_and_b32 v27, 0xffff0000, v10
    v_lshlrev_b32 v36, 16, v11
    v_and_b32 v37, 0xffff0000, v11
    v_add_f32 v26, v26, v36
    v_add_f32 v27, v27, v37
    ds_read_b64_tr_b16 v[84:85], v60 offset:96
    ds_read_b64_tr_b16 v[86:87], v60 offset:1376
    s_waitcnt lgkmcnt(12)
    v_mfma_f32_32x32x16_bf16 v[160:175], v[68:71], a[4:7], v[160:175]
    s_add_u32 m0, s21, 21504
    s_nop 0
    global_load_lds_dwordx4 v[42:43], off
    v_add_co_u32 v42, vcc, s20, v42
    v_addc_co_u32 v43, vcc, 0, v43, vcc
    v_lshlrev_b32 v36, 16, v12
    v_and_b32 v37, 0xffff0000, v12
    v_add_f32 v26, v26, v36
    v_add_f32 v27, v27, v37
    v_lshlrev_b32 v36, 16, v13
    v_and_b32 v37, 0xffff0000, v13
    ds_read_b64_tr_b16 v[64:65], v60 offset:128
    ds_read_b64_tr_b16 v[66:67], v60 offset:1408
    s_waitcnt lgkmcnt(11)
    v_mfma_f32_32x32x16_bf16 v[96:111], v[72:75], a[8:11], v[96:111]
    v_add_f32 v26, v26, v36
    v_add_f32 v27, v27, v37
    v_lshlrev_b32 v36, 16, v14
    v_and_b32 v37, 0xffff0000, v14
    v_add_f32 v26, v26, v36
    v_add_f32 v27, v27, v37
    ds_read_b64_tr_b16 v[68:69], v61 offset:0
    ds_read_b64_tr_b16 v[70:71], v61 offset:1280
    s_waitcnt lgkmcnt(10)
    v_mfma_f32_32x32x16_bf16 v[112:127], v[76:79], a[8:11], v[112:127]
    v_lshlrev_b32 v36, 16, v15
    v_and_b32 v37, 0xffff0000, v15
    v_add_f32 v26, v26, v36
    v_add_f32 v27, v27, v37
    v_lshlrev_b32 v36, 16, v16
    v_and_b32 v37, 0xffff0000, v16
    ds_read_b64_tr_b16 v[72:73], v61 offset:32
    ds_read_b64_tr_b16 v[74:75], v61 offset:1312
    s_waitcnt lgkmcnt(8)
    v_mfma_f32_32x32x16_bf16 v[128:143], v[80:83], a[8:11], v[128:143]
    s_add_u32 m0, s21, 22528
    s_mov_b32 exec_hi, 0
    global_load_lds_dwordx4 v[44:45], off
    s_mov_b32 exec_hi, -1
    v_add_co_u32 v44, vcc, s20, v44
    v_addc_co_u32 v45, vcc, 0, v45, vcc
    v_add_f32 v26, v26, v36
    v_add_f32 v27, v27, v37
    v_lshlrev_b32 v36, 16, v17
    v_and_b32 v37, 0xffff0000, v17
    v_add_f32 v26, v26, v36
    v_add_f32 v27, v27, v37
    ds_read_b64_tr_b16 v[76:77], v61 offset:64
    ds_read_b64_tr_b16 v[78:79], v61 offset:1344
    s_waitcnt lgkmcnt(8)
    v_mfma_f32_32x32x16_bf16 v[144:159], v[84:87], a[8:11], v[144:159]
    s_add_u32 m0, s34, 4096
    s_nop 0
    global_load_lds_dwordx4 v46, s[4:5]
    v_lshlrev_b32 v36, 16, v18
    v_and_b32 v37, 0xffff0000, v18
    v_add_f32 v26, v26, v36
    v_add_f32 v27, v27, v37
    v_lshlrev_b32 v36, 16, v19
    v_and_b32 v37, 0xffff0000, v19
    ds_read_b64_tr_b16 v[80:81], v61 offset:96
    ds_read_b64_tr_b16 v[82:83], v61 offset:1376
    s_waitcnt lgkmcnt(8)
    v_mfma_f32_32x32x16_bf16 v[160:175], v[64:67], a[8:11], v[160:175]
    v_add_f32 v26, v26, v36
    v_add_f32 v27, v27, v37
    v_lshlrev_b32 v36, 16, v20
    v_and_b32 v37, 0xffff0000, v20
    v_add_f32 v26, v26, v36
    v_add_f32 v27, v27, v37
    ds_read_b64_tr_b16 v[84:85], v61 offset:128
    ds_read_b64_tr_b16 v[86:87], v61 offset:1408
    s_waitcnt lgkmcnt(8)
    v_mfma_f32_32x32x16_bf16 v[96:111], v[68:71], a[12:15], v[96:111]
    s_add_u32 m0, s34, 5120
    s_nop 0
    global_load_lds_dwordx4 v47, s[4:5]
    v_lshlrev_b32 v36, 16, v21
    v_and_b32 v37, 0xffff0000, v21
    v_add_f32 v26, v26, v36
    v_add_f32 v27, v27, v37
    v_lshlrev_b32 v36, 16, v22
    v_and_b32 v37, 0xffff0000, v22
    ds_read_b64_tr_b16 v[64:65], v58 offset:20480
    ds_read_b64_tr_b16 v[66:67], v58 offset:21760
    s_waitcnt lgkmcnt(8)
    v_mfma_f32_32x32x16_bf16 v[112:127], v[72:75], a[12:15], v[112:127]
    v_add_f32 v26, v26, v36
    v_add_f32 v27, v27, v37
    v_lshlrev_b32 v36, 16, v23
    v_and_b32 v37, 0xffff0000, v23
    v_add_f32 v26, v26, v36
    v_add_f32 v27, v27, v37
    ds_read_b64_tr_b16 v[68:69], v58 offset:20512
    ds_read_b64_tr_b16 v[70:71], v58 offset:21792
    s_waitcnt lgkmcnt(8)
    v_mfma_f32_32x32x16_bf16 v[128:143], v[76:79], a[12:15], v[128:143]
    s_add_u32 m0, s34, 6144
    s_nop 0
    global_load_lds_dwordx4 v48, s[4:5]
    v_lshlrev_b32 v36, 16, v24
    v_and_b32 v37, 0xffff0000, v24
    v_add_f32 v26, v26, v36
    v_add_f32 v27, v27, v37
    v_lshlrev_b32 v36, 16, v25
    v_and_b32 v37, 0xffff0000, v25
    ds_read_b64_tr_b16 v[72:73], v58 offset:20544
    ds_read_b64_tr_b16 v[74:75], v58 offset:21824
    s_waitcnt lgkmcnt(8)
    v_mfma_f32_32x32x16_bf16 v[144:159], v[80:83], a[12:15], v[144:159]
    v_add_f32 v26, v26, v36
    v_add_f32 v27, v27, v37
    ds_read_b64_tr_b16 v[76:77], v58 offset:20576
    ds_read_b64_tr_b16 v[78:79], v58 offset:21856
    s_waitcnt lgkmcnt(8)
    v_mfma_f32_32x32x16_bf16 v[160:175], v[84:87], a[12:15], v[160:175]
    s_add_u32 m0, s34, 7168
    s_nop 0
    global_load_lds_dwordx4 v49, s[4:5]
    s_add_u32 s4, s4, 128
    s_addc_u32 s5, s5, 0
    ds_read_b64_tr_b16 v[80:81], v58 offset:20608
    ds_read_b64_tr_b16 v[82:83], v58 offset:21888
    ds_write_b64 v35, v[26:27]
    s_waitcnt lgkmcnt(9)
    v_mfma_f32_32x32x16_bf16 v[96:111], v[64:67], a[16:19], v[96:111]
    ds_read_b64_tr_b16 v[84:85], v59 offset:20480
    ds_read_b64_tr_b16 v[86:87], v59 offset:21760
    s_waitcnt lgkmcnt(9)
    v_mfma_f32_32x32x16_bf16 v[112:127], v[68:71], a[16:19], v[112:127]
    ds_read_b64_tr_b16 v[64:65], v59 offset:20512
    ds_read_b64_tr_b16 v[66:67], v59 offset:21792
    s_waitcnt lgkmcnt(9)
    v_mfma_f32_32x32x16_bf16 v[128:143], v[72:75], a[16:19], v[128:143]
    ds_read_b64_tr_b16 v[68:69], v59 offset:20544
    ds_read_b64_tr_b16 v[70:71], v59 offset:21824
    s_waitcnt lgkmcnt(9)
    v_mfma_f32_32x32x16_bf16 v[144:159], v[76:79], a[16:19], v[144:159]
    ds_read_b64_tr_b16 v[72:73], v59 offset:20576
    ds_read_b64_tr_b16 v[74:75], v59 offset:21856
    s_waitcnt vmcnt(7)
    s_waitcnt lgkmcnt(8)
    s_barrier
    v_mfma_f32_32x32x16_bf16 v[160:175], v[80:83], a[16:19], v[160:175]
    ds_read_b64_tr_b16 v[76:77], v59 offset:20608
    ds_read_b64_tr_b16 v[78:79], v59 offset:21888
    s_waitcnt lgkmcnt(8)
    v_mfma_f32_32x32x16_bf16 v[96:111], v[84:87], a[20:23], v[96:111]
    ds_read_b128 a[0:3], v50 offset:0
    ds_read_b64_tr_b16 v[80:81], v60 offset:20480
    ds_read_b64_tr_b16 v[82:83], v60 offset:21760
    v_and_b32 v38, 127, v0
    v_lshlrev_b32 v38, 3, v38
    v_add_u32 v39, 148480, v38
    ds_read_b64 v[10:11], v39 offset:0
    ds_read_b64 v[12:13], v39 offset:640
    ds_read_b64 v[14:15], v39 offset:1280
    ds_read_b64 v[16:17], v39 offset:1920
    ds_read_b64 v[18:19], v39 offset:2560
    s_waitcnt lgkmcnt(14)
    v_mfma_f32_32x32x16_bf16 v[112:127], v[64:67], a[20:23], v[112:127]
    ds_read_b128 a[4:7], v51 offset:0
    s_add_u32 m0, s21, 40960
    s_nop 0
    global_load_lds_dwordx4 v[40:41], off
    v_add_co_u32 v40, vcc, s20, v40
    v_addc_co_u32 v41, vcc, 0, v41, vcc
    ds_read_b64_tr_b16 v[84:85], v60 offset:20512
    ds_read_b64_tr_b16 v[86:87], v60 offset:21792
    s_waitcnt lgkmcnt(15)
    v_mfma_f32_32x32x16_bf16 v[128:143], v[68:71], a[20:23], v[128:143]
    ds_read_b128 a[8:11], v52 offset:0
    ds_read_b64_tr_b16 v[64:65], v60 offset:20544
    ds_read_b64_tr_b16 v[66:67], v60 offset:21824
    s_waitcnt lgkmcnt(15)
    v_mfma_f32_32x32x16_bf16 v[144:159], v[72:75], a[20:23], v[144:159]
    ds_read_b128 a[12:15], v53 offset:0
    ds_read_b64_tr_b16 v[68:69], v60 offset:20576
    ds_read_b64_tr_b16 v[70:71], v60 offset:21856
    s_waitcnt lgkmcnt(15)
    v_mfma_f32_32x32x16_bf16 v[160:175], v[76:79], a[20:23], v[160:175]
    s_add_u32 m0, s21, 41984
    s_nop 0
    global_load_lds_dwordx4 v[42:43], off
    v_add_co_u32 v42, vcc, s20, v42
    v_addc_co_u32 v43, vcc, 0, v43, vcc
    ds_read_b64_tr_b16 v[72:73], v60 offset:20608
    ds_read_b64_tr_b16 v[74:75], v60 offset:21888
    s_waitcnt lgkmcnt(11)
    v_add_f32 v10, v10, v12
    v_add_f32 v11, v11, v13
    v_add_f32 v10, v10, v14
    v_add_f32 v11, v11, v15
    v_add_f32 v10, v10, v16
    v_add_f32 v11, v11, v17
    v_add_f32 v10, v10, v18
    v_add_f32 v11, v11, v19
    v_cmp_gt_u32 vcc, 80, v0
    s_nop 1
    s_and_saveexec_b64 s[50:51], vcc
    s_cbranch_execz L_nocp_a5e0_5
    global_store_dwordx2 v38, v[10:11], s[52:53] sc0 sc1
L_nocp_a5e0_5:
    s_mov_b64 exec, -1
    v_mfma_f32_32x32x16_bf16 v[96:111], v[80:83], a[24:27], v[96:111]
    ds_read_b64_tr_b16 v[76:77], v61 offset:20480
    ds_read_b64_tr_b16 v[78:79], v61 offset:21760
    s_waitcnt lgkmcnt(10)
    v_mfma_f32_32x32x16_bf16 v[112:127], v[84:87], a[24:27], v[112:127]
    ds_read_b64_tr_b16 v[80:81], v61 offset:20512
    ds_read_b64_tr_b16 v[82:83], v61 offset:21792
    s_waitcnt lgkmcnt(8)
    s_mov_b64 exec, 1
    global_store_dwordx2 v7, v[30:31], s[42:43] sc0 sc1
    s_mov_b64 exec, -1
    v_mfma_f32_32x32x16_bf16 v[128:143], v[64:67], a[24:27], v[128:143]
    s_add_u32 m0, s21, 43008
    s_mov_b32 exec_hi, 0
    global_load_lds_dwordx4 v[44:45], off
    s_mov_b32 exec_hi, -1
    v_add_co_u32 v44, vcc, s20, v44
    v_addc_co_u32 v45, vcc, 0, v45, vcc
    ds_read_b64_tr_b16 v[84:85], v61 offset:20544
    ds_read_b64_tr_b16 v[86:87], v61 offset:21824
    s_waitcnt lgkmcnt(8)
    v_mfma_f32_32x32x16_bf16 v[144:159], v[68:71], a[24:27], v[144:159]
    s_add_u32 m0, s34, 0
    s_nop 0
    global_load_lds_dwordx4 v46, s[4:5]
    ds_read_b64_tr_b16 v[64:65], v61 offset:20576
    ds_read_b64_tr_b16 v[66:67], v61 offset:21856
    s_waitcnt lgkmcnt(8)
    v_mfma_f32_32x32x16_bf16 v[160:175], v[72:75], a[24:27], v[160:175]
    ds_read_b64_tr_b16 v[68:69], v61 offset:20608
    ds_read_b64_tr_b16 v[70:71], v61 offset:21888
    s_waitcnt lgkmcnt(8)
    v_mfma_f32_32x32x16_bf16 v[96:111], v[76:79], a[28:31], v[96:111]
    s_add_u32 m0, s34, 1024
    s_nop 0
    global_load_lds_dwordx4 v47, s[4:5]
    ds_read_b64_tr_b16 v[72:73], v54 offset:0
    ds_read_b64_tr_b16 v[74:75], v54 offset:1280
    s_waitcnt lgkmcnt(8)
    v_mfma_f32_32x32x16_bf16 v[112:127], v[80:83], a[28:31], v[112:127]
    ds_read_b64_tr_b16 v[76:77], v54 offset:32
    ds_read_b64_tr_b16 v[78:79], v54 offset:1312
    s_waitcnt lgkmcnt(8)
    v_mfma_f32_32x32x16_bf16 v[128:143], v[84:87], a[28:31], v[128:143]
    s_add_u32 m0, s34, 2048
    s_nop 0
    global_load_lds_dwordx4 v48, s[4:5]
    ds_read_b64_tr_b16 v[80:81], v54 offset:64
    ds_read_b64_tr_b16 v[82:83], v54 offset:1344
    s_waitcnt lgkmcnt(8)
    v_mfma_f32_32x32x16_bf16 v[144:159], v[64:67], a[28:31], v[144:159]
    ds_read_b64_tr_b16 v[84:85], v54 offset:96
    ds_read_b64_tr_b16 v[86:87], v54 offset:1376
    s_waitcnt lgkmcnt(8)
    v_mfma_f32_32x32x16_bf16 v[160:175], v[68:71], a[28:31], v[160:175]
    s_add_u32 m0, s34, 3072
    s_nop 0
    global_load_lds_dwordx4 v49, s[4:5]
    s_add_u32 s4, s4, 128
    s_addc_u32 s5, s5, 0
    ds_read_b64_tr_b16 v[64:65], v54 offset:128
    ds_read_b64_tr_b16 v[66:67], v54 offset:1408
    s_waitcnt lgkmcnt(8)
    v_mfma_f32_32x32x16_bf16 v[96:111], v[72:75], a[0:3], v[96:111]
    ds_read_b64_tr_b16 v[68:69], v55 offset:0
    ds_read_b64_tr_b16 v[70:71], v55 offset:1280
    s_waitcnt lgkmcnt(8)
    v_mfma_f32_32x32x16_bf16 v[112:127], v[76:79], a[0:3], v[112:127]
    ds_read_b64_tr_b16 v[72:73], v55 offset:32
    ds_read_b64_tr_b16 v[74:75], v55 offset:1312
    s_waitcnt lgkmcnt(8)
    v_mfma_f32_32x32x16_bf16 v[128:143], v[80:83], a[0:3], v[128:143]
    ds_read_b64_tr_b16 v[76:77], v55 offset:64
    ds_read_b64_tr_b16 v[78:79], v55 offset:1344
    s_waitcnt lgkmcnt(8)
    v_mfma_f32_32x32x16_bf16 v[144:159], v[84:87], a[0:3], v[144:159]
    ds_read_b64_tr_b16 v[80:81], v55 offset:96
    ds_read_b64_tr_b16 v[82:83], v55 offset:1376
    s_waitcnt vmcnt(8)
    s_waitcnt vmcnt(5)
    s_barrier
    s_cmp_lg_u32 s14, 0
    s_cbranch_scc1 L_flag_a5e0_6
    v_mov_b32 v38, s13
    v_mov_b32 v39, 1
    s_mov_b64 exec, 1
    global_store_byte v38, v39, s[36:37] sc0 sc1
    s_mov_b64 exec, -1

L_flag_a5e0_6:
    s_waitcnt lgkmcnt(8)
    v_mfma_f32_32x32x16_bf16 v[160:175], v[64:67], a[0:3], v[160:175]
    ds_read_b64_tr_b16 v[84:85], v55 offset:128
    ds_read_b64_tr_b16 v[86:87], v55 offset:1408
    s_waitcnt lgkmcnt(8)
    v_mfma_f32_32x32x16_bf16 v[96:111], v[68:71], a[4:7], v[96:111]
    ds_read_b128 a[16:19], v50 offset:4096
    ds_read_b64_tr_b16 v[64:65], v56 offset:0
    ds_read_b64_tr_b16 v[66:67], v56 offset:1280
    s_waitcnt lgkmcnt(9)
    v_mfma_f32_32x32x16_bf16 v[112:127], v[72:75], a[4:7], v[112:127]
    ds_read_b128 a[20:23], v51 offset:4096
    s_add_u32 m0, s21, 61440
    s_nop 0
    global_load_lds_dwordx4 v[40:41], off
    v_add_co_u32 v40, vcc, s20, v40
    v_addc_co_u32 v41, vcc, 0, v41, vcc
    ds_read_b64_tr_b16 v[68:69], v56 offset:32
    ds_read_b64_tr_b16 v[70:71], v56 offset:1312
    s_waitcnt lgkmcnt(10)
    v_mfma_f32_32x32x16_bf16 v[128:143], v[76:79], a[4:7], v[128:143]
    ds_read_b128 a[24:27], v52 offset:4096
    ds_read_b64_tr_b16 v[72:73], v56 offset:64
    ds_read_b64_tr_b16 v[74:75], v56 offset:1344
    s_waitcnt lgkmcnt(11)
    v_mfma_f32_32x32x16_bf16 v[144:159], v[80:83], a[4:7], v[144:159]
    ds_read_b128 a[28:31], v53 offset:4096
    ds_read_b64_tr_b16 v[76:77], v56 offset:96
    ds_read_b64_tr_b16 v[78:79], v56 offset:1376
    s_waitcnt lgkmcnt(12)
    v_mfma_f32_32x32x16_bf16 v[160:175], v[84:87], a[4:7], v[160:175]
    s_add_u32 m0, s21, 62464
    s_nop 0
    global_load_lds_dwordx4 v[42:43], off
    v_add_co_u32 v42, vcc, s20, v42
    v_addc_co_u32 v43, vcc, 0, v43, vcc
    ds_read_b64_tr_b16 v[80:81], v56 offset:128
    ds_read_b64_tr_b16 v[82:83], v56 offset:1408
    s_waitcnt lgkmcnt(11)
    v_mfma_f32_32x32x16_bf16 v[96:111], v[64:67], a[8:11], v[96:111]
    ds_read_b64_tr_b16 v[84:85], v57 offset:0
    ds_read_b64_tr_b16 v[86:87], v57 offset:1280
    s_waitcnt lgkmcnt(10)
    v_mfma_f32_32x32x16_bf16 v[112:127], v[68:71], a[8:11], v[112:127]
    ds_read_b64_tr_b16 v[64:65], v57 offset:32
    ds_read_b64_tr_b16 v[66:67], v57 offset:1312
    s_waitcnt lgkmcnt(8)
    v_mfma_f32_32x32x16_bf16 v[128:143], v[72:75], a[8:11], v[128:143]
    s_add_u32 m0, s21, 63488
    s_mov_b32 exec_hi, 0
    global_load_lds_dwordx4 v[44:45], off
    s_mov_b32 exec_hi, -1
    v_add_co_u32 v44, vcc, s20, v44
    v_addc_co_u32 v45, vcc, 0, v45, vcc
    ds_read_b64_tr_b16 v[68:69], v57 offset:64
    ds_read_b64_tr_b16 v[70:71], v57 offset:1344
    s_waitcnt lgkmcnt(8)
    v_mfma_f32_32x32x16_bf16 v[144:159], v[76:79], a[8:11], v[144:159]
    s_add_u32 m0, s34, 4096
    s_nop 0
    global_load_lds_dwordx4 v46, s[4:5]
    ds_read_b64_tr_b16 v[72:73], v57 offset:96
    ds_read_b64_tr_b16 v[74:75], v57 offset:1376
    s_waitcnt lgkmcnt(8)
    v_mfma_f32_32x32x16_bf16 v[160:175], v[80:83], a[8:11], v[160:175]
    ds_read_b64_tr_b16 v[76:77], v57 offset:128
    ds_read_b64_tr_b16 v[78:79], v57 offset:1408
    s_waitcnt lgkmcnt(8)
    v_mfma_f32_32x32x16_bf16 v[96:111], v[84:87], a[12:15], v[96:111]
    s_add_u32 m0, s34, 5120
    s_nop 0
    global_load_lds_dwordx4 v47, s[4:5]
    ds_read_b64_tr_b16 v[80:81], v54 offset:20480
    ds_read_b64_tr_b16 v[82:83], v54 offset:21760
    s_waitcnt lgkmcnt(8)
    v_mfma_f32_32x32x16_bf16 v[112:127], v[64:67], a[12:15], v[112:127]
    ds_read_b64_tr_b16 v[84:85], v54 offset:20512
    ds_read_b64_tr_b16 v[86:87], v54 offset:21792
    s_waitcnt lgkmcnt(8)
    v_mfma_f32_32x32x16_bf16 v[128:143], v[68:71], a[12:15], v[128:143]
    s_add_u32 m0, s34, 6144
    s_nop 0
    global_load_lds_dwordx4 v48, s[4:5]
    ds_read_b64_tr_b16 v[64:65], v54 offset:20544
    ds_read_b64_tr_b16 v[66:67], v54 offset:21824
    s_waitcnt lgkmcnt(8)
    v_mfma_f32_32x32x16_bf16 v[144:159], v[72:75], a[12:15], v[144:159]
    ds_read_b64_tr_b16 v[68:69], v54 offset:20576
    ds_read_b64_tr_b16 v[70:71], v54 offset:21856
    s_waitcnt lgkmcnt(8)
    v_mfma_f32_32x32x16_bf16 v[160:175], v[76:79], a[12:15], v[160:175]
    s_add_u32 m0, s34, 7168
    s_nop 0
    global_load_lds_dwordx4 v49, s[4:5]
    s_add_u32 s4, s4, 128
    s_addc_u32 s5, s5, 0
    ds_read_b64_tr_b16 v[72:73], v54 offset:20608
    ds_read_b64_tr_b16 v[74:75], v54 offset:21888
    s_waitcnt lgkmcnt(8)
    v_mfma_f32_32x32x16_bf16 v[96:111], v[80:83], a[16:19], v[96:111]
    ds_read_b64_tr_b16 v[76:77], v55 offset:20480
    ds_read_b64_tr_b16 v[78:79], v55 offset:21760
    s_waitcnt lgkmcnt(8)
    v_mfma_f32_32x32x16_bf16 v[112:127], v[84:87], a[16:19], v[112:127]
    ds_read_b64_tr_b16 v[80:81], v55 offset:20512
    ds_read_b64_tr_b16 v[82:83], v55 offset:21792
    s_waitcnt lgkmcnt(8)
    v_mfma_f32_32x32x16_bf16 v[128:143], v[64:67], a[16:19], v[128:143]
    ds_read_b64_tr_b16 v[84:85], v55 offset:20544
    ds_read_b64_tr_b16 v[86:87], v55 offset:21824
    s_waitcnt lgkmcnt(8)
    v_mfma_f32_32x32x16_bf16 v[144:159], v[68:71], a[16:19], v[144:159]
    ds_read_b64_tr_b16 v[64:65], v55 offset:20576
    ds_read_b64_tr_b16 v[66:67], v55 offset:21856
    s_waitcnt vmcnt(7)
    s_barrier
    s_waitcnt lgkmcnt(8)
    v_mfma_f32_32x32x16_bf16 v[160:175], v[72:75], a[16:19], v[160:175]
    ds_read_b64_tr_b16 v[68:69], v55 offset:20608
    ds_read_b64_tr_b16 v[70:71], v55 offset:21888
    s_waitcnt lgkmcnt(8)
    v_mfma_f32_32x32x16_bf16 v[96:111], v[76:79], a[20:23], v[96:111]
    ds_read_b128 a[0:3], v50 offset:0
    ds_read_b64_tr_b16 v[72:73], v56 offset:20480
    ds_read_b64_tr_b16 v[74:75], v56 offset:21760
    s_waitcnt lgkmcnt(9)
    v_mfma_f32_32x32x16_bf16 v[112:127], v[80:83], a[20:23], v[112:127]
    ds_read_b128 a[4:7], v51 offset:0
    s_add_u32 m0, s21, 0
    s_nop 0
    global_load_lds_dwordx4 v[40:41], off
    v_add_co_u32 v40, vcc, s20, v40
    v_addc_co_u32 v41, vcc, 0, v41, vcc
    ds_read_b64_tr_b16 v[76:77], v56 offset:20512
    ds_read_b64_tr_b16 v[78:79], v56 offset:21792
    s_waitcnt lgkmcnt(10)
    v_mfma_f32_32x32x16_bf16 v[128:143], v[84:87], a[20:23], v[128:143]
    ds_read_b128 a[8:11], v52 offset:0
    ds_read_b64_tr_b16 v[80:81], v56 offset:20544
    ds_read_b64_tr_b16 v[82:83], v56 offset:21824
    s_waitcnt lgkmcnt(11)
    v_mfma_f32_32x32x16_bf16 v[144:159], v[64:67], a[20:23], v[144:159]
    ds_read_b128 a[12:15], v53 offset:0
    ds_read_b64_tr_b16 v[84:85], v56 offset:20576
    ds_read_b64_tr_b16 v[86:87], v56 offset:21856
    s_waitcnt lgkmcnt(12)
    v_mfma_f32_32x32x16_bf16 v[160:175], v[68:71], a[20:23], v[160:175]
    s_add_u32 m0, s21, 1024
    s_nop 0
    global_load_lds_dwordx4 v[42:43], off
    v_add_co_u32 v42, vcc, s20, v42
    v_addc_co_u32 v43, vcc, 0, v43, vcc
    ds_read_b64_tr_b16 v[64:65], v56 offset:20608
    ds_read_b64_tr_b16 v[66:67], v56 offset:21888
    s_waitcnt lgkmcnt(11)
    v_mfma_f32_32x32x16_bf16 v[96:111], v[72:75], a[24:27], v[96:111]
    ds_read_b64_tr_b16 v[68:69], v57 offset:20480
    ds_read_b64_tr_b16 v[70:71], v57 offset:21760
    s_waitcnt lgkmcnt(10)
    v_mfma_f32_32x32x16_bf16 v[112:127], v[76:79], a[24:27], v[112:127]
    ds_read_b64_tr_b16 v[72:73], v57 offset:20512
    ds_read_b64_tr_b16 v[74:75], v57 offset:21792
    s_waitcnt lgkmcnt(8)
    v_mfma_f32_32x32x16_bf16 v[128:143], v[80:83], a[24:27], v[128:143]
    s_add_u32 m0, s21, 2048
    s_mov_b32 exec_hi, 0
    global_load_lds_dwordx4 v[44:45], off
    s_mov_b32 exec_hi, -1
    v_add_co_u32 v44, vcc, s20, v44
    v_addc_co_u32 v45, vcc, 0, v45, vcc
    ds_read_b64_tr_b16 v[76:77], v57 offset:20544
    ds_read_b64_tr_b16 v[78:79], v57 offset:21824
    s_waitcnt lgkmcnt(8)
    v_mfma_f32_32x32x16_bf16 v[144:159], v[84:87], a[24:27], v[144:159]
    s_add_u32 m0, s34, 0
    s_nop 0
    global_load_lds_dwordx4 v46, s[4:5]
    ds_read_b64_tr_b16 v[80:81], v57 offset:20576
    ds_read_b64_tr_b16 v[82:83], v57 offset:21856
    s_waitcnt lgkmcnt(8)
    v_mfma_f32_32x32x16_bf16 v[160:175], v[64:67], a[24:27], v[160:175]
    ds_read_b64_tr_b16 v[84:85], v57 offset:20608
    ds_read_b64_tr_b16 v[86:87], v57 offset:21888
    s_waitcnt lgkmcnt(8)
    v_mfma_f32_32x32x16_bf16 v[96:111], v[68:71], a[28:31], v[96:111]
    s_add_u32 m0, s34, 1024
    s_nop 0
    global_load_lds_dwordx4 v47, s[4:5]
    ds_read_b64_tr_b16 v[64:65], v58 offset:0
    ds_read_b64_tr_b16 v[66:67], v58 offset:1280
    s_waitcnt lgkmcnt(8)
    v_mfma_f32_32x32x16_bf16 v[112:127], v[72:75], a[28:31], v[112:127]
    ds_read_b64_tr_b16 v[68:69], v58 offset:32
    ds_read_b64_tr_b16 v[70:71], v58 offset:1312
    s_waitcnt lgkmcnt(8)
    v_mfma_f32_32x32x16_bf16 v[128:143], v[76:79], a[28:31], v[128:143]
    s_add_u32 m0, s34, 2048
    s_nop 0
    global_load_lds_dwordx4 v48, s[4:5]
    ds_read_b64_tr_b16 v[72:73], v58 offset:64
    ds_read_b64_tr_b16 v[74:75], v58 offset:1344
    s_waitcnt lgkmcnt(8)
    v_mfma_f32_32x32x16_bf16 v[144:159], v[80:83], a[28:31], v[144:159]
    ds_read_b64_tr_b16 v[76:77], v58 offset:96
    ds_read_b64_tr_b16 v[78:79], v58 offset:1376
    s_waitcnt lgkmcnt(8)
    v_mfma_f32_32x32x16_bf16 v[160:175], v[84:87], a[28:31], v[160:175]
    s_add_u32 m0, s34, 3072
    s_nop 0
    global_load_lds_dwordx4 v49, s[4:5]
    s_add_u32 s4, s4, 128
    s_addc_u32 s5, s5, 0
    ds_read_b64_tr_b16 v[80:81], v58 offset:128
    ds_read_b64_tr_b16 v[82:83], v58 offset:1408
    s_waitcnt lgkmcnt(8)
    v_mfma_f32_32x32x16_bf16 v[96:111], v[64:67], a[0:3], v[96:111]
    ds_read_b64_tr_b16 v[84:85], v59 offset:0
    ds_read_b64_tr_b16 v[86:87], v59 offset:1280
    s_waitcnt lgkmcnt(8)
    v_mfma_f32_32x32x16_bf16 v[112:127], v[68:71], a[0:3], v[112:127]
    ds_read_b64_tr_b16 v[64:65], v59 offset:32
    ds_read_b64_tr_b16 v[66:67], v59 offset:1312
    s_waitcnt lgkmcnt(8)
    v_mfma_f32_32x32x16_bf16 v[128:143], v[72:75], a[0:3], v[128:143]
    ds_read_b64_tr_b16 v[68:69], v59 offset:64
    ds_read_b64_tr_b16 v[70:71], v59 offset:1344
    s_waitcnt lgkmcnt(8)
    v_mfma_f32_32x32x16_bf16 v[144:159], v[76:79], a[0:3], v[144:159]
    ds_read_b64_tr_b16 v[72:73], v59 offset:96
    ds_read_b64_tr_b16 v[74:75], v59 offset:1376
    s_waitcnt vmcnt(7)
    s_barrier
    s_waitcnt lgkmcnt(8)
    v_mfma_f32_32x32x16_bf16 v[160:175], v[80:83], a[0:3], v[160:175]
    ds_read_b64_tr_b16 v[76:77], v59 offset:128
    ds_read_b64_tr_b16 v[78:79], v59 offset:1408
    s_waitcnt lgkmcnt(8)
    v_mfma_f32_32x32x16_bf16 v[96:111], v[84:87], a[4:7], v[96:111]
    ds_read_b128 a[16:19], v50 offset:4096
    ds_read_b64_tr_b16 v[80:81], v60 offset:0
    ds_read_b64_tr_b16 v[82:83], v60 offset:1280
    s_waitcnt lgkmcnt(9)
    v_mfma_f32_32x32x16_bf16 v[112:127], v[64:67], a[4:7], v[112:127]
    ds_read_b128 a[20:23], v51 offset:4096
    s_add_u32 m0, s21, 20480
    s_nop 0
    global_load_lds_dwordx4 v[40:41], off
    v_add_co_u32 v40, vcc, s20, v40
    v_addc_co_u32 v41, vcc, 0, v41, vcc
    ds_read_b64_tr_b16 v[84:85], v60 offset:32
    ds_read_b64_tr_b16 v[86:87], v60 offset:1312
    s_waitcnt lgkmcnt(10)
    v_mfma_f32_32x32x16_bf16 v[128:143], v[68:71], a[4:7], v[128:143]
    ds_read_b128 a[24:27], v52 offset:4096
    ds_read_b64_tr_b16 v[64:65], v60 offset:64
    ds_read_b64_tr_b16 v[66:67], v60 offset:1344
    s_waitcnt lgkmcnt(11)
    v_mfma_f32_32x32x16_bf16 v[144:159], v[72:75], a[4:7], v[144:159]
    ds_read_b128 a[28:31], v53 offset:4096
    ds_read_b64_tr_b16 v[68:69], v60 offset:96
    ds_read_b64_tr_b16 v[70:71], v60 offset:1376
    s_waitcnt lgkmcnt(12)
    v_mfma_f32_32x32x16_bf16 v[160:175], v[76:79], a[4:7], v[160:175]
    s_add_u32 m0, s21, 21504
    s_nop 0
    global_load_lds_dwordx4 v[42:43], off
    v_add_co_u32 v42, vcc, s20, v42
    v_addc_co_u32 v43, vcc, 0, v43, vcc
    ds_read_b64_tr_b16 v[72:73], v60 offset:128
    ds_read_b64_tr_b16 v[74:75], v60 offset:1408
    s_waitcnt lgkmcnt(11)
    v_mfma_f32_32x32x16_bf16 v[96:111], v[80:83], a[8:11], v[96:111]
    ds_read_b64_tr_b16 v[76:77], v61 offset:0
    ds_read_b64_tr_b16 v[78:79], v61 offset:1280
    s_waitcnt lgkmcnt(10)
    v_mfma_f32_32x32x16_bf16 v[112:127], v[84:87], a[8:11], v[112:127]
    ds_read_b64_tr_b16 v[80:81], v61 offset:32
    ds_read_b64_tr_b16 v[82:83], v61 offset:1312
    s_waitcnt lgkmcnt(8)
    v_mfma_f32_32x32x16_bf16 v[128:143], v[64:67], a[8:11], v[128:143]
    s_add_u32 m0, s21, 22528
    s_mov_b32 exec_hi, 0
    global_load_lds_dwordx4 v[44:45], off
    s_mov_b32 exec_hi, -1
    v_add_co_u32 v44, vcc, s20, v44
    v_addc_co_u32 v45, vcc, 0, v45, vcc
    ds_read_b64_tr_b16 v[84:85], v61 offset:64
    ds_read_b64_tr_b16 v[86:87], v61 offset:1344
    s_waitcnt lgkmcnt(8)
    v_mfma_f32_32x32x16_bf16 v[144:159], v[68:71], a[8:11], v[144:159]
    s_add_u32 m0, s34, 4096
    s_nop 0
    global_load_lds_dwordx4 v46, s[4:5]
    ds_read_b64_tr_b16 v[64:65], v61 offset:96
    ds_read_b64_tr_b16 v[66:67], v61 offset:1376
    s_waitcnt lgkmcnt(8)
    v_mfma_f32_32x32x16_bf16 v[160:175], v[72:75], a[8:11], v[160:175]
    ds_read_b64_tr_b16 v[68:69], v61 offset:128
    ds_read_b64_tr_b16 v[70:71], v61 offset:1408
    s_waitcnt lgkmcnt(8)
    v_mfma_f32_32x32x16_bf16 v[96:111], v[76:79], a[12:15], v[96:111]
    s_add_u32 m0, s34, 5120
    s_nop 0
    global_load_lds_dwordx4 v47, s[4:5]
    ds_read_b64_tr_b16 v[72:73], v58 offset:20480
    ds_read_b64_tr_b16 v[74:75], v58 offset:21760
    s_waitcnt lgkmcnt(8)
    v_mfma_f32_32x32x16_bf16 v[112:127], v[80:83], a[12:15], v[112:127]
    ds_read_b64_tr_b16 v[76:77], v58 offset:20512
    ds_read_b64_tr_b16 v[78:79], v58 offset:21792
    s_waitcnt lgkmcnt(8)
    v_mfma_f32_32x32x16_bf16 v[128:143], v[84:87], a[12:15], v[128:143]
    s_add_u32 m0, s34, 6144
    s_nop 0
    global_load_lds_dwordx4 v48, s[4:5]
    ds_read_b64_tr_b16 v[80:81], v58 offset:20544
    ds_read_b64_tr_b16 v[82:83], v58 offset:21824
    s_waitcnt lgkmcnt(8)
    v_mfma_f32_32x32x16_bf16 v[144:159], v[64:67], a[12:15], v[144:159]
    ds_read_b64_tr_b16 v[84:85], v58 offset:20576
    ds_read_b64_tr_b16 v[86:87], v58 offset:21856
    s_waitcnt lgkmcnt(8)
    v_mfma_f32_32x32x16_bf16 v[160:175], v[68:71], a[12:15], v[160:175]
    s_add_u32 m0, s34, 7168
    s_nop 0
    global_load_lds_dwordx4 v49, s[4:5]
    s_add_u32 s4, s4, 128
    s_addc_u32 s5, s5, 0
    ds_read_b64_tr_b16 v[64:65], v58 offset:20608
    ds_read_b64_tr_b16 v[66:67], v58 offset:21888
    s_waitcnt lgkmcnt(8)
    v_mfma_f32_32x32x16_bf16 v[96:111], v[72:75], a[16:19], v[96:111]
    ds_read_b64_tr_b16 v[68:69], v59 offset:20480
    ds_read_b64_tr_b16 v[70:71], v59 offset:21760
    s_waitcnt lgkmcnt(8)
    v_mfma_f32_32x32x16_bf16 v[112:127], v[76:79], a[16:19], v[112:127]
    ds_read_b64_tr_b16 v[72:73], v59 offset:20512
    ds_read_b64_tr_b16 v[74:75], v59 offset:21792
    s_waitcnt lgkmcnt(8)
    v_mfma_f32_32x32x16_bf16 v[128:143], v[80:83], a[16:19], v[128:143]
    ds_read_b64_tr_b16 v[76:77], v59 offset:20544
    ds_read_b64_tr_b16 v[78:79], v59 offset:21824
    s_waitcnt lgkmcnt(8)
    v_mfma_f32_32x32x16_bf16 v[144:159], v[84:87], a[16:19], v[144:159]
    ds_read_b64_tr_b16 v[80:81], v59 offset:20576
    ds_read_b64_tr_b16 v[82:83], v59 offset:21856
    s_waitcnt vmcnt(7)
    s_barrier
    s_waitcnt lgkmcnt(8)
    v_mfma_f32_32x32x16_bf16 v[160:175], v[64:67], a[16:19], v[160:175]
    ds_read_b64_tr_b16 v[84:85], v59 offset:20608
    ds_read_b64_tr_b16 v[86:87], v59 offset:21888
    s_waitcnt lgkmcnt(8)
    v_mfma_f32_32x32x16_bf16 v[96:111], v[68:71], a[20:23], v[96:111]
    ds_read_b128 a[0:3], v50 offset:0
    ds_read_b64_tr_b16 v[64:65], v60 offset:20480
    ds_read_b64_tr_b16 v[66:67], v60 offset:21760
    s_waitcnt lgkmcnt(9)
    v_mfma_f32_32x32x16_bf16 v[112:127], v[72:75], a[20:23], v[112:127]
    ds_read_b128 a[4:7], v51 offset:0
    ds_read_b64_tr_b16 v[68:69], v60 offset:20512
    ds_read_b64_tr_b16 v[70:71], v60 offset:21792
    s_waitcnt lgkmcnt(10)
    v_mfma_f32_32x32x16_bf16 v[128:143], v[76:79], a[20:23], v[128:143]
    ds_read_b128 a[8:11], v52 offset:0
    ds_read_b64_tr_b16 v[72:73], v60 offset:20544
    ds_read_b64_tr_b16 v[74:75], v60 offset:21824
    s_waitcnt lgkmcnt(11)
    v_mfma_f32_32x32x16_bf16 v[144:159], v[80:83], a[20:23], v[144:159]
    ds_read_b128 a[12:15], v53 offset:0
    ds_read_b64_tr_b16 v[76:77], v60 offset:20576
    ds_read_b64_tr_b16 v[78:79], v60 offset:21856
    s_waitcnt lgkmcnt(12)
    v_mfma_f32_32x32x16_bf16 v[160:175], v[84:87], a[20:23], v[160:175]
    ds_read_b64_tr_b16 v[80:81], v60 offset:20608
    ds_read_b64_tr_b16 v[82:83], v60 offset:21888
    s_waitcnt lgkmcnt(11)
    v_mfma_f32_32x32x16_bf16 v[96:111], v[64:67], a[24:27], v[96:111]
    ds_read_b64_tr_b16 v[84:85], v61 offset:20480
    ds_read_b64_tr_b16 v[86:87], v61 offset:21760
    s_waitcnt lgkmcnt(10)
    v_mfma_f32_32x32x16_bf16 v[112:127], v[68:71], a[24:27], v[112:127]
    ds_read_b64_tr_b16 v[64:65], v61 offset:20512
    ds_read_b64_tr_b16 v[66:67], v61 offset:21792
    s_waitcnt lgkmcnt(9)
    v_mfma_f32_32x32x16_bf16 v[128:143], v[72:75], a[24:27], v[128:143]
    ds_read_b64_tr_b16 v[68:69], v61 offset:20544
    ds_read_b64_tr_b16 v[70:71], v61 offset:21824
    s_waitcnt lgkmcnt(8)
    v_mfma_f32_32x32x16_bf16 v[144:159], v[76:79], a[24:27], v[144:159]
    ds_read_b64_tr_b16 v[72:73], v61 offset:20576
    ds_read_b64_tr_b16 v[74:75], v61 offset:21856
    s_waitcnt lgkmcnt(8)
    v_mfma_f32_32x32x16_bf16 v[160:175], v[80:83], a[24:27], v[160:175]
    ds_read_b64_tr_b16 v[76:77], v61 offset:20608
    ds_read_b64_tr_b16 v[78:79], v61 offset:21888
    s_waitcnt lgkmcnt(8)
    v_mfma_f32_32x32x16_bf16 v[96:111], v[84:87], a[28:31], v[96:111]
    ds_read_b64_tr_b16 v[80:81], v54 offset:0
    ds_read_b64_tr_b16 v[82:83], v54 offset:1280
    s_waitcnt lgkmcnt(8)
    v_mfma_f32_32x32x16_bf16 v[112:127], v[64:67], a[28:31], v[112:127]
    ds_read_b64_tr_b16 v[84:85], v54 offset:32
    ds_read_b64_tr_b16 v[86:87], v54 offset:1312
    s_waitcnt lgkmcnt(8)
    v_mfma_f32_32x32x16_bf16 v[128:143], v[68:71], a[28:31], v[128:143]
    ds_read_b64_tr_b16 v[64:65], v54 offset:64
    ds_read_b64_tr_b16 v[66:67], v54 offset:1344
    s_waitcnt lgkmcnt(8)
    v_mfma_f32_32x32x16_bf16 v[144:159], v[72:75], a[28:31], v[144:159]
    ds_read_b64_tr_b16 v[68:69], v54 offset:96
    ds_read_b64_tr_b16 v[70:71], v54 offset:1376
    s_waitcnt lgkmcnt(8)
    v_mfma_f32_32x32x16_bf16 v[160:175], v[76:79], a[28:31], v[160:175]
    ds_read_b64_tr_b16 v[72:73], v54 offset:128
    ds_read_b64_tr_b16 v[74:75], v54 offset:1408
    s_waitcnt lgkmcnt(8)
    v_mfma_f32_32x32x16_bf16 v[96:111], v[80:83], a[0:3], v[96:111]
    ds_read_b64_tr_b16 v[76:77], v55 offset:0
    ds_read_b64_tr_b16 v[78:79], v55 offset:1280
    s_waitcnt lgkmcnt(8)
    v_mfma_f32_32x32x16_bf16 v[112:127], v[84:87], a[0:3], v[112:127]
    ds_read_b64_tr_b16 v[80:81], v55 offset:32
    ds_read_b64_tr_b16 v[82:83], v55 offset:1312
    s_waitcnt lgkmcnt(8)
    v_mfma_f32_32x32x16_bf16 v[128:143], v[64:67], a[0:3], v[128:143]
    ds_read_b64_tr_b16 v[84:85], v55 offset:64
    ds_read_b64_tr_b16 v[86:87], v55 offset:1344
    s_waitcnt lgkmcnt(8)
    v_mfma_f32_32x32x16_bf16 v[144:159], v[68:71], a[0:3], v[144:159]
    ds_read_b64_tr_b16 v[64:65], v55 offset:96
    ds_read_b64_tr_b16 v[66:67], v55 offset:1376
    s_waitcnt vmcnt(0)
    s_barrier
    s_waitcnt lgkmcnt(8)
    v_mfma_f32_32x32x16_bf16 v[160:175], v[72:75], a[0:3], v[160:175]
    ds_read_b64_tr_b16 v[68:69], v55 offset:128
    ds_read_b64_tr_b16 v[70:71], v55 offset:1408
    s_waitcnt lgkmcnt(8)
    v_mfma_f32_32x32x16_bf16 v[96:111], v[76:79], a[4:7], v[96:111]
    ds_read_b128 a[16:19], v50 offset:4096
    ds_read_b64_tr_b16 v[72:73], v56 offset:0
    ds_read_b64_tr_b16 v[74:75], v56 offset:1280
    s_waitcnt lgkmcnt(9)
    v_mfma_f32_32x32x16_bf16 v[112:127], v[80:83], a[4:7], v[112:127]
    ds_read_b128 a[20:23], v51 offset:4096
    ds_read_b64_tr_b16 v[76:77], v56 offset:32
    ds_read_b64_tr_b16 v[78:79], v56 offset:1312
    s_waitcnt lgkmcnt(10)
    v_mfma_f32_32x32x16_bf16 v[128:143], v[84:87], a[4:7], v[128:143]
    ds_read_b128 a[24:27], v52 offset:4096
    ds_read_b64_tr_b16 v[80:81], v56 offset:64
    ds_read_b64_tr_b16 v[82:83], v56 offset:1344
    s_waitcnt lgkmcnt(11)
    v_mfma_f32_32x32x16_bf16 v[144:159], v[64:67], a[4:7], v[144:159]
    ds_read_b128 a[28:31], v53 offset:4096
    ds_read_b64_tr_b16 v[84:85], v56 offset:96
    ds_read_b64_tr_b16 v[86:87], v56 offset:1376
    s_waitcnt lgkmcnt(12)
    v_mfma_f32_32x32x16_bf16 v[160:175], v[68:71], a[4:7], v[160:175]
    ds_read_b64_tr_b16 v[64:65], v56 offset:128
    ds_read_b64_tr_b16 v[66:67], v56 offset:1408
    s_waitcnt lgkmcnt(11)
    v_mfma_f32_32x32x16_bf16 v[96:111], v[72:75], a[8:11], v[96:111]
    ds_read_b64_tr_b16 v[68:69], v57 offset:0
    ds_read_b64_tr_b16 v[70:71], v57 offset:1280
    s_waitcnt lgkmcnt(10)
    v_mfma_f32_32x32x16_bf16 v[112:127], v[76:79], a[8:11], v[112:127]
    ds_read_b64_tr_b16 v[72:73], v57 offset:32
    ds_read_b64_tr_b16 v[74:75], v57 offset:1312
    v_lshlrev_b32 v38, 2, v2
    global_load_dword v32, v38, s[44:45] sc0 sc1
    s_waitcnt lgkmcnt(9)
    v_mfma_f32_32x32x16_bf16 v[128:143], v[80:83], a[8:11], v[128:143]
    ds_read_b64_tr_b16 v[76:77], v57 offset:64
    ds_read_b64_tr_b16 v[78:79], v57 offset:1344
    s_waitcnt lgkmcnt(8)
    v_mfma_f32_32x32x16_bf16 v[144:159], v[84:87], a[8:11], v[144:159]
    ds_read_b64_tr_b16 v[80:81], v57 offset:96
    ds_read_b64_tr_b16 v[82:83], v57 offset:1376
    s_waitcnt lgkmcnt(8)
    v_mfma_f32_32x32x16_bf16 v[160:175], v[64:67], a[8:11], v[160:175]
    ds_read_b64_tr_b16 v[84:85], v57 offset:128
    ds_read_b64_tr_b16 v[86:87], v57 offset:1408
    s_waitcnt lgkmcnt(8)
    v_mfma_f32_32x32x16_bf16 v[96:111], v[68:71], a[12:15], v[96:111]
    ds_read_b64_tr_b16 v[64:65], v54 offset:20480
    ds_read_b64_tr_b16 v[66:67], v54 offset:21760
    s_waitcnt lgkmcnt(8)
    v_mfma_f32_32x32x16_bf16 v[112:127], v[72:75], a[12:15], v[112:127]
    ds_read_b64_tr_b16 v[68:69], v54 offset:20512
    ds_read_b64_tr_b16 v[70:71], v54 offset:21792
    s_waitcnt lgkmcnt(8)
    v_mfma_f32_32x32x16_bf16 v[128:143], v[76:79], a[12:15], v[128:143]
    ds_read_b64_tr_b16 v[72:73], v54 offset:20544
    ds_read_b64_tr_b16 v[74:75], v54 offset:21824
    s_waitcnt lgkmcnt(8)
    v_mfma_f32_32x32x16_bf16 v[144:159], v[80:83], a[12:15], v[144:159]
    ds_read_b64_tr_b16 v[76:77], v54 offset:20576
    ds_read_b64_tr_b16 v[78:79], v54 offset:21856
    s_waitcnt lgkmcnt(8)
    v_mfma_f32_32x32x16_bf16 v[160:175], v[84:87], a[12:15], v[160:175]
    ds_read_b64_tr_b16 v[80:81], v54 offset:20608
    ds_read_b64_tr_b16 v[82:83], v54 offset:21888
    s_waitcnt lgkmcnt(8)
    v_mfma_f32_32x32x16_bf16 v[96:111], v[64:67], a[16:19], v[96:111]
    ds_read_b64_tr_b16 v[84:85], v55 offset:20480
    ds_read_b64_tr_b16 v[86:87], v55 offset:21760
    s_waitcnt lgkmcnt(8)
    v_mfma_f32_32x32x16_bf16 v[112:127], v[68:71], a[16:19], v[112:127]
    ds_read_b64_tr_b16 v[64:65], v55 offset:20512
    ds_read_b64_tr_b16 v[66:67], v55 offset:21792
    s_waitcnt lgkmcnt(8)
    v_mfma_f32_32x32x16_bf16 v[128:143], v[72:75], a[16:19], v[128:143]
    ds_read_b64_tr_b16 v[68:69], v55 offset:20544
    ds_read_b64_tr_b16 v[70:71], v55 offset:21824
    s_waitcnt lgkmcnt(8)
    v_mfma_f32_32x32x16_bf16 v[144:159], v[76:79], a[16:19], v[144:159]
    ds_read_b64_tr_b16 v[72:73], v55 offset:20576
    ds_read_b64_tr_b16 v[74:75], v55 offset:21856
    s_waitcnt lgkmcnt(8)
    v_mfma_f32_32x32x16_bf16 v[160:175], v[80:83], a[16:19], v[160:175]
    ds_read_b64_tr_b16 v[76:77], v55 offset:20608
    ds_read_b64_tr_b16 v[78:79], v55 offset:21888
    s_waitcnt lgkmcnt(8)
    v_mfma_f32_32x32x16_bf16 v[96:111], v[84:87], a[20:23], v[96:111]
    ds_read_b64_tr_b16 v[80:81], v56 offset:20480
    ds_read_b64_tr_b16 v[82:83], v56 offset:21760
    s_waitcnt lgkmcnt(8)
    v_mfma_f32_32x32x16_bf16 v[112:127], v[64:67], a[20:23], v[112:127]
    ds_read_b64_tr_b16 v[84:85], v56 offset:20512
    ds_read_b64_tr_b16 v[86:87], v56 offset:21792
    s_waitcnt lgkmcnt(8)
    v_mfma_f32_32x32x16_bf16 v[128:143], v[68:71], a[20:23], v[128:143]
    ds_read_b64_tr_b16 v[64:65], v56 offset:20544
    ds_read_b64_tr_b16 v[66:67], v56 offset:21824
    s_waitcnt lgkmcnt(8)
    v_mfma_f32_32x32x16_bf16 v[144:159], v[72:75], a[20:23], v[144:159]
    ds_read_b64_tr_b16 v[68:69], v56 offset:20576
    ds_read_b64_tr_b16 v[70:71], v56 offset:21856
    s_waitcnt lgkmcnt(8)
    v_mfma_f32_32x32x16_bf16 v[160:175], v[76:79], a[20:23], v[160:175]
    ds_read_b64_tr_b16 v[72:73], v56 offset:20608
    ds_read_b64_tr_b16 v[74:75], v56 offset:21888
    s_waitcnt vmcnt(0)
    v_cmp_ne_u32 vcc, 0x01010101, v32
    v_lshlrev_b32 v38, 3, v3
    s_nop 2
    s_cmp_eq_u64 vcc, 0
    s_cselect_b32 s48, 1, 0
    s_cbranch_scc0 L_nopre_a5e0_7
    global_load_dwordx2 v[30:31], v38, s[42:43] sc0 sc1
    global_load_dword v10, v8, s[54:55] offset:-2560 sc0 sc1
    global_load_dword v11, v8, s[54:55] offset:-1920 sc0 sc1
    global_load_dword v12, v8, s[54:55] offset:-1280 sc0 sc1
    global_load_dword v13, v8, s[54:55] offset:-640 sc0 sc1
    global_load_dword v14, v8, s[54:55] offset:0 sc0 sc1
    global_load_dword v15, v8, s[54:55] offset:640 sc0 sc1
    global_load_dword v16, v8, s[54:55] offset:1280 sc0 sc1
    global_load_dword v17, v8, s[54:55] offset:1920 sc0 sc1
L_nopre_a5e0_7:
    s_waitcnt lgkmcnt(8)
    v_mfma_f32_32x32x16_bf16 v[96:111], v[80:83], a[24:27], v[96:111]
    ds_read_b64_tr_b16 v[76:77], v57 offset:20480
    ds_read_b64_tr_b16 v[78:79], v57 offset:21760
    s_waitcnt lgkmcnt(8)
    v_mfma_f32_32x32x16_bf16 v[112:127], v[84:87], a[24:27], v[112:127]
    ds_read_b64_tr_b16 v[80:81], v57 offset:20512
    ds_read_b64_tr_b16 v[82:83], v57 offset:21792
    s_waitcnt lgkmcnt(8)
    v_mfma_f32_32x32x16_bf16 v[128:143], v[64:67], a[24:27], v[128:143]
    ds_read_b64_tr_b16 v[84:85], v57 offset:20544
    ds_read_b64_tr_b16 v[86:87], v57 offset:21824
    s_waitcnt lgkmcnt(8)
    v_mfma_f32_32x32x16_bf16 v[144:159], v[68:71], a[24:27], v[144:159]
    ds_read_b64_tr_b16 v[64:65], v57 offset:20576
    ds_read_b64_tr_b16 v[66:67], v57 offset:21856
    s_waitcnt lgkmcnt(8)
    v_mfma_f32_32x32x16_bf16 v[160:175], v[72:75], a[24:27], v[160:175]
    ds_read_b64_tr_b16 v[68:69], v57 offset:20608
    ds_read_b64_tr_b16 v[70:71], v57 offset:21888
    s_waitcnt lgkmcnt(8)
    v_mfma_f32_32x32x16_bf16 v[96:111], v[76:79], a[28:31], v[96:111]
    s_waitcnt lgkmcnt(6)
    v_mfma_f32_32x32x16_bf16 v[112:127], v[80:83], a[28:31], v[112:127]
    s_cmp_eq_u32 s48, 1
    s_cbranch_scc0 L_nocs_a5e0_8
    s_waitcnt vmcnt(0)
    v_add_f32 v10, v10, v11
    v_add_f32 v12, v12, v13
    v_add_f32 v14, v14, v15
    v_add_f32 v16, v16, v17
    v_add_f32 v10, v10, v12
    v_add_f32 v14, v14, v16
    v_add_f32 v10, v10, v14
    v_min_u32 v5, 255, v0
    v_lshlrev_b32 v5, 2, v5
    v_add_u32 v5, 147456, v5
    ds_write_b32 v5, v10
    s_waitcnt lgkmcnt(0)

L_nocs_a5e0_8:
    s_waitcnt lgkmcnt(4)
    v_mfma_f32_32x32x16_bf16 v[128:143], v[84:87], a[28:31], v[128:143]
    s_waitcnt lgkmcnt(2)
    v_mfma_f32_32x32x16_bf16 v[144:159], v[64:67], a[28:31], v[144:159]
    s_waitcnt lgkmcnt(0)
    v_mfma_f32_32x32x16_bf16 v[160:175], v[68:71], a[28:31], v[160:175]
    s_cmp_eq_u32 s48, 1
    s_cbranch_scc1 L_k1_bar2
    s_mov_b32 s40, 4096
    v_lshlrev_b32 v5, 2, v2
    s_mov_b32 s41, 0x01010101

L_k1_poll2:
    global_load_dword v6, v5, s[44:45] sc0 sc1
    s_waitcnt vmcnt(0)
    v_cmp_ne_u32 vcc, s41, v6
    s_nop 3
    s_cmp_eq_u64 vcc, 0
    s_cbranch_scc1 L_k1_ok2
    s_sleep 4
    s_sub_u32 s40, s40, 1
    s_cmp_lg_u32 s40, 0
    s_cbranch_scc1 L_k1_poll2
    v_lshrrev_b32 v9, 4, v2
    v_add_u32 v9, s22, v9
    v_lshlrev_b32 v7, 3, v9
    v_mul_u32_u24 v9, 1280, v9
    v_and_b32 v6, 15, v2
    v_lshl_add_u32 v9, v6, 4, v9
    s_mov_b32 s40, 8

L_k1_fb2:
    global_load_dwordx4 v[64:67], v9, s[38:39] offset:0
    global_load_dwordx4 v[68:71], v9, s[38:39] offset:256
    global_load_dwordx4 v[72:75], v9, s[38:39] offset:512
    global_load_dwordx4 v[76:79], v9, s[38:39] offset:768
    global_load_dwordx4 v[80:83], v9, s[38:39] offset:1024
    s_waitcnt vmcnt(0)
    v_mov_b32 v30, 0
    v_mov_b32 v31, 0
    v_mov_b32 v33, 0
    v_mov_b32 v34, 0
    v_mov_b32 v5, v64
    v_lshlrev_b32 v6, 16, v5
    v_and_b32 v5, 0xffff0000, v5
    v_add_f32 v30, v30, v6
    v_add_f32 v31, v31, v5
    v_mov_b32 v5, v65
    v_lshlrev_b32 v6, 16, v5
    v_and_b32 v5, 0xffff0000, v5
    v_add_f32 v33, v33, v6
    v_add_f32 v34, v34, v5
    v_mov_b32 v5, v66
    v_lshlrev_b32 v6, 16, v5
    v_and_b32 v5, 0xffff0000, v5
    v_add_f32 v30, v30, v6
    v_add_f32 v31, v31, v5
    v_mov_b32 v5, v67
    v_lshlrev_b32 v6, 16, v5
    v_and_b32 v5, 0xffff0000, v5
    v_add_f32 v33, v33, v6
    v_add_f32 v34, v34, v5
    v_mov_b32 v5, v68
    v_lshlrev_b32 v6, 16, v5
    v_and_b32 v5, 0xffff0000, v5
    v_add_f32 v30, v30, v6
    v_add_f32 v31, v31, v5
    v_mov_b32 v5, v69
    v_lshlrev_b32 v6, 16, v5
    v_and_b32 v5, 0xffff0000, v5
    v_add_f32 v33, v33, v6
    v_add_f32 v34, v34, v5
    v_mov_b32 v5, v70
    v_lshlrev_b32 v6, 16, v5
    v_and_b32 v5, 0xffff0000, v5
    v_add_f32 v30, v30, v6
    v_add_f32 v31, v31, v5
    v_mov_b32 v5, v71
    v_lshlrev_b32 v6, 16, v5
    v_and_b32 v5, 0xffff0000, v5
    v_add_f32 v33, v33, v6
    v_add_f32 v34, v34, v5
    v_mov_b32 v5, v72
    v_lshlrev_b32 v6, 16, v5
    v_and_b32 v5, 0xffff0000, v5
    v_add_f32 v30, v30, v6
    v_add_f32 v31, v31, v5
    v_mov_b32 v5, v73
    v_lshlrev_b32 v6, 16, v5
    v_and_b32 v5, 0xffff0000, v5
    v_add_f32 v33, v33, v6
    v_add_f32 v34, v34, v5
    v_mov_b32 v5, v74
    v_lshlrev_b32 v6, 16, v5
    v_and_b32 v5, 0xffff0000, v5
    v_add_f32 v30, v30, v6
    v_add_f32 v31, v31, v5
    v_mov_b32 v5, v75
    v_lshlrev_b32 v6, 16, v5
    v_and_b32 v5, 0xffff0000, v5
    v_add_f32 v33, v33, v6
    v_add_f32 v34, v34, v5
    v_mov_b32 v5, v76
    v_lshlrev_b32 v6, 16, v5
    v_and_b32 v5, 0xffff0000, v5
    v_add_f32 v30, v30, v6
    v_add_f32 v31, v31, v5
    v_mov_b32 v5, v77
    v_lshlrev_b32 v6, 16, v5
    v_and_b32 v5, 0xffff0000, v5
    v_add_f32 v33, v33, v6
    v_add_f32 v34, v34, v5
    v_mov_b32 v5, v78
    v_lshlrev_b32 v6, 16, v5
    v_and_b32 v5, 0xffff0000, v5
    v_add_f32 v30, v30, v6
    v_add_f32 v31, v31, v5
    v_mov_b32 v5, v79
    v_lshlrev_b32 v6, 16, v5
    v_and_b32 v5, 0xffff0000, v5
    v_add_f32 v33, v33, v6
    v_add_f32 v34, v34, v5
    v_mov_b32 v5, v80
    v_lshlrev_b32 v6, 16, v5
    v_and_b32 v5, 0xffff0000, v5
    v_add_f32 v30, v30, v6
    v_add_f32 v31, v31, v5
    v_mov_b32 v5, v81
    v_lshlrev_b32 v6, 16, v5
    v_and_b32 v5, 0xffff0000, v5
    v_add_f32 v33, v33, v6
    v_add_f32 v34, v34, v5
    v_mov_b32 v5, v82
    v_lshlrev_b32 v6, 16, v5
    v_and_b32 v5, 0xffff0000, v5
    v_add_f32 v30, v30, v6
    v_add_f32 v31, v31, v5
    v_mov_b32 v5, v83
    v_lshlrev_b32 v6, 16, v5
    v_and_b32 v5, 0xffff0000, v5
    v_add_f32 v33, v33, v6
    v_add_f32 v34, v34, v5
    v_add_f32 v30, v30, v31
    v_add_f32 v33, v33, v34
    v_add_f32 v30, v30, v33
    s_nop 1
    v_add_f32_dpp v30, v30, v30 row_ror:8 row_mask:0xf bank_mask:0xf
    s_nop 1
    v_add_f32_dpp v30, v30, v30 row_ror:4 row_mask:0xf bank_mask:0xf
    s_nop 1
    v_add_f32_dpp v30, v30, v30 row_ror:2 row_mask:0xf bank_mask:0xf
    s_nop 1
    v_add_f32_dpp v30, v30, v30 row_ror:1 row_mask:0xf bank_mask:0xf
    v_mul_f32 v30, 0x3acccccd, v30
    v_mov_b32 v31, 0
    v_mov_b32 v33, 0
    v_mov_b32 v5, v64
    v_lshlrev_b32 v6, 16, v5
    v_and_b32 v5, 0xffff0000, v5
    v_sub_f32 v6, v6, v30
    v_sub_f32 v5, v5, v30
    v_fmac_f32 v31, v6, v6
    v_fmac_f32 v33, v5, v5
    v_mov_b32 v5, v65
    v_lshlrev_b32 v6, 16, v5
    v_and_b32 v5, 0xffff0000, v5
    v_sub_f32 v6, v6, v30
    v_sub_f32 v5, v5, v30
    v_fmac_f32 v31, v6, v6
    v_fmac_f32 v33, v5, v5
    v_mov_b32 v5, v66
    v_lshlrev_b32 v6, 16, v5
    v_and_b32 v5, 0xffff0000, v5
    v_sub_f32 v6, v6, v30
    v_sub_f32 v5, v5, v30
    v_fmac_f32 v31, v6, v6
    v_fmac_f32 v33, v5, v5
    v_mov_b32 v5, v67
    v_lshlrev_b32 v6, 16, v5
    v_and_b32 v5, 0xffff0000, v5
    v_sub_f32 v6, v6, v30
    v_sub_f32 v5, v5, v30
    v_fmac_f32 v31, v6, v6
    v_fmac_f32 v33, v5, v5
    v_mov_b32 v5, v68
    v_lshlrev_b32 v6, 16, v5
    v_and_b32 v5, 0xffff0000, v5
    v_sub_f32 v6, v6, v30
    v_sub_f32 v5, v5, v30
    v_fmac_f32 v31, v6, v6
    v_fmac_f32 v33, v5, v5
    v_mov_b32 v5, v69
    v_lshlrev_b32 v6, 16, v5
    v_and_b32 v5, 0xffff0000, v5
    v_sub_f32 v6, v6, v30
    v_sub_f32 v5, v5, v30
    v_fmac_f32 v31, v6, v6
    v_fmac_f32 v33, v5, v5
    v_mov_b32 v5, v70
    v_lshlrev_b32 v6, 16, v5
    v_and_b32 v5, 0xffff0000, v5
    v_sub_f32 v6, v6, v30
    v_sub_f32 v5, v5, v30
    v_fmac_f32 v31, v6, v6
    v_fmac_f32 v33, v5, v5
    v_mov_b32 v5, v71
    v_lshlrev_b32 v6, 16, v5
    v_and_b32 v5, 0xffff0000, v5
    v_sub_f32 v6, v6, v30
    v_sub_f32 v5, v5, v30
    v_fmac_f32 v31, v6, v6
    v_fmac_f32 v33, v5, v5
    v_mov_b32 v5, v72
    v_lshlrev_b32 v6, 16, v5
    v_and_b32 v5, 0xffff0000, v5
    v_sub_f32 v6, v6, v30
    v_sub_f32 v5, v5, v30
    v_fmac_f32 v31, v6, v6
    v_fmac_f32 v33, v5, v5
    v_mov_b32 v5, v73
    v_lshlrev_b32 v6, 16, v5
    v_and_b32 v5, 0xffff0000, v5
    v_sub_f32 v6, v6, v30
    v_sub_f32 v5, v5, v30
    v_fmac_f32 v31, v6, v6
    v_fmac_f32 v33, v5, v5
    v_mov_b32 v5, v74
    v_lshlrev_b32 v6, 16, v5
    v_and_b32 v5, 0xffff0000, v5
    v_sub_f32 v6, v6, v30
    v_sub_f32 v5, v5, v30
    v_fmac_f32 v31, v6, v6
    v_fmac_f32 v33, v5, v5
    v_mov_b32 v5, v75
    v_lshlrev_b32 v6, 16, v5
    v_and_b32 v5, 0xffff0000, v5
    v_sub_f32 v6, v6, v30
    v_sub_f32 v5, v5, v30
    v_fmac_f32 v31, v6, v6
    v_fmac_f32 v33, v5, v5
    v_mov_b32 v5, v76
    v_lshlrev_b32 v6, 16, v5
    v_and_b32 v5, 0xffff0000, v5
    v_sub_f32 v6, v6, v30
    v_sub_f32 v5, v5, v30
    v_fmac_f32 v31, v6, v6
    v_fmac_f32 v33, v5, v5
    v_mov_b32 v5, v77
    v_lshlrev_b32 v6, 16, v5
    v_and_b32 v5, 0xffff0000, v5
    v_sub_f32 v6, v6, v30
    v_sub_f32 v5, v5, v30
    v_fmac_f32 v31, v6, v6
    v_fmac_f32 v33, v5, v5
    v_mov_b32 v5, v78
    v_lshlrev_b32 v6, 16, v5
    v_and_b32 v5, 0xffff0000, v5
    v_sub_f32 v6, v6, v30
    v_sub_f32 v5, v5, v30
    v_fmac_f32 v31, v6, v6
    v_fmac_f32 v33, v5, v5
    v_mov_b32 v5, v79
    v_lshlrev_b32 v6, 16, v5
    v_and_b32 v5, 0xffff0000, v5
    v_sub_f32 v6, v6, v30
    v_sub_f32 v5, v5, v30
    v_fmac_f32 v31, v6, v6
    v_fmac_f32 v33, v5, v5
    v_mov_b32 v5, v80
    v_lshlrev_b32 v6, 16, v5
    v_and_b32 v5, 0xffff0000, v5
    v_sub_f32 v6, v6, v30
    v_sub_f32 v5, v5, v30
    v_fmac_f32 v31, v6, v6
    v_fmac_f32 v33, v5, v5
    v_mov_b32 v5, v81
    v_lshlrev_b32 v6, 16, v5
    v_and_b32 v5, 0xffff0000, v5
    v_sub_f32 v6, v6, v30
    v_sub_f32 v5, v5, v30
    v_fmac_f32 v31, v6, v6
    v_fmac_f32 v33, v5, v5
    v_mov_b32 v5, v82
    v_lshlrev_b32 v6, 16, v5
    v_and_b32 v5, 0xffff0000, v5
    v_sub_f32 v6, v6, v30
    v_sub_f32 v5, v5, v30
    v_fmac_f32 v31, v6, v6
    v_fmac_f32 v33, v5, v5
    v_mov_b32 v5, v83
    v_lshlrev_b32 v6, 16, v5
    v_and_b32 v5, 0xffff0000, v5
    v_sub_f32 v6, v6, v30
    v_sub_f32 v5, v5, v30
    v_fmac_f32 v31, v6, v6
    v_fmac_f32 v33, v5, v5
    v_add_f32 v31, v31, v33
    s_nop 1
    v_add_f32_dpp v31, v31, v31 row_ror:8 row_mask:0xf bank_mask:0xf
    s_nop 1
    v_add_f32_dpp v31, v31, v31 row_ror:4 row_mask:0xf bank_mask:0xf
    s_nop 1
    v_add_f32_dpp v31, v31, v31 row_ror:2 row_mask:0xf bank_mask:0xf
    s_nop 1
    v_add_f32_dpp v31, v31, v31 row_ror:1 row_mask:0xf bank_mask:0xf
    v_mul_f32 v31, 0x3acccccd, v31
    v_cvt_pk_bf16_f32 v5, v30, v31
    v_lshlrev_b32 v30, 16, v5
    v_and_b32 v31, 0xffff0000, v5
    v_add_f32 v31, 0x3727c5ac, v31
    v_cvt_pk_bf16_f32 v5, v31, v31
    v_lshlrev_b32 v31, 16, v5
    v_sqrt_f32 v31, v31
    s_nop 0
    v_cvt_pk_bf16_f32 v5, v31, v31
    v_lshlrev_b32 v31, 16, v5
    v_rcp_f32 v31, v31
    s_nop 0
    s_mov_b32 exec_lo, 0x00010001
    s_mov_b32 exec_hi, 0x00010001
    global_store_dwordx2 v7, v[30:31], s[42:43] sc0 sc1
    s_mov_b64 exec, -1
    v_add_u32 v9, 5120, v9
    v_add_u32 v7, 32, v7
    s_sub_u32 s40, s40, 1
    s_cmp_lg_u32 s40, 0
    s_cbranch_scc1 L_k1_fb2
    v_lshrrev_b32 v6, 1, v8
    v_cmp_le_u32 vcc, 160, v6
    v_mov_b32 v11, s56
    v_mov_b32 v12, s57
    v_mov_b32 v13, s58
    v_mov_b32 v14, s59
    v_cndmask_b32 v11, v11, v13, vcc
    v_cndmask_b32 v12, v12, v14, vcc
    v_add_co_u32 v28, vcc, v11, v6
    v_addc_co_u32 v29, vcc, 0, v12, vcc
    v_mov_b32 v10, 0
    s_mov_b32 s40, 640

L_k1_fc2:
    global_load_ushort v11, v[28:29], off
    v_add_co_u32 v28, vcc, s49, v28
    v_addc_co_u32 v29, vcc, 0, v29, vcc
    s_waitcnt vmcnt(0)
    v_lshlrev_b32 v11, 16, v11
    v_add_f32 v10, v10, v11
    s_sub_u32 s40, s40, 1
    s_cmp_lg_u32 s40, 0
    s_cbranch_scc1 L_k1_fc2
    v_lshlrev_b32 v5, 3, v3
    global_load_dwordx2 v[30:31], v5, s[42:43] sc0 sc1
    s_waitcnt vmcnt(0)
    s_branch L_k1_csd2

L_k1_ok2:
    v_lshlrev_b32 v5, 3, v3
    global_load_dwordx2 v[30:31], v5, s[42:43] sc0 sc1

    global_load_dword v10, v8, s[54:55] offset:-2560 sc0 sc1
    global_load_dword v11, v8, s[54:55] offset:-1920 sc0 sc1
    global_load_dword v12, v8, s[54:55] offset:-1280 sc0 sc1
    global_load_dword v13, v8, s[54:55] offset:-640 sc0 sc1
    global_load_dword v14, v8, s[54:55] offset:0 sc0 sc1
    global_load_dword v15, v8, s[54:55] offset:640 sc0 sc1
    global_load_dword v16, v8, s[54:55] offset:1280 sc0 sc1
    global_load_dword v17, v8, s[54:55] offset:1920 sc0 sc1
L_k1_fast2:
    s_waitcnt vmcnt(0)
    v_add_f32 v10, v10, v11
    v_add_f32 v12, v12, v13
    v_add_f32 v14, v14, v15
    v_add_f32 v16, v16, v17
    v_add_f32 v10, v10, v12
    v_add_f32 v14, v14, v16
    v_add_f32 v10, v10, v14

L_k1_csd2:
    v_min_u32 v5, 255, v0
    v_lshlrev_b32 v5, 2, v5
    v_add_u32 v5, 147456, v5
    ds_write_b32 v5, v10
    s_waitcnt lgkmcnt(0)

L_k1_bar2:
    s_barrier
    v_lshlrev_b32 v5, 4, v4
    v_add_u32 v5, 147456, v5

    ds_read_b128 v[40:43], v5 offset:0
    ds_read_b128 v[44:47], v5 offset:32
    ds_read_b128 v[48:51], v5 offset:64
    ds_read_b128 v[52:55], v5 offset:96
    ds_read_b128 v[56:59], v5 offset:128
    ds_read_b128 v[60:63], v5 offset:160
    ds_read_b128 v[64:67], v5 offset:192
    ds_read_b128 v[68:71], v5 offset:224
    ds_read_b128 v[72:75], v5 offset:256
    ds_read_b128 v[76:79], v5 offset:288
    ds_read_b128 v[80:83], v5 offset:320
    ds_read_b128 v[84:87], v5 offset:352
    ds_read_b128 v[88:91], v5 offset:384
    ds_read_b128 v[92:95], v5 offset:416
    ds_read_b128 v[12:15], v5 offset:448
    ds_read_b128 v[16:19], v5 offset:480
    ds_read_b128 v[20:23], v5 offset:512
    ds_read_b128 v[24:27], v5 offset:544
    ds_read_b128 v[32:35], v5 offset:576
    ds_read_b128 v[36:39], v5 offset:608
    s_waitcnt lgkmcnt(0)
    s_lshl_b32 s28, s29, 4
    s_add_u32 s28, s28, 16797696
    v_lshrrev_b32 v5, 4, v3
    v_mul_u32_u24 v5, 69632, v5
    v_and_b32 v6, 15, v3
    v_lshl_add_u32 v5, v6, 4, v5
    v_lshl_add_u32 v5, v4, 8, v5
    s_mov_b32 s33, 0xbfb8aa3b

    s_cmp_lg_u32 s31, 0
    s_cbranch_scc1 L_k1_ffn_skip0

    v_pk_fma_f32 v[96:97], v[30:31], v[40:41], v[96:97] op_sel:[0,0,0] op_sel_hi:[0,1,1] neg_lo:[1,0,0] neg_hi:[1,0,0]
    v_pk_mul_f32 v[96:97], v[96:97], v[30:31] op_sel:[0,1] op_sel_hi:[1,1]
    v_pk_fma_f32 v[98:99], v[30:31], v[42:43], v[98:99] op_sel:[0,0,0] op_sel_hi:[0,1,1] neg_lo:[1,0,0] neg_hi:[1,0,0]
    v_pk_mul_f32 v[98:99], v[98:99], v[30:31] op_sel:[0,1] op_sel_hi:[1,1]
    v_pk_fma_f32 v[100:101], v[30:31], v[44:45], v[100:101] op_sel:[0,0,0] op_sel_hi:[0,1,1] neg_lo:[1,0,0] neg_hi:[1,0,0]
    v_pk_mul_f32 v[100:101], v[100:101], v[30:31] op_sel:[0,1] op_sel_hi:[1,1]
    v_pk_fma_f32 v[102:103], v[30:31], v[46:47], v[102:103] op_sel:[0,0,0] op_sel_hi:[0,1,1] neg_lo:[1,0,0] neg_hi:[1,0,0]
    v_pk_mul_f32 v[102:103], v[102:103], v[30:31] op_sel:[0,1] op_sel_hi:[1,1]
    v_pk_fma_f32 v[104:105], v[30:31], v[48:49], v[104:105] op_sel:[0,0,0] op_sel_hi:[0,1,1] neg_lo:[1,0,0] neg_hi:[1,0,0]
    v_pk_mul_f32 v[104:105], v[104:105], v[30:31] op_sel:[0,1] op_sel_hi:[1,1]
    v_pk_fma_f32 v[106:107], v[30:31], v[50:51], v[106:107] op_sel:[0,0,0] op_sel_hi:[0,1,1] neg_lo:[1,0,0] neg_hi:[1,0,0]
    v_pk_mul_f32 v[106:107], v[106:107], v[30:31] op_sel:[0,1] op_sel_hi:[1,1]
    v_pk_fma_f32 v[108:109], v[30:31], v[52:53], v[108:109] op_sel:[0,0,0] op_sel_hi:[0,1,1] neg_lo:[1,0,0] neg_hi:[1,0,0]
    v_pk_mul_f32 v[108:109], v[108:109], v[30:31] op_sel:[0,1] op_sel_hi:[1,1]
    v_pk_fma_f32 v[110:111], v[30:31], v[54:55], v[110:111] op_sel:[0,0,0] op_sel_hi:[0,1,1] neg_lo:[1,0,0] neg_hi:[1,0,0]
    v_pk_mul_f32 v[110:111], v[110:111], v[30:31] op_sel:[0,1] op_sel_hi:[1,1]
    v_pk_mul_f32 v[104:105], v[96:97], v[104:105]
    v_pk_mul_f32 v[106:107], v[98:99], v[106:107]
    v_pk_mul_f32 v[108:109], v[100:101], v[108:109]
    v_pk_mul_f32 v[110:111], v[102:103], v[110:111]
    v_mul_f32 v96, s33, v96
    v_mul_f32 v97, s33, v97
    v_mul_f32 v98, s33, v98
    v_mul_f32 v99, s33, v99
    v_mul_f32 v100, s33, v100
    v_mul_f32 v101, s33, v101
    v_mul_f32 v102, s33, v102
    v_mul_f32 v103, s33, v103
    v_exp_f32 v96, v96
    v_exp_f32 v97, v97
    v_exp_f32 v98, v98
    v_exp_f32 v99, v99
    v_exp_f32 v100, v100
    v_exp_f32 v101, v101
    v_exp_f32 v102, v102
    v_exp_f32 v103, v103
    s_nop 0
    v_add_f32 v96, 1.0, v96
    v_add_f32 v97, 1.0, v97
    v_add_f32 v98, 1.0, v98
    v_add_f32 v99, 1.0, v99
    v_add_f32 v100, 1.0, v100
    v_add_f32 v101, 1.0, v101
    v_add_f32 v102, 1.0, v102
    v_add_f32 v103, 1.0, v103
    v_rcp_f32 v96, v96
    v_rcp_f32 v97, v97
    v_rcp_f32 v98, v98
    v_rcp_f32 v99, v99
    v_rcp_f32 v100, v100
    v_rcp_f32 v101, v101
    v_rcp_f32 v102, v102
    v_rcp_f32 v103, v103
    s_nop 0
    v_pk_mul_f32 v[104:105], v[96:97], v[104:105]
    v_pk_mul_f32 v[106:107], v[98:99], v[106:107]
    v_pk_mul_f32 v[108:109], v[100:101], v[108:109]
    v_pk_mul_f32 v[110:111], v[102:103], v[110:111]
    v_cvt_pk_bf16_f32 v96, v104, v105
    v_cvt_pk_bf16_f32 v97, v106, v107
    v_cvt_pk_bf16_f32 v98, v108, v109
    v_cvt_pk_bf16_f32 v99, v110, v111
    s_nop 1
    v_permlane32_swap_b32 v96, v98
    v_permlane32_swap_b32 v97, v99
    buffer_store_dwordx4 v[96:99], v5, s[8:11], s28 offen offset:0 sc1
L_k1_ffn_skip0:
    v_pk_fma_f32 v[112:113], v[30:31], v[56:57], v[112:113] op_sel:[0,0,0] op_sel_hi:[0,1,1] neg_lo:[1,0,0] neg_hi:[1,0,0]
    v_pk_mul_f32 v[112:113], v[112:113], v[30:31] op_sel:[0,1] op_sel_hi:[1,1]
    v_pk_fma_f32 v[114:115], v[30:31], v[58:59], v[114:115] op_sel:[0,0,0] op_sel_hi:[0,1,1] neg_lo:[1,0,0] neg_hi:[1,0,0]
    v_pk_mul_f32 v[114:115], v[114:115], v[30:31] op_sel:[0,1] op_sel_hi:[1,1]
    v_pk_fma_f32 v[116:117], v[30:31], v[60:61], v[116:117] op_sel:[0,0,0] op_sel_hi:[0,1,1] neg_lo:[1,0,0] neg_hi:[1,0,0]
    v_pk_mul_f32 v[116:117], v[116:117], v[30:31] op_sel:[0,1] op_sel_hi:[1,1]
    v_pk_fma_f32 v[118:119], v[30:31], v[62:63], v[118:119] op_sel:[0,0,0] op_sel_hi:[0,1,1] neg_lo:[1,0,0] neg_hi:[1,0,0]
    v_pk_mul_f32 v[118:119], v[118:119], v[30:31] op_sel:[0,1] op_sel_hi:[1,1]
    v_pk_fma_f32 v[120:121], v[30:31], v[64:65], v[120:121] op_sel:[0,0,0] op_sel_hi:[0,1,1] neg_lo:[1,0,0] neg_hi:[1,0,0]
    v_pk_mul_f32 v[120:121], v[120:121], v[30:31] op_sel:[0,1] op_sel_hi:[1,1]
    v_pk_fma_f32 v[122:123], v[30:31], v[66:67], v[122:123] op_sel:[0,0,0] op_sel_hi:[0,1,1] neg_lo:[1,0,0] neg_hi:[1,0,0]
    v_pk_mul_f32 v[122:123], v[122:123], v[30:31] op_sel:[0,1] op_sel_hi:[1,1]
    v_pk_fma_f32 v[124:125], v[30:31], v[68:69], v[124:125] op_sel:[0,0,0] op_sel_hi:[0,1,1] neg_lo:[1,0,0] neg_hi:[1,0,0]
    v_pk_mul_f32 v[124:125], v[124:125], v[30:31] op_sel:[0,1] op_sel_hi:[1,1]
    v_pk_fma_f32 v[126:127], v[30:31], v[70:71], v[126:127] op_sel:[0,0,0] op_sel_hi:[0,1,1] neg_lo:[1,0,0] neg_hi:[1,0,0]
    v_pk_mul_f32 v[126:127], v[126:127], v[30:31] op_sel:[0,1] op_sel_hi:[1,1]
    v_pk_mul_f32 v[120:121], v[112:113], v[120:121]
    v_pk_mul_f32 v[122:123], v[114:115], v[122:123]
    v_pk_mul_f32 v[124:125], v[116:117], v[124:125]
    v_pk_mul_f32 v[126:127], v[118:119], v[126:127]
    v_mul_f32 v112, s33, v112
    v_mul_f32 v113, s33, v113
    v_mul_f32 v114, s33, v114
    v_mul_f32 v115, s33, v115
    v_mul_f32 v116, s33, v116
    v_mul_f32 v117, s33, v117
    v_mul_f32 v118, s33, v118
    v_mul_f32 v119, s33, v119
    v_exp_f32 v112, v112
    v_exp_f32 v113, v113
    v_exp_f32 v114, v114
    v_exp_f32 v115, v115
    v_exp_f32 v116, v116
    v_exp_f32 v117, v117
    v_exp_f32 v118, v118
    v_exp_f32 v119, v119
    s_nop 0
    v_add_f32 v112, 1.0, v112
    v_add_f32 v113, 1.0, v113
    v_add_f32 v114, 1.0, v114
    v_add_f32 v115, 1.0, v115
    v_add_f32 v116, 1.0, v116
    v_add_f32 v117, 1.0, v117
    v_add_f32 v118, 1.0, v118
    v_add_f32 v119, 1.0, v119
    v_rcp_f32 v112, v112
    v_rcp_f32 v113, v113
    v_rcp_f32 v114, v114
    v_rcp_f32 v115, v115
    v_rcp_f32 v116, v116
    v_rcp_f32 v117, v117
    v_rcp_f32 v118, v118
    v_rcp_f32 v119, v119
    s_nop 0
    v_pk_mul_f32 v[120:121], v[112:113], v[120:121]
    v_pk_mul_f32 v[122:123], v[114:115], v[122:123]
    v_pk_mul_f32 v[124:125], v[116:117], v[124:125]
    v_pk_mul_f32 v[126:127], v[118:119], v[126:127]
    v_cvt_pk_bf16_f32 v112, v120, v121
    v_cvt_pk_bf16_f32 v113, v122, v123
    v_cvt_pk_bf16_f32 v114, v124, v125
    v_cvt_pk_bf16_f32 v115, v126, v127
    s_nop 1
    v_permlane32_swap_b32 v112, v114
    v_permlane32_swap_b32 v113, v115
    buffer_store_dwordx4 v[112:115], v5, s[8:11], s28 offen offset:512 sc1
    v_pk_fma_f32 v[128:129], v[30:31], v[72:73], v[128:129] op_sel:[0,0,0] op_sel_hi:[0,1,1] neg_lo:[1,0,0] neg_hi:[1,0,0]
    v_pk_mul_f32 v[128:129], v[128:129], v[30:31] op_sel:[0,1] op_sel_hi:[1,1]
    v_pk_fma_f32 v[130:131], v[30:31], v[74:75], v[130:131] op_sel:[0,0,0] op_sel_hi:[0,1,1] neg_lo:[1,0,0] neg_hi:[1,0,0]
    v_pk_mul_f32 v[130:131], v[130:131], v[30:31] op_sel:[0,1] op_sel_hi:[1,1]
    v_pk_fma_f32 v[132:133], v[30:31], v[76:77], v[132:133] op_sel:[0,0,0] op_sel_hi:[0,1,1] neg_lo:[1,0,0] neg_hi:[1,0,0]
    v_pk_mul_f32 v[132:133], v[132:133], v[30:31] op_sel:[0,1] op_sel_hi:[1,1]
    v_pk_fma_f32 v[134:135], v[30:31], v[78:79], v[134:135] op_sel:[0,0,0] op_sel_hi:[0,1,1] neg_lo:[1,0,0] neg_hi:[1,0,0]
    v_pk_mul_f32 v[134:135], v[134:135], v[30:31] op_sel:[0,1] op_sel_hi:[1,1]
    v_pk_fma_f32 v[136:137], v[30:31], v[80:81], v[136:137] op_sel:[0,0,0] op_sel_hi:[0,1,1] neg_lo:[1,0,0] neg_hi:[1,0,0]
    v_pk_mul_f32 v[136:137], v[136:137], v[30:31] op_sel:[0,1] op_sel_hi:[1,1]
    v_pk_fma_f32 v[138:139], v[30:31], v[82:83], v[138:139] op_sel:[0,0,0] op_sel_hi:[0,1,1] neg_lo:[1,0,0] neg_hi:[1,0,0]
    v_pk_mul_f32 v[138:139], v[138:139], v[30:31] op_sel:[0,1] op_sel_hi:[1,1]
    v_pk_fma_f32 v[140:141], v[30:31], v[84:85], v[140:141] op_sel:[0,0,0] op_sel_hi:[0,1,1] neg_lo:[1,0,0] neg_hi:[1,0,0]
    v_pk_mul_f32 v[140:141], v[140:141], v[30:31] op_sel:[0,1] op_sel_hi:[1,1]
    v_pk_fma_f32 v[142:143], v[30:31], v[86:87], v[142:143] op_sel:[0,0,0] op_sel_hi:[0,1,1] neg_lo:[1,0,0] neg_hi:[1,0,0]
    v_pk_mul_f32 v[142:143], v[142:143], v[30:31] op_sel:[0,1] op_sel_hi:[1,1]
    v_pk_mul_f32 v[136:137], v[128:129], v[136:137]
    v_pk_mul_f32 v[138:139], v[130:131], v[138:139]
    v_pk_mul_f32 v[140:141], v[132:133], v[140:141]
    v_pk_mul_f32 v[142:143], v[134:135], v[142:143]
    v_mul_f32 v128, s33, v128
    v_mul_f32 v129, s33, v129
    v_mul_f32 v130, s33, v130
    v_mul_f32 v131, s33, v131
    v_mul_f32 v132, s33, v132
    v_mul_f32 v133, s33, v133
    v_mul_f32 v134, s33, v134
    v_mul_f32 v135, s33, v135
    v_exp_f32 v128, v128
    v_exp_f32 v129, v129
    v_exp_f32 v130, v130
    v_exp_f32 v131, v131
    v_exp_f32 v132, v132
    v_exp_f32 v133, v133
    v_exp_f32 v134, v134
    v_exp_f32 v135, v135
    s_nop 0
    v_add_f32 v128, 1.0, v128
    v_add_f32 v129, 1.0, v129
    v_add_f32 v130, 1.0, v130
    v_add_f32 v131, 1.0, v131
    v_add_f32 v132, 1.0, v132
    v_add_f32 v133, 1.0, v133
    v_add_f32 v134, 1.0, v134
    v_add_f32 v135, 1.0, v135
    v_rcp_f32 v128, v128
    v_rcp_f32 v129, v129
    v_rcp_f32 v130, v130
    v_rcp_f32 v131, v131
    v_rcp_f32 v132, v132
    v_rcp_f32 v133, v133
    v_rcp_f32 v134, v134
    v_rcp_f32 v135, v135
    s_nop 0
    v_pk_mul_f32 v[136:137], v[128:129], v[136:137]
    v_pk_mul_f32 v[138:139], v[130:131], v[138:139]
    v_pk_mul_f32 v[140:141], v[132:133], v[140:141]
    v_pk_mul_f32 v[142:143], v[134:135], v[142:143]
    v_cvt_pk_bf16_f32 v128, v136, v137
    v_cvt_pk_bf16_f32 v129, v138, v139
    v_cvt_pk_bf16_f32 v130, v140, v141
    v_cvt_pk_bf16_f32 v131, v142, v143
    s_nop 1
    v_permlane32_swap_b32 v128, v130
    v_permlane32_swap_b32 v129, v131
    buffer_store_dwordx4 v[128:131], v5, s[8:11], s28 offen offset:1024 sc1
    v_pk_fma_f32 v[144:145], v[30:31], v[88:89], v[144:145] op_sel:[0,0,0] op_sel_hi:[0,1,1] neg_lo:[1,0,0] neg_hi:[1,0,0]
    v_pk_mul_f32 v[144:145], v[144:145], v[30:31] op_sel:[0,1] op_sel_hi:[1,1]
    v_pk_fma_f32 v[146:147], v[30:31], v[90:91], v[146:147] op_sel:[0,0,0] op_sel_hi:[0,1,1] neg_lo:[1,0,0] neg_hi:[1,0,0]
    v_pk_mul_f32 v[146:147], v[146:147], v[30:31] op_sel:[0,1] op_sel_hi:[1,1]
    v_pk_fma_f32 v[148:149], v[30:31], v[92:93], v[148:149] op_sel:[0,0,0] op_sel_hi:[0,1,1] neg_lo:[1,0,0] neg_hi:[1,0,0]
    v_pk_mul_f32 v[148:149], v[148:149], v[30:31] op_sel:[0,1] op_sel_hi:[1,1]
    v_pk_fma_f32 v[150:151], v[30:31], v[94:95], v[150:151] op_sel:[0,0,0] op_sel_hi:[0,1,1] neg_lo:[1,0,0] neg_hi:[1,0,0]
    v_pk_mul_f32 v[150:151], v[150:151], v[30:31] op_sel:[0,1] op_sel_hi:[1,1]
    v_pk_fma_f32 v[152:153], v[30:31], v[12:13], v[152:153] op_sel:[0,0,0] op_sel_hi:[0,1,1] neg_lo:[1,0,0] neg_hi:[1,0,0]
    v_pk_mul_f32 v[152:153], v[152:153], v[30:31] op_sel:[0,1] op_sel_hi:[1,1]
    v_pk_fma_f32 v[154:155], v[30:31], v[14:15], v[154:155] op_sel:[0,0,0] op_sel_hi:[0,1,1] neg_lo:[1,0,0] neg_hi:[1,0,0]
    v_pk_mul_f32 v[154:155], v[154:155], v[30:31] op_sel:[0,1] op_sel_hi:[1,1]
    v_pk_fma_f32 v[156:157], v[30:31], v[16:17], v[156:157] op_sel:[0,0,0] op_sel_hi:[0,1,1] neg_lo:[1,0,0] neg_hi:[1,0,0]
    v_pk_mul_f32 v[156:157], v[156:157], v[30:31] op_sel:[0,1] op_sel_hi:[1,1]
    v_pk_fma_f32 v[158:159], v[30:31], v[18:19], v[158:159] op_sel:[0,0,0] op_sel_hi:[0,1,1] neg_lo:[1,0,0] neg_hi:[1,0,0]
    v_pk_mul_f32 v[158:159], v[158:159], v[30:31] op_sel:[0,1] op_sel_hi:[1,1]
    v_pk_mul_f32 v[152:153], v[144:145], v[152:153]
    v_pk_mul_f32 v[154:155], v[146:147], v[154:155]
    v_pk_mul_f32 v[156:157], v[148:149], v[156:157]
    v_pk_mul_f32 v[158:159], v[150:151], v[158:159]
    v_mul_f32 v144, s33, v144
    v_mul_f32 v145, s33, v145
    v_mul_f32 v146, s33, v146
    v_mul_f32 v147, s33, v147
    v_mul_f32 v148, s33, v148
    v_mul_f32 v149, s33, v149
    v_mul_f32 v150, s33, v150
    v_mul_f32 v151, s33, v151
    v_exp_f32 v144, v144
    v_exp_f32 v145, v145
    v_exp_f32 v146, v146
    v_exp_f32 v147, v147
    v_exp_f32 v148, v148
    v_exp_f32 v149, v149
    v_exp_f32 v150, v150
    v_exp_f32 v151, v151
    s_nop 0
    v_add_f32 v144, 1.0, v144
    v_add_f32 v145, 1.0, v145
    v_add_f32 v146, 1.0, v146
    v_add_f32 v147, 1.0, v147
    v_add_f32 v148, 1.0, v148
    v_add_f32 v149, 1.0, v149
    v_add_f32 v150, 1.0, v150
    v_add_f32 v151, 1.0, v151
    v_rcp_f32 v144, v144
    v_rcp_f32 v145, v145
    v_rcp_f32 v146, v146
    v_rcp_f32 v147, v147
    v_rcp_f32 v148, v148
    v_rcp_f32 v149, v149
    v_rcp_f32 v150, v150
    v_rcp_f32 v151, v151
    s_nop 0
    v_pk_mul_f32 v[152:153], v[144:145], v[152:153]
    v_pk_mul_f32 v[154:155], v[146:147], v[154:155]
    v_pk_mul_f32 v[156:157], v[148:149], v[156:157]
    v_pk_mul_f32 v[158:159], v[150:151], v[158:159]
    v_cvt_pk_bf16_f32 v144, v152, v153
    v_cvt_pk_bf16_f32 v145, v154, v155
    v_cvt_pk_bf16_f32 v146, v156, v157
    v_cvt_pk_bf16_f32 v147, v158, v159
    s_nop 1
    v_permlane32_swap_b32 v144, v146
    v_permlane32_swap_b32 v145, v147
    buffer_store_dwordx4 v[144:147], v5, s[8:11], s28 offen offset:1536 sc1
    v_pk_fma_f32 v[160:161], v[30:31], v[20:21], v[160:161] op_sel:[0,0,0] op_sel_hi:[0,1,1] neg_lo:[1,0,0] neg_hi:[1,0,0]
    v_pk_mul_f32 v[160:161], v[160:161], v[30:31] op_sel:[0,1] op_sel_hi:[1,1]
    v_pk_fma_f32 v[162:163], v[30:31], v[22:23], v[162:163] op_sel:[0,0,0] op_sel_hi:[0,1,1] neg_lo:[1,0,0] neg_hi:[1,0,0]
    v_pk_mul_f32 v[162:163], v[162:163], v[30:31] op_sel:[0,1] op_sel_hi:[1,1]
    v_pk_fma_f32 v[164:165], v[30:31], v[24:25], v[164:165] op_sel:[0,0,0] op_sel_hi:[0,1,1] neg_lo:[1,0,0] neg_hi:[1,0,0]
    v_pk_mul_f32 v[164:165], v[164:165], v[30:31] op_sel:[0,1] op_sel_hi:[1,1]
    v_pk_fma_f32 v[166:167], v[30:31], v[26:27], v[166:167] op_sel:[0,0,0] op_sel_hi:[0,1,1] neg_lo:[1,0,0] neg_hi:[1,0,0]
    v_pk_mul_f32 v[166:167], v[166:167], v[30:31] op_sel:[0,1] op_sel_hi:[1,1]
    v_pk_fma_f32 v[168:169], v[30:31], v[32:33], v[168:169] op_sel:[0,0,0] op_sel_hi:[0,1,1] neg_lo:[1,0,0] neg_hi:[1,0,0]
    v_pk_mul_f32 v[168:169], v[168:169], v[30:31] op_sel:[0,1] op_sel_hi:[1,1]
    v_pk_fma_f32 v[170:171], v[30:31], v[34:35], v[170:171] op_sel:[0,0,0] op_sel_hi:[0,1,1] neg_lo:[1,0,0] neg_hi:[1,0,0]
    v_pk_mul_f32 v[170:171], v[170:171], v[30:31] op_sel:[0,1] op_sel_hi:[1,1]
    v_pk_fma_f32 v[172:173], v[30:31], v[36:37], v[172:173] op_sel:[0,0,0] op_sel_hi:[0,1,1] neg_lo:[1,0,0] neg_hi:[1,0,0]
    v_pk_mul_f32 v[172:173], v[172:173], v[30:31] op_sel:[0,1] op_sel_hi:[1,1]
    v_pk_fma_f32 v[174:175], v[30:31], v[38:39], v[174:175] op_sel:[0,0,0] op_sel_hi:[0,1,1] neg_lo:[1,0,0] neg_hi:[1,0,0]
    v_pk_mul_f32 v[174:175], v[174:175], v[30:31] op_sel:[0,1] op_sel_hi:[1,1]
    v_pk_mul_f32 v[168:169], v[160:161], v[168:169]
    v_pk_mul_f32 v[170:171], v[162:163], v[170:171]
    v_pk_mul_f32 v[172:173], v[164:165], v[172:173]
    v_pk_mul_f32 v[174:175], v[166:167], v[174:175]
    v_mul_f32 v160, s33, v160
    v_mul_f32 v161, s33, v161
    v_mul_f32 v162, s33, v162
    v_mul_f32 v163, s33, v163
    v_mul_f32 v164, s33, v164
    v_mul_f32 v165, s33, v165
    v_mul_f32 v166, s33, v166
    v_mul_f32 v167, s33, v167
    v_exp_f32 v160, v160
    v_exp_f32 v161, v161
    v_exp_f32 v162, v162
    v_exp_f32 v163, v163
    v_exp_f32 v164, v164
    v_exp_f32 v165, v165
    v_exp_f32 v166, v166
    v_exp_f32 v167, v167
    s_nop 0
    v_add_f32 v160, 1.0, v160
    v_add_f32 v161, 1.0, v161
    v_add_f32 v162, 1.0, v162
    v_add_f32 v163, 1.0, v163
    v_add_f32 v164, 1.0, v164
    v_add_f32 v165, 1.0, v165
    v_add_f32 v166, 1.0, v166
    v_add_f32 v167, 1.0, v167
    v_rcp_f32 v160, v160
    v_rcp_f32 v161, v161
    v_rcp_f32 v162, v162
    v_rcp_f32 v163, v163
    v_rcp_f32 v164, v164
    v_rcp_f32 v165, v165
    v_rcp_f32 v166, v166
    v_rcp_f32 v167, v167
    s_nop 0
    v_pk_mul_f32 v[168:169], v[160:161], v[168:169]
    v_pk_mul_f32 v[170:171], v[162:163], v[170:171]
    v_pk_mul_f32 v[172:173], v[164:165], v[172:173]
    v_pk_mul_f32 v[174:175], v[166:167], v[174:175]
    v_cvt_pk_bf16_f32 v160, v168, v169
    v_cvt_pk_bf16_f32 v161, v170, v171
    v_cvt_pk_bf16_f32 v162, v172, v173
    v_cvt_pk_bf16_f32 v163, v174, v175
    s_nop 1
    v_permlane32_swap_b32 v160, v162
    v_permlane32_swap_b32 v161, v163
    buffer_store_dwordx4 v[160:163], v5, s[8:11], s28 offen offset:2048 sc1
    s_branch L_k1_end
L_k1_main_v:
    s_waitcnt vmcnt(25)
    s_barrier
    s_waitcnt vmcnt(21)
    ds_read_b128 a[0:3], v50 offset:0
    ds_read_b128 a[4:7], v51 offset:0
    ds_read_b128 a[8:11], v52 offset:0
    ds_read_b128 a[12:15], v53 offset:0
    ds_read_b64_tr_b16 v[64:65], v54 offset:0
    ds_read_b64_tr_b16 v[66:67], v54 offset:1280
    ds_read_b64_tr_b16 v[68:69], v54 offset:32
    ds_read_b64_tr_b16 v[70:71], v54 offset:1312
    ds_read_b64_tr_b16 v[72:73], v54 offset:64
    ds_read_b64_tr_b16 v[74:75], v54 offset:1344
    ds_read_b64_tr_b16 v[76:77], v54 offset:96
    ds_read_b64_tr_b16 v[78:79], v54 offset:1376
    s_waitcnt lgkmcnt(8)
    ds_read_b64_tr_b16 v[80:81], v54 offset:128
    ds_read_b64_tr_b16 v[82:83], v54 offset:1408
    s_waitcnt lgkmcnt(8)
    v_mfma_f32_32x32x16_bf16 v[96:111], a[0:3], v[64:67], 0
    s_add_u32 m0, s21, 20480
    s_nop 0
    global_load_lds_dwordx4 v[40:41], off
    v_add_co_u32 v40, vcc, s20, v40
    v_addc_co_u32 v41, vcc, 0, v41, vcc
    ds_read_b64_tr_b16 v[84:85], v55 offset:0
    ds_read_b64_tr_b16 v[86:87], v55 offset:1280
    s_waitcnt lgkmcnt(8)
    v_mfma_f32_32x32x16_bf16 v[112:127], a[0:3], v[68:71], 0
    s_add_u32 m0, s21, 21504
    s_nop 0
    global_load_lds_dwordx4 v[42:43], off
    v_add_co_u32 v42, vcc, s20, v42
    v_addc_co_u32 v43, vcc, 0, v43, vcc
    ds_read_b64_tr_b16 v[64:65], v55 offset:32
    ds_read_b64_tr_b16 v[66:67], v55 offset:1312
    s_waitcnt lgkmcnt(8)
    v_mfma_f32_32x32x16_bf16 v[128:143], a[0:3], v[72:75], 0
    s_add_u32 m0, s21, 22528
    s_mov_b32 exec_hi, 0
    global_load_lds_dwordx4 v[44:45], off
    s_mov_b32 exec_hi, -1
    v_add_co_u32 v44, vcc, s20, v44
    v_addc_co_u32 v45, vcc, 0, v45, vcc
    ds_read_b64_tr_b16 v[68:69], v55 offset:64
    ds_read_b64_tr_b16 v[70:71], v55 offset:1344
    s_waitcnt lgkmcnt(8)
    v_mfma_f32_32x32x16_bf16 v[144:159], a[0:3], v[76:79], 0
    s_add_u32 m0, s34, 4096
    s_nop 0
    global_load_lds_dwordx4 v46, s[4:5]
    ds_read_b64_tr_b16 v[72:73], v55 offset:96
    ds_read_b64_tr_b16 v[74:75], v55 offset:1376
    s_waitcnt lgkmcnt(8)
    v_mfma_f32_32x32x16_bf16 v[160:175], a[0:3], v[80:83], 0
    s_add_u32 m0, s34, 5120
    s_nop 0
    global_load_lds_dwordx4 v47, s[4:5]
    ds_read_b64_tr_b16 v[76:77], v55 offset:128
    ds_read_b64_tr_b16 v[78:79], v55 offset:1408
    s_waitcnt lgkmcnt(8)
    v_mfma_f32_32x32x16_bf16 v[96:111], a[4:7], v[84:87], v[96:111]
    s_add_u32 m0, s34, 6144
    s_nop 0
    global_load_lds_dwordx4 v48, s[4:5]
    ds_read_b64_tr_b16 v[80:81], v56 offset:0
    ds_read_b64_tr_b16 v[82:83], v56 offset:1280
    s_waitcnt lgkmcnt(8)
    v_mfma_f32_32x32x16_bf16 v[112:127], a[4:7], v[64:67], v[112:127]
    s_add_u32 m0, s34, 7168
    s_nop 0
    global_load_lds_dwordx4 v49, s[4:5]
    s_add_u32 s4, s4, 128
    s_addc_u32 s5, s5, 0
    ds_read_b64_tr_b16 v[84:85], v56 offset:32
    ds_read_b64_tr_b16 v[86:87], v56 offset:1312
    s_waitcnt lgkmcnt(8)
    v_mfma_f32_32x32x16_bf16 v[128:143], a[4:7], v[68:71], v[128:143]
    s_add_u32 m0, s21, 40960
    s_nop 0
    global_load_lds_dwordx4 v[40:41], off
    v_add_co_u32 v40, vcc, s20, v40
    v_addc_co_u32 v41, vcc, 0, v41, vcc
    ds_read_b64_tr_b16 v[64:65], v56 offset:64
    ds_read_b64_tr_b16 v[66:67], v56 offset:1344
    s_waitcnt lgkmcnt(8)
    v_mfma_f32_32x32x16_bf16 v[144:159], a[4:7], v[72:75], v[144:159]
    s_add_u32 m0, s21, 41984
    s_nop 0
    global_load_lds_dwordx4 v[42:43], off
    v_add_co_u32 v42, vcc, s20, v42
    v_addc_co_u32 v43, vcc, 0, v43, vcc
    ds_read_b64_tr_b16 v[68:69], v56 offset:96
    ds_read_b64_tr_b16 v[70:71], v56 offset:1376
    s_waitcnt lgkmcnt(8)
    v_mfma_f32_32x32x16_bf16 v[160:175], a[4:7], v[76:79], v[160:175]
    s_add_u32 m0, s21, 43008
    s_mov_b32 exec_hi, 0
    global_load_lds_dwordx4 v[44:45], off
    s_mov_b32 exec_hi, -1
    v_add_co_u32 v44, vcc, s20, v44
    v_addc_co_u32 v45, vcc, 0, v45, vcc
    ds_read_b64_tr_b16 v[72:73], v56 offset:128
    ds_read_b64_tr_b16 v[74:75], v56 offset:1408
    s_waitcnt lgkmcnt(8)
    v_mfma_f32_32x32x16_bf16 v[96:111], a[8:11], v[80:83], v[96:111]
    s_add_u32 m0, s34, 0
    s_nop 0
    global_load_lds_dwordx4 v46, s[4:5]
    ds_read_b64_tr_b16 v[76:77], v57 offset:0
    ds_read_b64_tr_b16 v[78:79], v57 offset:1280
    s_waitcnt lgkmcnt(8)
    v_mfma_f32_32x32x16_bf16 v[112:127], a[8:11], v[84:87], v[112:127]
    s_add_u32 m0, s34, 1024
    s_nop 0
    global_load_lds_dwordx4 v47, s[4:5]
    ds_read_b64_tr_b16 v[80:81], v57 offset:32
    ds_read_b64_tr_b16 v[82:83], v57 offset:1312
    s_waitcnt lgkmcnt(8)
    v_mfma_f32_32x32x16_bf16 v[128:143], a[8:11], v[64:67], v[128:143]
    s_add_u32 m0, s34, 2048
    s_nop 0
    global_load_lds_dwordx4 v48, s[4:5]
    ds_read_b64_tr_b16 v[84:85], v57 offset:64
    ds_read_b64_tr_b16 v[86:87], v57 offset:1344
    s_waitcnt lgkmcnt(8)
    v_mfma_f32_32x32x16_bf16 v[144:159], a[8:11], v[68:71], v[144:159]
    s_add_u32 m0, s34, 3072
    s_nop 0
    global_load_lds_dwordx4 v49, s[4:5]
    s_add_u32 s4, s4, 128
    s_addc_u32 s5, s5, 0
    ds_read_b64_tr_b16 v[64:65], v57 offset:96
    ds_read_b64_tr_b16 v[66:67], v57 offset:1376
    s_waitcnt vmcnt(7)
    s_barrier
    s_waitcnt lgkmcnt(8)
    v_mfma_f32_32x32x16_bf16 v[160:175], a[8:11], v[72:75], v[160:175]
    ds_read_b64_tr_b16 v[68:69], v57 offset:128
    ds_read_b64_tr_b16 v[70:71], v57 offset:1408
    s_waitcnt lgkmcnt(8)
    v_mfma_f32_32x32x16_bf16 v[96:111], a[12:15], v[76:79], v[96:111]
    ds_read_b128 a[16:19], v50 offset:4096
    s_add_u32 m0, s21, 61440
    s_nop 0
    global_load_lds_dwordx4 v[40:41], off
    v_add_co_u32 v40, vcc, s20, v40
    v_addc_co_u32 v41, vcc, 0, v41, vcc
    ds_read_b64_tr_b16 v[72:73], v54 offset:20480
    ds_read_b64_tr_b16 v[74:75], v54 offset:21760
    s_waitcnt lgkmcnt(9)
    v_mfma_f32_32x32x16_bf16 v[112:127], a[12:15], v[80:83], v[112:127]
    ds_read_b128 a[20:23], v51 offset:4096
    ds_read_b64_tr_b16 v[76:77], v54 offset:20512
    ds_read_b64_tr_b16 v[78:79], v54 offset:21792
    s_waitcnt lgkmcnt(10)
    v_mfma_f32_32x32x16_bf16 v[128:143], a[12:15], v[84:87], v[128:143]
    ds_read_b128 a[24:27], v52 offset:4096
    s_add_u32 m0, s21, 62464
    s_nop 0
    global_load_lds_dwordx4 v[42:43], off
    v_add_co_u32 v42, vcc, s20, v42
    v_addc_co_u32 v43, vcc, 0, v43, vcc
    ds_read_b64_tr_b16 v[80:81], v54 offset:20544
    ds_read_b64_tr_b16 v[82:83], v54 offset:21824
    s_waitcnt lgkmcnt(11)
    v_mfma_f32_32x32x16_bf16 v[144:159], a[12:15], v[64:67], v[144:159]
    ds_read_b128 a[28:31], v53 offset:4096
    ds_read_b64_tr_b16 v[84:85], v54 offset:20576
    ds_read_b64_tr_b16 v[86:87], v54 offset:21856
    s_waitcnt lgkmcnt(12)
    v_mfma_f32_32x32x16_bf16 v[160:175], a[12:15], v[68:71], v[160:175]
    s_add_u32 m0, s21, 63488
    s_mov_b32 exec_hi, 0
    global_load_lds_dwordx4 v[44:45], off
    s_mov_b32 exec_hi, -1
    v_add_co_u32 v44, vcc, s20, v44
    v_addc_co_u32 v45, vcc, 0, v45, vcc
    ds_read_b64_tr_b16 v[64:65], v54 offset:20608
    ds_read_b64_tr_b16 v[66:67], v54 offset:21888
    s_waitcnt lgkmcnt(4)
    v_mfma_f32_32x32x16_bf16 v[96:111], a[16:19], v[72:75], v[96:111]
    s_add_u32 m0, s34, 4096
    s_nop 0
    global_load_lds_dwordx4 v46, s[4:5]
    ds_read_b64_tr_b16 v[68:69], v55 offset:20480
    ds_read_b64_tr_b16 v[70:71], v55 offset:21760
    v_mfma_f32_32x32x16_bf16 v[112:127], a[16:19], v[76:79], v[112:127]
    s_add_u32 m0, s34, 5120
    s_nop 0
    global_load_lds_dwordx4 v47, s[4:5]
    ds_read_b64_tr_b16 v[72:73], v55 offset:20512
    ds_read_b64_tr_b16 v[74:75], v55 offset:21792
    v_mfma_f32_32x32x16_bf16 v[128:143], a[16:19], v[80:83], v[128:143]
    s_add_u32 m0, s34, 6144
    s_nop 0
    global_load_lds_dwordx4 v48, s[4:5]
    ds_read_b64_tr_b16 v[76:77], v55 offset:20544
    ds_read_b64_tr_b16 v[78:79], v55 offset:21824
    s_waitcnt lgkmcnt(8)
    v_mfma_f32_32x32x16_bf16 v[144:159], a[16:19], v[84:87], v[144:159]
    s_add_u32 m0, s34, 7168
    s_nop 0
    global_load_lds_dwordx4 v49, s[4:5]
    s_add_u32 s4, s4, 128
    s_addc_u32 s5, s5, 0
    ds_read_b64_tr_b16 v[80:81], v55 offset:20576
    ds_read_b64_tr_b16 v[82:83], v55 offset:21856
    s_waitcnt vmcnt(7)
    s_barrier
    s_waitcnt lgkmcnt(8)
    v_mfma_f32_32x32x16_bf16 v[160:175], a[16:19], v[64:67], v[160:175]
    ds_read_b64_tr_b16 v[84:85], v55 offset:20608
    ds_read_b64_tr_b16 v[86:87], v55 offset:21888
    s_waitcnt lgkmcnt(8)
    v_mfma_f32_32x32x16_bf16 v[96:111], a[20:23], v[68:71], v[96:111]
    ds_read_b128 a[0:3], v50 offset:0
    v_mov_b32 v30, 0
    v_mov_b32 v31, 0
    v_accvgpr_read_b32 v5, a32
    v_lshlrev_b32 v6, 16, v5
    v_and_b32 v5, 0xffff0000, v5
    ds_read_b64_tr_b16 v[64:65], v56 offset:20480
    ds_read_b64_tr_b16 v[66:67], v56 offset:21760
    s_waitcnt lgkmcnt(9)
    v_mfma_f32_32x32x16_bf16 v[112:127], a[20:23], v[72:75], v[112:127]
    ds_read_b128 a[4:7], v51 offset:0
    s_add_u32 m0, s21, 0
    s_nop 0
    global_load_lds_dwordx4 v[40:41], off
    v_add_co_u32 v40, vcc, s20, v40
    v_addc_co_u32 v41, vcc, 0, v41, vcc
    v_add_f32 v30, v30, v6
    v_add_f32 v31, v31, v5
    v_accvgpr_read_b32 v5, a33
    v_lshlrev_b32 v6, 16, v5
    v_and_b32 v5, 0xffff0000, v5
    ds_read_b64_tr_b16 v[68:69], v56 offset:20512
    ds_read_b64_tr_b16 v[70:71], v56 offset:21792
    s_waitcnt lgkmcnt(10)
    v_mfma_f32_32x32x16_bf16 v[128:143], a[20:23], v[76:79], v[128:143]
    ds_read_b128 a[8:11], v52 offset:0
    v_add_f32 v30, v30, v6
    v_add_f32 v31, v31, v5
    v_accvgpr_read_b32 v5, a34
    v_lshlrev_b32 v6, 16, v5
    v_and_b32 v5, 0xffff0000, v5
    ds_read_b64_tr_b16 v[72:73], v56 offset:20544
    ds_read_b64_tr_b16 v[74:75], v56 offset:21824
    s_waitcnt lgkmcnt(11)
    v_mfma_f32_32x32x16_bf16 v[144:159], a[20:23], v[80:83], v[144:159]
    ds_read_b128 a[12:15], v53 offset:0
    v_add_f32 v30, v30, v6
    v_add_f32 v31, v31, v5
    v_accvgpr_read_b32 v5, a35
    v_lshlrev_b32 v6, 16, v5
    v_and_b32 v5, 0xffff0000, v5
    ds_read_b64_tr_b16 v[76:77], v56 offset:20576
    ds_read_b64_tr_b16 v[78:79], v56 offset:21856
    s_waitcnt lgkmcnt(12)
    v_mfma_f32_32x32x16_bf16 v[160:175], a[20:23], v[84:87], v[160:175]
    s_add_u32 m0, s21, 1024
    s_nop 0
    global_load_lds_dwordx4 v[42:43], off
    v_add_co_u32 v42, vcc, s20, v42
    v_addc_co_u32 v43, vcc, 0, v43, vcc
    v_add_f32 v30, v30, v6
    v_add_f32 v31, v31, v5
    v_accvgpr_read_b32 v5, a36
    v_lshlrev_b32 v6, 16, v5
    v_and_b32 v5, 0xffff0000, v5
    ds_read_b64_tr_b16 v[80:81], v56 offset:20608
    ds_read_b64_tr_b16 v[82:83], v56 offset:21888
    s_waitcnt lgkmcnt(11)
    v_mfma_f32_32x32x16_bf16 v[96:111], a[24:27], v[64:67], v[96:111]
    v_add_f32 v30, v30, v6
    v_add_f32 v31, v31, v5
    v_add_f32 v30, v30, v31
    s_nop 1
    v_add_f32_dpp v30, v30, v30 row_ror:8 row_mask:0xf bank_mask:0xf
    ds_read_b64_tr_b16 v[84:85], v57 offset:20480
    ds_read_b64_tr_b16 v[86:87], v57 offset:21760
    s_waitcnt lgkmcnt(10)
    v_mfma_f32_32x32x16_bf16 v[112:127], a[24:27], v[68:71], v[112:127]
    s_nop 1
    v_add_f32_dpp v30, v30, v30 row_ror:4 row_mask:0xf bank_mask:0xf
    s_nop 1
    v_add_f32_dpp v30, v30, v30 row_ror:2 row_mask:0xf bank_mask:0xf
    s_nop 1
    ds_read_b64_tr_b16 v[64:65], v57 offset:20512
    ds_read_b64_tr_b16 v[66:67], v57 offset:21792
    s_waitcnt lgkmcnt(8)
    v_mfma_f32_32x32x16_bf16 v[128:143], a[24:27], v[72:75], v[128:143]
    s_add_u32 m0, s21, 2048
    s_mov_b32 exec_hi, 0
    global_load_lds_dwordx4 v[44:45], off
    s_mov_b32 exec_hi, -1
    v_add_co_u32 v44, vcc, s20, v44
    v_addc_co_u32 v45, vcc, 0, v45, vcc
    v_add_f32_dpp v30, v30, v30 row_ror:1 row_mask:0xf bank_mask:0xf
    v_mov_b32 v5, v30
    s_nop 1
    v_permlane32_swap_b32 v5, v30
    s_nop 1
    ds_read_b64_tr_b16 v[68:69], v57 offset:20544
    ds_read_b64_tr_b16 v[70:71], v57 offset:21824
    s_waitcnt lgkmcnt(8)
    v_mfma_f32_32x32x16_bf16 v[144:159], a[24:27], v[76:79], v[144:159]
    s_add_u32 m0, s34, 0
    s_nop 0
    global_load_lds_dwordx4 v46, s[4:5]
    v_add_f32 v30, v30, v5
    v_mov_b32 v5, v30
    s_nop 1
    v_permlane16_swap_b32 v5, v30
    s_nop 1
    ds_read_b64_tr_b16 v[72:73], v57 offset:20576
    ds_read_b64_tr_b16 v[74:75], v57 offset:21856
    s_waitcnt lgkmcnt(8)
    v_mfma_f32_32x32x16_bf16 v[160:175], a[24:27], v[80:83], v[160:175]
    v_add_f32 v30, v30, v5
    v_mul_f32 v30, 0x3acccccd, v30
    v_mov_b32 v31, 0
    v_mov_b32 v33, 0
    v_accvgpr_read_b32 v5, a32
    ds_read_b64_tr_b16 v[76:77], v57 offset:20608
    ds_read_b64_tr_b16 v[78:79], v57 offset:21888
    s_waitcnt lgkmcnt(8)
    v_mfma_f32_32x32x16_bf16 v[96:111], a[28:31], v[84:87], v[96:111]
    s_add_u32 m0, s34, 1024
    s_nop 0
    global_load_lds_dwordx4 v47, s[4:5]
    v_lshlrev_b32 v6, 16, v5
    v_and_b32 v5, 0xffff0000, v5
    v_sub_f32 v6, v6, v30
    v_sub_f32 v5, v5, v30
    v_fmac_f32 v31, v6, v6
    ds_read_b64_tr_b16 v[80:81], v58 offset:0
    ds_read_b64_tr_b16 v[82:83], v58 offset:1280
    s_waitcnt lgkmcnt(8)
    v_mfma_f32_32x32x16_bf16 v[112:127], a[28:31], v[64:67], v[112:127]
    v_fmac_f32 v33, v5, v5
    v_accvgpr_read_b32 v5, a33
    v_lshlrev_b32 v6, 16, v5
    v_and_b32 v5, 0xffff0000, v5
    v_sub_f32 v6, v6, v30
    ds_read_b64_tr_b16 v[84:85], v58 offset:32
    ds_read_b64_tr_b16 v[86:87], v58 offset:1312
    s_waitcnt lgkmcnt(8)
    v_mfma_f32_32x32x16_bf16 v[128:143], a[28:31], v[68:71], v[128:143]
    s_add_u32 m0, s34, 2048
    s_nop 0
    global_load_lds_dwordx4 v48, s[4:5]
    v_sub_f32 v5, v5, v30
    v_fmac_f32 v31, v6, v6
    v_fmac_f32 v33, v5, v5
    v_accvgpr_read_b32 v5, a34
    v_lshlrev_b32 v6, 16, v5
    ds_read_b64_tr_b16 v[64:65], v58 offset:64
    ds_read_b64_tr_b16 v[66:67], v58 offset:1344
    s_waitcnt lgkmcnt(8)
    v_mfma_f32_32x32x16_bf16 v[144:159], a[28:31], v[72:75], v[144:159]
    v_and_b32 v5, 0xffff0000, v5
    v_sub_f32 v6, v6, v30
    v_sub_f32 v5, v5, v30
    v_fmac_f32 v31, v6, v6
    v_fmac_f32 v33, v5, v5
    ds_read_b64_tr_b16 v[68:69], v58 offset:96
    ds_read_b64_tr_b16 v[70:71], v58 offset:1376
    s_waitcnt lgkmcnt(8)
    v_mfma_f32_32x32x16_bf16 v[160:175], a[28:31], v[76:79], v[160:175]
    s_add_u32 m0, s34, 3072
    s_nop 0
    global_load_lds_dwordx4 v49, s[4:5]
    s_add_u32 s4, s4, 128
    s_addc_u32 s5, s5, 0
    v_accvgpr_read_b32 v5, a35
    v_lshlrev_b32 v6, 16, v5
    v_and_b32 v5, 0xffff0000, v5
    v_sub_f32 v6, v6, v30
    v_sub_f32 v5, v5, v30
    ds_read_b64_tr_b16 v[72:73], v58 offset:128
    ds_read_b64_tr_b16 v[74:75], v58 offset:1408
    s_waitcnt lgkmcnt(8)
    v_mfma_f32_32x32x16_bf16 v[96:111], a[0:3], v[80:83], v[96:111]
    v_fmac_f32 v31, v6, v6
    v_fmac_f32 v33, v5, v5
    v_accvgpr_read_b32 v5, a36
    v_lshlrev_b32 v6, 16, v5
    v_and_b32 v5, 0xffff0000, v5
    ds_read_b64_tr_b16 v[76:77], v59 offset:0
    ds_read_b64_tr_b16 v[78:79], v59 offset:1280
    s_waitcnt lgkmcnt(8)
    v_mfma_f32_32x32x16_bf16 v[112:127], a[0:3], v[84:87], v[112:127]
    v_sub_f32 v6, v6, v30
    v_sub_f32 v5, v5, v30
    v_fmac_f32 v31, v6, v6
    v_fmac_f32 v33, v5, v5
    v_add_f32 v31, v31, v33
    ds_read_b64_tr_b16 v[80:81], v59 offset:32
    ds_read_b64_tr_b16 v[82:83], v59 offset:1312
    s_waitcnt lgkmcnt(8)
    v_mfma_f32_32x32x16_bf16 v[128:143], a[0:3], v[64:67], v[128:143]
    s_nop 1
    v_add_f32_dpp v31, v31, v31 row_ror:8 row_mask:0xf bank_mask:0xf
    s_nop 1
    v_add_f32_dpp v31, v31, v31 row_ror:4 row_mask:0xf bank_mask:0xf
    s_nop 1
    ds_read_b64_tr_b16 v[84:85], v59 offset:64
    ds_read_b64_tr_b16 v[86:87], v59 offset:1344
    s_waitcnt lgkmcnt(8)
    v_mfma_f32_32x32x16_bf16 v[144:159], a[0:3], v[68:71], v[144:159]
    v_add_f32_dpp v31, v31, v31 row_ror:2 row_mask:0xf bank_mask:0xf
    s_nop 1
    v_add_f32_dpp v31, v31, v31 row_ror:1 row_mask:0xf bank_mask:0xf
    v_mov_b32 v5, v31
    s_nop 1
    ds_read_b64_tr_b16 v[64:65], v59 offset:96
    ds_read_b64_tr_b16 v[66:67], v59 offset:1376
    s_waitcnt vmcnt(7)
    s_barrier
    s_waitcnt lgkmcnt(8)
    v_mfma_f32_32x32x16_bf16 v[160:175], a[0:3], v[72:75], v[160:175]
    v_permlane32_swap_b32 v5, v31
    s_nop 1
    v_add_f32 v31, v31, v5
    v_mov_b32 v5, v31
    s_nop 1
    ds_read_b64_tr_b16 v[68:69], v59 offset:128
    ds_read_b64_tr_b16 v[70:71], v59 offset:1408
    s_waitcnt lgkmcnt(8)
    v_mfma_f32_32x32x16_bf16 v[96:111], a[4:7], v[76:79], v[96:111]
    ds_read_b128 a[16:19], v50 offset:4096
    v_permlane16_swap_b32 v5, v31
    s_nop 1
    v_add_f32 v31, v31, v5
    v_mul_f32 v31, 0x3acccccd, v31
    v_cvt_pk_bf16_f32 v5, v30, v31
    ds_read_b64_tr_b16 v[72:73], v60 offset:0
    ds_read_b64_tr_b16 v[74:75], v60 offset:1280
    s_waitcnt lgkmcnt(9)
    v_mfma_f32_32x32x16_bf16 v[112:127], a[4:7], v[80:83], v[112:127]
    ds_read_b128 a[20:23], v51 offset:4096
    s_add_u32 m0, s21, 20480
    s_nop 0
    global_load_lds_dwordx4 v[40:41], off
    v_add_co_u32 v40, vcc, s20, v40
    v_addc_co_u32 v41, vcc, 0, v41, vcc
    v_lshlrev_b32 v30, 16, v5
    v_and_b32 v31, 0xffff0000, v5
    v_add_f32 v31, 0x3727c5ac, v31
    v_cvt_pk_bf16_f32 v5, v31, v31
    v_lshlrev_b32 v31, 16, v5
    ds_read_b64_tr_b16 v[76:77], v60 offset:32
    ds_read_b64_tr_b16 v[78:79], v60 offset:1312
    s_waitcnt lgkmcnt(10)
    v_mfma_f32_32x32x16_bf16 v[128:143], a[4:7], v[84:87], v[128:143]
    ds_read_b128 a[24:27], v52 offset:4096
    v_sqrt_f32 v31, v31
    s_nop 0
    v_cvt_pk_bf16_f32 v5, v31, v31
    v_lshlrev_b32 v31, 16, v5
    v_rcp_f32 v31, v31
    ds_read_b64_tr_b16 v[80:81], v60 offset:64
    ds_read_b64_tr_b16 v[82:83], v60 offset:1344
    s_waitcnt lgkmcnt(11)
    v_mfma_f32_32x32x16_bf16 v[144:159], a[4:7], v[64:67], v[144:159]
    ds_read_b128 a[28:31], v53 offset:4096
    s_nop 0
    v_lshlrev_b32 v26, 16, v10
    v_and_b32 v27, 0xffff0000, v10
    v_lshlrev_b32 v36, 16, v11
    v_and_b32 v37, 0xffff0000, v11
    v_add_f32 v26, v26, v36
    v_add_f32 v27, v27, v37
    ds_read_b64_tr_b16 v[84:85], v60 offset:96
    ds_read_b64_tr_b16 v[86:87], v60 offset:1376
    s_waitcnt lgkmcnt(12)
    v_mfma_f32_32x32x16_bf16 v[160:175], a[4:7], v[68:71], v[160:175]
    s_add_u32 m0, s21, 21504
    s_nop 0
    global_load_lds_dwordx4 v[42:43], off
    v_add_co_u32 v42, vcc, s20, v42
    v_addc_co_u32 v43, vcc, 0, v43, vcc
    v_lshlrev_b32 v36, 16, v12
    v_and_b32 v37, 0xffff0000, v12
    v_add_f32 v26, v26, v36
    v_add_f32 v27, v27, v37
    v_lshlrev_b32 v36, 16, v13
    v_and_b32 v37, 0xffff0000, v13
    ds_read_b64_tr_b16 v[64:65], v60 offset:128
    ds_read_b64_tr_b16 v[66:67], v60 offset:1408
    s_waitcnt lgkmcnt(11)
    v_mfma_f32_32x32x16_bf16 v[96:111], a[8:11], v[72:75], v[96:111]
    v_add_f32 v26, v26, v36
    v_add_f32 v27, v27, v37
    v_lshlrev_b32 v36, 16, v14
    v_and_b32 v37, 0xffff0000, v14
    v_add_f32 v26, v26, v36
    v_add_f32 v27, v27, v37
    ds_read_b64_tr_b16 v[68:69], v61 offset:0
    ds_read_b64_tr_b16 v[70:71], v61 offset:1280
    s_waitcnt lgkmcnt(10)
    v_mfma_f32_32x32x16_bf16 v[112:127], a[8:11], v[76:79], v[112:127]
    v_lshlrev_b32 v36, 16, v15
    v_and_b32 v37, 0xffff0000, v15
    v_add_f32 v26, v26, v36
    v_add_f32 v27, v27, v37
    v_lshlrev_b32 v36, 16, v16
    v_and_b32 v37, 0xffff0000, v16
    ds_read_b64_tr_b16 v[72:73], v61 offset:32
    ds_read_b64_tr_b16 v[74:75], v61 offset:1312
    s_waitcnt lgkmcnt(8)
    v_mfma_f32_32x32x16_bf16 v[128:143], a[8:11], v[80:83], v[128:143]
    s_add_u32 m0, s21, 22528
    s_mov_b32 exec_hi, 0
    global_load_lds_dwordx4 v[44:45], off
    s_mov_b32 exec_hi, -1
    v_add_co_u32 v44, vcc, s20, v44
    v_addc_co_u32 v45, vcc, 0, v45, vcc
    v_add_f32 v26, v26, v36
    v_add_f32 v27, v27, v37
    v_lshlrev_b32 v36, 16, v17
    v_and_b32 v37, 0xffff0000, v17
    v_add_f32 v26, v26, v36
    v_add_f32 v27, v27, v37
    ds_read_b64_tr_b16 v[76:77], v61 offset:64
    ds_read_b64_tr_b16 v[78:79], v61 offset:1344
    s_waitcnt lgkmcnt(8)
    v_mfma_f32_32x32x16_bf16 v[144:159], a[8:11], v[84:87], v[144:159]
    s_add_u32 m0, s34, 4096
    s_nop 0
    global_load_lds_dwordx4 v46, s[4:5]
    v_lshlrev_b32 v36, 16, v18
    v_and_b32 v37, 0xffff0000, v18
    v_add_f32 v26, v26, v36
    v_add_f32 v27, v27, v37
    v_lshlrev_b32 v36, 16, v19
    v_and_b32 v37, 0xffff0000, v19
    ds_read_b64_tr_b16 v[80:81], v61 offset:96
    ds_read_b64_tr_b16 v[82:83], v61 offset:1376
    s_waitcnt lgkmcnt(8)
    v_mfma_f32_32x32x16_bf16 v[160:175], a[8:11], v[64:67], v[160:175]
    v_add_f32 v26, v26, v36
    v_add_f32 v27, v27, v37
    v_lshlrev_b32 v36, 16, v20
    v_and_b32 v37, 0xffff0000, v20
    v_add_f32 v26, v26, v36
    v_add_f32 v27, v27, v37
    ds_read_b64_tr_b16 v[84:85], v61 offset:128
    ds_read_b64_tr_b16 v[86:87], v61 offset:1408
    s_waitcnt lgkmcnt(8)
    v_mfma_f32_32x32x16_bf16 v[96:111], a[12:15], v[68:71], v[96:111]
    s_add_u32 m0, s34, 5120
    s_nop 0
    global_load_lds_dwordx4 v47, s[4:5]
    v_lshlrev_b32 v36, 16, v21
    v_and_b32 v37, 0xffff0000, v21
    v_add_f32 v26, v26, v36
    v_add_f32 v27, v27, v37
    v_lshlrev_b32 v36, 16, v22
    v_and_b32 v37, 0xffff0000, v22
    ds_read_b64_tr_b16 v[64:65], v58 offset:20480
    ds_read_b64_tr_b16 v[66:67], v58 offset:21760
    s_waitcnt lgkmcnt(8)
    v_mfma_f32_32x32x16_bf16 v[112:127], a[12:15], v[72:75], v[112:127]
    v_add_f32 v26, v26, v36
    v_add_f32 v27, v27, v37
    v_lshlrev_b32 v36, 16, v23
    v_and_b32 v37, 0xffff0000, v23
    v_add_f32 v26, v26, v36
    v_add_f32 v27, v27, v37
    ds_read_b64_tr_b16 v[68:69], v58 offset:20512
    ds_read_b64_tr_b16 v[70:71], v58 offset:21792
    s_waitcnt lgkmcnt(8)
    v_mfma_f32_32x32x16_bf16 v[128:143], a[12:15], v[76:79], v[128:143]
    s_add_u32 m0, s34, 6144
    s_nop 0
    global_load_lds_dwordx4 v48, s[4:5]
    v_lshlrev_b32 v36, 16, v24
    v_and_b32 v37, 0xffff0000, v24
    v_add_f32 v26, v26, v36
    v_add_f32 v27, v27, v37
    v_lshlrev_b32 v36, 16, v25
    v_and_b32 v37, 0xffff0000, v25
    ds_read_b64_tr_b16 v[72:73], v58 offset:20544
    ds_read_b64_tr_b16 v[74:75], v58 offset:21824
    s_waitcnt lgkmcnt(8)
    v_mfma_f32_32x32x16_bf16 v[144:159], a[12:15], v[80:83], v[144:159]
    v_add_f32 v26, v26, v36
    v_add_f32 v27, v27, v37
    ds_read_b64_tr_b16 v[76:77], v58 offset:20576
    ds_read_b64_tr_b16 v[78:79], v58 offset:21856
    s_waitcnt lgkmcnt(8)
    v_mfma_f32_32x32x16_bf16 v[160:175], a[12:15], v[84:87], v[160:175]
    s_add_u32 m0, s34, 7168
    s_nop 0
    global_load_lds_dwordx4 v49, s[4:5]
    s_add_u32 s4, s4, 128
    s_addc_u32 s5, s5, 0
    ds_read_b64_tr_b16 v[80:81], v58 offset:20608
    ds_read_b64_tr_b16 v[82:83], v58 offset:21888
    ds_write_b64 v35, v[26:27]
    s_waitcnt lgkmcnt(9)
    v_mfma_f32_32x32x16_bf16 v[96:111], a[16:19], v[64:67], v[96:111]
    ds_read_b64_tr_b16 v[84:85], v59 offset:20480
    ds_read_b64_tr_b16 v[86:87], v59 offset:21760
    s_waitcnt lgkmcnt(9)
    v_mfma_f32_32x32x16_bf16 v[112:127], a[16:19], v[68:71], v[112:127]
    ds_read_b64_tr_b16 v[64:65], v59 offset:20512
    ds_read_b64_tr_b16 v[66:67], v59 offset:21792
    s_waitcnt lgkmcnt(9)
    v_mfma_f32_32x32x16_bf16 v[128:143], a[16:19], v[72:75], v[128:143]
    ds_read_b64_tr_b16 v[68:69], v59 offset:20544
    ds_read_b64_tr_b16 v[70:71], v59 offset:21824
    s_waitcnt lgkmcnt(9)
    v_mfma_f32_32x32x16_bf16 v[144:159], a[16:19], v[76:79], v[144:159]
    ds_read_b64_tr_b16 v[72:73], v59 offset:20576
    ds_read_b64_tr_b16 v[74:75], v59 offset:21856
    s_waitcnt vmcnt(7)
    s_waitcnt lgkmcnt(8)
    s_barrier
    v_mfma_f32_32x32x16_bf16 v[160:175], a[16:19], v[80:83], v[160:175]
    ds_read_b64_tr_b16 v[76:77], v59 offset:20608
    ds_read_b64_tr_b16 v[78:79], v59 offset:21888
    s_waitcnt lgkmcnt(8)
    v_mfma_f32_32x32x16_bf16 v[96:111], a[20:23], v[84:87], v[96:111]
    ds_read_b128 a[0:3], v50 offset:0
    ds_read_b64_tr_b16 v[80:81], v60 offset:20480
    ds_read_b64_tr_b16 v[82:83], v60 offset:21760
    v_and_b32 v38, 127, v0
    v_lshlrev_b32 v38, 3, v38
    v_add_u32 v39, 148480, v38
    ds_read_b64 v[10:11], v39 offset:0
    ds_read_b64 v[12:13], v39 offset:640
    ds_read_b64 v[14:15], v39 offset:1280
    ds_read_b64 v[16:17], v39 offset:1920
    ds_read_b64 v[18:19], v39 offset:2560
    s_waitcnt lgkmcnt(14)
    v_mfma_f32_32x32x16_bf16 v[112:127], a[20:23], v[64:67], v[112:127]
    ds_read_b128 a[4:7], v51 offset:0
    s_add_u32 m0, s21, 40960
    s_nop 0
    global_load_lds_dwordx4 v[40:41], off
    v_add_co_u32 v40, vcc, s20, v40
    v_addc_co_u32 v41, vcc, 0, v41, vcc
    ds_read_b64_tr_b16 v[84:85], v60 offset:20512
    ds_read_b64_tr_b16 v[86:87], v60 offset:21792
    s_waitcnt lgkmcnt(15)
    v_mfma_f32_32x32x16_bf16 v[128:143], a[20:23], v[68:71], v[128:143]
    ds_read_b128 a[8:11], v52 offset:0
    ds_read_b64_tr_b16 v[64:65], v60 offset:20544
    ds_read_b64_tr_b16 v[66:67], v60 offset:21824
    s_waitcnt lgkmcnt(15)
    v_mfma_f32_32x32x16_bf16 v[144:159], a[20:23], v[72:75], v[144:159]
    ds_read_b128 a[12:15], v53 offset:0
    ds_read_b64_tr_b16 v[68:69], v60 offset:20576
    ds_read_b64_tr_b16 v[70:71], v60 offset:21856
    s_waitcnt lgkmcnt(15)
    v_mfma_f32_32x32x16_bf16 v[160:175], a[20:23], v[76:79], v[160:175]
    s_add_u32 m0, s21, 41984
    s_nop 0
    global_load_lds_dwordx4 v[42:43], off
    v_add_co_u32 v42, vcc, s20, v42
    v_addc_co_u32 v43, vcc, 0, v43, vcc
    ds_read_b64_tr_b16 v[72:73], v60 offset:20608
    ds_read_b64_tr_b16 v[74:75], v60 offset:21888
    s_waitcnt lgkmcnt(11)
    v_add_f32 v10, v10, v12
    v_add_f32 v11, v11, v13
    v_add_f32 v10, v10, v14
    v_add_f32 v11, v11, v15
    v_add_f32 v10, v10, v16
    v_add_f32 v11, v11, v17
    v_add_f32 v10, v10, v18
    v_add_f32 v11, v11, v19
    v_cmp_gt_u32 vcc, 80, v0
    s_nop 1
    s_and_saveexec_b64 s[50:51], vcc
    s_cbranch_execz L_nocp_a5e0_9
    global_store_dwordx2 v38, v[10:11], s[52:53] sc0 sc1
L_nocp_a5e0_9:
    s_mov_b64 exec, -1
    v_mfma_f32_32x32x16_bf16 v[96:111], a[24:27], v[80:83], v[96:111]
    ds_read_b64_tr_b16 v[76:77], v61 offset:20480
    ds_read_b64_tr_b16 v[78:79], v61 offset:21760
    s_waitcnt lgkmcnt(10)
    v_mfma_f32_32x32x16_bf16 v[112:127], a[24:27], v[84:87], v[112:127]
    ds_read_b64_tr_b16 v[80:81], v61 offset:20512
    ds_read_b64_tr_b16 v[82:83], v61 offset:21792
    s_waitcnt lgkmcnt(8)
    s_mov_b64 exec, 1
    global_store_dwordx2 v7, v[30:31], s[42:43] sc0 sc1
    s_mov_b64 exec, -1
    v_mfma_f32_32x32x16_bf16 v[128:143], a[24:27], v[64:67], v[128:143]
    s_add_u32 m0, s21, 43008
    s_mov_b32 exec_hi, 0
    global_load_lds_dwordx4 v[44:45], off
    s_mov_b32 exec_hi, -1
    v_add_co_u32 v44, vcc, s20, v44
    v_addc_co_u32 v45, vcc, 0, v45, vcc
    ds_read_b64_tr_b16 v[84:85], v61 offset:20544
    ds_read_b64_tr_b16 v[86:87], v61 offset:21824
    s_waitcnt lgkmcnt(8)
    v_mfma_f32_32x32x16_bf16 v[144:159], a[24:27], v[68:71], v[144:159]
    s_add_u32 m0, s34, 0
    s_nop 0
    global_load_lds_dwordx4 v46, s[4:5]
    ds_read_b64_tr_b16 v[64:65], v61 offset:20576
    ds_read_b64_tr_b16 v[66:67], v61 offset:21856
    s_waitcnt lgkmcnt(8)
    v_mfma_f32_32x32x16_bf16 v[160:175], a[24:27], v[72:75], v[160:175]
    ds_read_b64_tr_b16 v[68:69], v61 offset:20608
    ds_read_b64_tr_b16 v[70:71], v61 offset:21888
    s_waitcnt lgkmcnt(8)
    v_mfma_f32_32x32x16_bf16 v[96:111], a[28:31], v[76:79], v[96:111]
    s_add_u32 m0, s34, 1024
    s_nop 0
    global_load_lds_dwordx4 v47, s[4:5]
    ds_read_b64_tr_b16 v[72:73], v54 offset:0
    ds_read_b64_tr_b16 v[74:75], v54 offset:1280
    s_waitcnt lgkmcnt(8)
    v_mfma_f32_32x32x16_bf16 v[112:127], a[28:31], v[80:83], v[112:127]
    ds_read_b64_tr_b16 v[76:77], v54 offset:32
    ds_read_b64_tr_b16 v[78:79], v54 offset:1312
    s_waitcnt lgkmcnt(8)
    v_mfma_f32_32x32x16_bf16 v[128:143], a[28:31], v[84:87], v[128:143]
    s_add_u32 m0, s34, 2048
    s_nop 0
    global_load_lds_dwordx4 v48, s[4:5]
    ds_read_b64_tr_b16 v[80:81], v54 offset:64
    ds_read_b64_tr_b16 v[82:83], v54 offset:1344
    s_waitcnt lgkmcnt(8)
    v_mfma_f32_32x32x16_bf16 v[144:159], a[28:31], v[64:67], v[144:159]
    ds_read_b64_tr_b16 v[84:85], v54 offset:96
    ds_read_b64_tr_b16 v[86:87], v54 offset:1376
    s_waitcnt lgkmcnt(8)
    v_mfma_f32_32x32x16_bf16 v[160:175], a[28:31], v[68:71], v[160:175]
    s_add_u32 m0, s34, 3072
    s_nop 0
    global_load_lds_dwordx4 v49, s[4:5]
    s_add_u32 s4, s4, 128
    s_addc_u32 s5, s5, 0
    ds_read_b64_tr_b16 v[64:65], v54 offset:128
    ds_read_b64_tr_b16 v[66:67], v54 offset:1408
    s_waitcnt lgkmcnt(8)
    v_mfma_f32_32x32x16_bf16 v[96:111], a[0:3], v[72:75], v[96:111]
    ds_read_b64_tr_b16 v[68:69], v55 offset:0
    ds_read_b64_tr_b16 v[70:71], v55 offset:1280
    s_waitcnt lgkmcnt(8)
    v_mfma_f32_32x32x16_bf16 v[112:127], a[0:3], v[76:79], v[112:127]
    ds_read_b64_tr_b16 v[72:73], v55 offset:32
    ds_read_b64_tr_b16 v[74:75], v55 offset:1312
    s_waitcnt lgkmcnt(8)
    v_mfma_f32_32x32x16_bf16 v[128:143], a[0:3], v[80:83], v[128:143]
    ds_read_b64_tr_b16 v[76:77], v55 offset:64
    ds_read_b64_tr_b16 v[78:79], v55 offset:1344
    s_waitcnt lgkmcnt(8)
    v_mfma_f32_32x32x16_bf16 v[144:159], a[0:3], v[84:87], v[144:159]
    ds_read_b64_tr_b16 v[80:81], v55 offset:96
    ds_read_b64_tr_b16 v[82:83], v55 offset:1376
    s_waitcnt vmcnt(8)
    s_waitcnt vmcnt(5)
    s_barrier
    s_cmp_lg_u32 s14, 0
    s_cbranch_scc1 L_flag_a5e0_10
    v_mov_b32 v38, s13
    v_mov_b32 v39, 1
    s_mov_b64 exec, 1
    global_store_byte v38, v39, s[36:37] sc0 sc1
    s_mov_b64 exec, -1

L_flag_a5e0_10:
    s_waitcnt lgkmcnt(8)
    v_mfma_f32_32x32x16_bf16 v[160:175], a[0:3], v[64:67], v[160:175]
    ds_read_b64_tr_b16 v[84:85], v55 offset:128
    ds_read_b64_tr_b16 v[86:87], v55 offset:1408
    s_waitcnt lgkmcnt(8)
    v_mfma_f32_32x32x16_bf16 v[96:111], a[4:7], v[68:71], v[96:111]
    ds_read_b128 a[16:19], v50 offset:4096
    ds_read_b64_tr_b16 v[64:65], v56 offset:0
    ds_read_b64_tr_b16 v[66:67], v56 offset:1280
    s_waitcnt lgkmcnt(9)
    v_mfma_f32_32x32x16_bf16 v[112:127], a[4:7], v[72:75], v[112:127]
    ds_read_b128 a[20:23], v51 offset:4096
    s_add_u32 m0, s21, 61440
    s_nop 0
    global_load_lds_dwordx4 v[40:41], off
    v_add_co_u32 v40, vcc, s20, v40
    v_addc_co_u32 v41, vcc, 0, v41, vcc
    ds_read_b64_tr_b16 v[68:69], v56 offset:32
    ds_read_b64_tr_b16 v[70:71], v56 offset:1312
    s_waitcnt lgkmcnt(10)
    v_mfma_f32_32x32x16_bf16 v[128:143], a[4:7], v[76:79], v[128:143]
    ds_read_b128 a[24:27], v52 offset:4096
    ds_read_b64_tr_b16 v[72:73], v56 offset:64
    ds_read_b64_tr_b16 v[74:75], v56 offset:1344
    s_waitcnt lgkmcnt(11)
    v_mfma_f32_32x32x16_bf16 v[144:159], a[4:7], v[80:83], v[144:159]
    ds_read_b128 a[28:31], v53 offset:4096
    ds_read_b64_tr_b16 v[76:77], v56 offset:96
    ds_read_b64_tr_b16 v[78:79], v56 offset:1376
    s_waitcnt lgkmcnt(12)
    v_mfma_f32_32x32x16_bf16 v[160:175], a[4:7], v[84:87], v[160:175]
    s_add_u32 m0, s21, 62464
    s_nop 0
    global_load_lds_dwordx4 v[42:43], off
    v_add_co_u32 v42, vcc, s20, v42
    v_addc_co_u32 v43, vcc, 0, v43, vcc
    ds_read_b64_tr_b16 v[80:81], v56 offset:128
    ds_read_b64_tr_b16 v[82:83], v56 offset:1408
    s_waitcnt lgkmcnt(11)
    v_mfma_f32_32x32x16_bf16 v[96:111], a[8:11], v[64:67], v[96:111]
    ds_read_b64_tr_b16 v[84:85], v57 offset:0
    ds_read_b64_tr_b16 v[86:87], v57 offset:1280
    s_waitcnt lgkmcnt(10)
    v_mfma_f32_32x32x16_bf16 v[112:127], a[8:11], v[68:71], v[112:127]
    ds_read_b64_tr_b16 v[64:65], v57 offset:32
    ds_read_b64_tr_b16 v[66:67], v57 offset:1312
    s_waitcnt lgkmcnt(8)
    v_mfma_f32_32x32x16_bf16 v[128:143], a[8:11], v[72:75], v[128:143]
    s_add_u32 m0, s21, 63488
    s_mov_b32 exec_hi, 0
    global_load_lds_dwordx4 v[44:45], off
    s_mov_b32 exec_hi, -1
    v_add_co_u32 v44, vcc, s20, v44
    v_addc_co_u32 v45, vcc, 0, v45, vcc
    ds_read_b64_tr_b16 v[68:69], v57 offset:64
    ds_read_b64_tr_b16 v[70:71], v57 offset:1344
    s_waitcnt lgkmcnt(8)
    v_mfma_f32_32x32x16_bf16 v[144:159], a[8:11], v[76:79], v[144:159]
    s_add_u32 m0, s34, 4096
    s_nop 0
    global_load_lds_dwordx4 v46, s[4:5]
    ds_read_b64_tr_b16 v[72:73], v57 offset:96
    ds_read_b64_tr_b16 v[74:75], v57 offset:1376
    s_waitcnt lgkmcnt(8)
    v_mfma_f32_32x32x16_bf16 v[160:175], a[8:11], v[80:83], v[160:175]
    ds_read_b64_tr_b16 v[76:77], v57 offset:128
    ds_read_b64_tr_b16 v[78:79], v57 offset:1408
    s_waitcnt lgkmcnt(8)
    v_mfma_f32_32x32x16_bf16 v[96:111], a[12:15], v[84:87], v[96:111]
    s_add_u32 m0, s34, 5120
    s_nop 0
    global_load_lds_dwordx4 v47, s[4:5]
    ds_read_b64_tr_b16 v[80:81], v54 offset:20480
    ds_read_b64_tr_b16 v[82:83], v54 offset:21760
    s_waitcnt lgkmcnt(8)
    v_mfma_f32_32x32x16_bf16 v[112:127], a[12:15], v[64:67], v[112:127]
    ds_read_b64_tr_b16 v[84:85], v54 offset:20512
    ds_read_b64_tr_b16 v[86:87], v54 offset:21792
    s_waitcnt lgkmcnt(8)
    v_mfma_f32_32x32x16_bf16 v[128:143], a[12:15], v[68:71], v[128:143]
    s_add_u32 m0, s34, 6144
    s_nop 0
    global_load_lds_dwordx4 v48, s[4:5]
    ds_read_b64_tr_b16 v[64:65], v54 offset:20544
    ds_read_b64_tr_b16 v[66:67], v54 offset:21824
    s_waitcnt lgkmcnt(8)
    v_mfma_f32_32x32x16_bf16 v[144:159], a[12:15], v[72:75], v[144:159]
    ds_read_b64_tr_b16 v[68:69], v54 offset:20576
    ds_read_b64_tr_b16 v[70:71], v54 offset:21856
    s_waitcnt lgkmcnt(8)
    v_mfma_f32_32x32x16_bf16 v[160:175], a[12:15], v[76:79], v[160:175]
    s_add_u32 m0, s34, 7168
    s_nop 0
    global_load_lds_dwordx4 v49, s[4:5]
    s_add_u32 s4, s4, 128
    s_addc_u32 s5, s5, 0
    ds_read_b64_tr_b16 v[72:73], v54 offset:20608
    ds_read_b64_tr_b16 v[74:75], v54 offset:21888
    s_waitcnt lgkmcnt(8)
    v_mfma_f32_32x32x16_bf16 v[96:111], a[16:19], v[80:83], v[96:111]
    ds_read_b64_tr_b16 v[76:77], v55 offset:20480
    ds_read_b64_tr_b16 v[78:79], v55 offset:21760
    s_waitcnt lgkmcnt(8)
    v_mfma_f32_32x32x16_bf16 v[112:127], a[16:19], v[84:87], v[112:127]
    ds_read_b64_tr_b16 v[80:81], v55 offset:20512
    ds_read_b64_tr_b16 v[82:83], v55 offset:21792
    s_waitcnt lgkmcnt(8)
    v_mfma_f32_32x32x16_bf16 v[128:143], a[16:19], v[64:67], v[128:143]
    ds_read_b64_tr_b16 v[84:85], v55 offset:20544
    ds_read_b64_tr_b16 v[86:87], v55 offset:21824
    s_waitcnt lgkmcnt(8)
    v_mfma_f32_32x32x16_bf16 v[144:159], a[16:19], v[68:71], v[144:159]
    ds_read_b64_tr_b16 v[64:65], v55 offset:20576
    ds_read_b64_tr_b16 v[66:67], v55 offset:21856
    s_waitcnt vmcnt(7)
    s_barrier
    s_waitcnt lgkmcnt(8)
    v_mfma_f32_32x32x16_bf16 v[160:175], a[16:19], v[72:75], v[160:175]
    ds_read_b64_tr_b16 v[68:69], v55 offset:20608
    ds_read_b64_tr_b16 v[70:71], v55 offset:21888
    s_waitcnt lgkmcnt(8)
    v_mfma_f32_32x32x16_bf16 v[96:111], a[20:23], v[76:79], v[96:111]
    ds_read_b128 a[0:3], v50 offset:0
    ds_read_b64_tr_b16 v[72:73], v56 offset:20480
    ds_read_b64_tr_b16 v[74:75], v56 offset:21760
    s_waitcnt lgkmcnt(9)
    v_mfma_f32_32x32x16_bf16 v[112:127], a[20:23], v[80:83], v[112:127]
    ds_read_b128 a[4:7], v51 offset:0
    s_add_u32 m0, s21, 0
    s_nop 0
    global_load_lds_dwordx4 v[40:41], off
    v_add_co_u32 v40, vcc, s20, v40
    v_addc_co_u32 v41, vcc, 0, v41, vcc
    ds_read_b64_tr_b16 v[76:77], v56 offset:20512
    ds_read_b64_tr_b16 v[78:79], v56 offset:21792
    s_waitcnt lgkmcnt(10)
    v_mfma_f32_32x32x16_bf16 v[128:143], a[20:23], v[84:87], v[128:143]
    ds_read_b128 a[8:11], v52 offset:0
    ds_read_b64_tr_b16 v[80:81], v56 offset:20544
    ds_read_b64_tr_b16 v[82:83], v56 offset:21824
    s_waitcnt lgkmcnt(11)
    v_mfma_f32_32x32x16_bf16 v[144:159], a[20:23], v[64:67], v[144:159]
    ds_read_b128 a[12:15], v53 offset:0
    ds_read_b64_tr_b16 v[84:85], v56 offset:20576
    ds_read_b64_tr_b16 v[86:87], v56 offset:21856
    s_waitcnt lgkmcnt(12)
    v_mfma_f32_32x32x16_bf16 v[160:175], a[20:23], v[68:71], v[160:175]
    s_add_u32 m0, s21, 1024
    s_nop 0
    global_load_lds_dwordx4 v[42:43], off
    v_add_co_u32 v42, vcc, s20, v42
    v_addc_co_u32 v43, vcc, 0, v43, vcc
    ds_read_b64_tr_b16 v[64:65], v56 offset:20608
    ds_read_b64_tr_b16 v[66:67], v56 offset:21888
    s_waitcnt lgkmcnt(11)
    v_mfma_f32_32x32x16_bf16 v[96:111], a[24:27], v[72:75], v[96:111]
    ds_read_b64_tr_b16 v[68:69], v57 offset:20480
    ds_read_b64_tr_b16 v[70:71], v57 offset:21760
    s_waitcnt lgkmcnt(10)
    v_mfma_f32_32x32x16_bf16 v[112:127], a[24:27], v[76:79], v[112:127]
    ds_read_b64_tr_b16 v[72:73], v57 offset:20512
    ds_read_b64_tr_b16 v[74:75], v57 offset:21792
    s_waitcnt lgkmcnt(8)
    v_mfma_f32_32x32x16_bf16 v[128:143], a[24:27], v[80:83], v[128:143]
    s_add_u32 m0, s21, 2048
    s_mov_b32 exec_hi, 0
    global_load_lds_dwordx4 v[44:45], off
    s_mov_b32 exec_hi, -1
    v_add_co_u32 v44, vcc, s20, v44
    v_addc_co_u32 v45, vcc, 0, v45, vcc
    ds_read_b64_tr_b16 v[76:77], v57 offset:20544
    ds_read_b64_tr_b16 v[78:79], v57 offset:21824
    s_waitcnt lgkmcnt(8)
    v_mfma_f32_32x32x16_bf16 v[144:159], a[24:27], v[84:87], v[144:159]
    s_add_u32 m0, s34, 0
    s_nop 0
    global_load_lds_dwordx4 v46, s[4:5]
    ds_read_b64_tr_b16 v[80:81], v57 offset:20576
    ds_read_b64_tr_b16 v[82:83], v57 offset:21856
    s_waitcnt lgkmcnt(8)
    v_mfma_f32_32x32x16_bf16 v[160:175], a[24:27], v[64:67], v[160:175]
    ds_read_b64_tr_b16 v[84:85], v57 offset:20608
    ds_read_b64_tr_b16 v[86:87], v57 offset:21888
    s_waitcnt lgkmcnt(8)
    v_mfma_f32_32x32x16_bf16 v[96:111], a[28:31], v[68:71], v[96:111]
    s_add_u32 m0, s34, 1024
    s_nop 0
    global_load_lds_dwordx4 v47, s[4:5]
    ds_read_b64_tr_b16 v[64:65], v58 offset:0
    ds_read_b64_tr_b16 v[66:67], v58 offset:1280
    s_waitcnt lgkmcnt(8)
    v_mfma_f32_32x32x16_bf16 v[112:127], a[28:31], v[72:75], v[112:127]
    ds_read_b64_tr_b16 v[68:69], v58 offset:32
    ds_read_b64_tr_b16 v[70:71], v58 offset:1312
    s_waitcnt lgkmcnt(8)
    v_mfma_f32_32x32x16_bf16 v[128:143], a[28:31], v[76:79], v[128:143]
    s_add_u32 m0, s34, 2048
    s_nop 0
    global_load_lds_dwordx4 v48, s[4:5]
    ds_read_b64_tr_b16 v[72:73], v58 offset:64
    ds_read_b64_tr_b16 v[74:75], v58 offset:1344
    s_waitcnt lgkmcnt(8)
    v_mfma_f32_32x32x16_bf16 v[144:159], a[28:31], v[80:83], v[144:159]
    ds_read_b64_tr_b16 v[76:77], v58 offset:96
    ds_read_b64_tr_b16 v[78:79], v58 offset:1376
    s_waitcnt lgkmcnt(8)
    v_mfma_f32_32x32x16_bf16 v[160:175], a[28:31], v[84:87], v[160:175]
    s_add_u32 m0, s34, 3072
    s_nop 0
    global_load_lds_dwordx4 v49, s[4:5]
    s_add_u32 s4, s4, 128
    s_addc_u32 s5, s5, 0
    ds_read_b64_tr_b16 v[80:81], v58 offset:128
    ds_read_b64_tr_b16 v[82:83], v58 offset:1408
    s_waitcnt lgkmcnt(8)
    v_mfma_f32_32x32x16_bf16 v[96:111], a[0:3], v[64:67], v[96:111]
    ds_read_b64_tr_b16 v[84:85], v59 offset:0
    ds_read_b64_tr_b16 v[86:87], v59 offset:1280
    s_waitcnt lgkmcnt(8)
    v_mfma_f32_32x32x16_bf16 v[112:127], a[0:3], v[68:71], v[112:127]
    ds_read_b64_tr_b16 v[64:65], v59 offset:32
    ds_read_b64_tr_b16 v[66:67], v59 offset:1312
    s_waitcnt lgkmcnt(8)
    v_mfma_f32_32x32x16_bf16 v[128:143], a[0:3], v[72:75], v[128:143]
    ds_read_b64_tr_b16 v[68:69], v59 offset:64
    ds_read_b64_tr_b16 v[70:71], v59 offset:1344
    s_waitcnt lgkmcnt(8)
    v_mfma_f32_32x32x16_bf16 v[144:159], a[0:3], v[76:79], v[144:159]
    ds_read_b64_tr_b16 v[72:73], v59 offset:96
    ds_read_b64_tr_b16 v[74:75], v59 offset:1376
    s_waitcnt vmcnt(7)
    s_barrier
    s_waitcnt lgkmcnt(8)
    v_mfma_f32_32x32x16_bf16 v[160:175], a[0:3], v[80:83], v[160:175]
    ds_read_b64_tr_b16 v[76:77], v59 offset:128
    ds_read_b64_tr_b16 v[78:79], v59 offset:1408
    s_waitcnt lgkmcnt(8)
    v_mfma_f32_32x32x16_bf16 v[96:111], a[4:7], v[84:87], v[96:111]
    ds_read_b128 a[16:19], v50 offset:4096
    ds_read_b64_tr_b16 v[80:81], v60 offset:0
    ds_read_b64_tr_b16 v[82:83], v60 offset:1280
    s_waitcnt lgkmcnt(9)
    v_mfma_f32_32x32x16_bf16 v[112:127], a[4:7], v[64:67], v[112:127]
    ds_read_b128 a[20:23], v51 offset:4096
    s_add_u32 m0, s21, 20480
    s_nop 0
    global_load_lds_dwordx4 v[40:41], off
    v_add_co_u32 v40, vcc, s20, v40
    v_addc_co_u32 v41, vcc, 0, v41, vcc
    ds_read_b64_tr_b16 v[84:85], v60 offset:32
    ds_read_b64_tr_b16 v[86:87], v60 offset:1312
    s_waitcnt lgkmcnt(10)
    v_mfma_f32_32x32x16_bf16 v[128:143], a[4:7], v[68:71], v[128:143]
    ds_read_b128 a[24:27], v52 offset:4096
    ds_read_b64_tr_b16 v[64:65], v60 offset:64
    ds_read_b64_tr_b16 v[66:67], v60 offset:1344
    s_waitcnt lgkmcnt(11)
    v_mfma_f32_32x32x16_bf16 v[144:159], a[4:7], v[72:75], v[144:159]
    ds_read_b128 a[28:31], v53 offset:4096
    ds_read_b64_tr_b16 v[68:69], v60 offset:96
    ds_read_b64_tr_b16 v[70:71], v60 offset:1376
    s_waitcnt lgkmcnt(12)
    v_mfma_f32_32x32x16_bf16 v[160:175], a[4:7], v[76:79], v[160:175]
    s_add_u32 m0, s21, 21504
    s_nop 0
    global_load_lds_dwordx4 v[42:43], off
    v_add_co_u32 v42, vcc, s20, v42
    v_addc_co_u32 v43, vcc, 0, v43, vcc
    ds_read_b64_tr_b16 v[72:73], v60 offset:128
    ds_read_b64_tr_b16 v[74:75], v60 offset:1408
    s_waitcnt lgkmcnt(11)
    v_mfma_f32_32x32x16_bf16 v[96:111], a[8:11], v[80:83], v[96:111]
    ds_read_b64_tr_b16 v[76:77], v61 offset:0
    ds_read_b64_tr_b16 v[78:79], v61 offset:1280
    s_waitcnt lgkmcnt(10)
    v_mfma_f32_32x32x16_bf16 v[112:127], a[8:11], v[84:87], v[112:127]
    ds_read_b64_tr_b16 v[80:81], v61 offset:32
    ds_read_b64_tr_b16 v[82:83], v61 offset:1312
    s_waitcnt lgkmcnt(8)
    v_mfma_f32_32x32x16_bf16 v[128:143], a[8:11], v[64:67], v[128:143]
    s_add_u32 m0, s21, 22528
    s_mov_b32 exec_hi, 0
    global_load_lds_dwordx4 v[44:45], off
    s_mov_b32 exec_hi, -1
    v_add_co_u32 v44, vcc, s20, v44
    v_addc_co_u32 v45, vcc, 0, v45, vcc
    ds_read_b64_tr_b16 v[84:85], v61 offset:64
    ds_read_b64_tr_b16 v[86:87], v61 offset:1344
    s_waitcnt lgkmcnt(8)
    v_mfma_f32_32x32x16_bf16 v[144:159], a[8:11], v[68:71], v[144:159]
    s_add_u32 m0, s34, 4096
    s_nop 0
    global_load_lds_dwordx4 v46, s[4:5]
    ds_read_b64_tr_b16 v[64:65], v61 offset:96
    ds_read_b64_tr_b16 v[66:67], v61 offset:1376
    s_waitcnt lgkmcnt(8)
    v_mfma_f32_32x32x16_bf16 v[160:175], a[8:11], v[72:75], v[160:175]
    ds_read_b64_tr_b16 v[68:69], v61 offset:128
    ds_read_b64_tr_b16 v[70:71], v61 offset:1408
    s_waitcnt lgkmcnt(8)
    v_mfma_f32_32x32x16_bf16 v[96:111], a[12:15], v[76:79], v[96:111]
    s_add_u32 m0, s34, 5120
    s_nop 0
    global_load_lds_dwordx4 v47, s[4:5]
    ds_read_b64_tr_b16 v[72:73], v58 offset:20480
    ds_read_b64_tr_b16 v[74:75], v58 offset:21760
    s_waitcnt lgkmcnt(8)
    v_mfma_f32_32x32x16_bf16 v[112:127], a[12:15], v[80:83], v[112:127]
    ds_read_b64_tr_b16 v[76:77], v58 offset:20512
    ds_read_b64_tr_b16 v[78:79], v58 offset:21792
    s_waitcnt lgkmcnt(8)
    v_mfma_f32_32x32x16_bf16 v[128:143], a[12:15], v[84:87], v[128:143]
    s_add_u32 m0, s34, 6144
    s_nop 0
    global_load_lds_dwordx4 v48, s[4:5]
    ds_read_b64_tr_b16 v[80:81], v58 offset:20544
    ds_read_b64_tr_b16 v[82:83], v58 offset:21824
    s_waitcnt lgkmcnt(8)
    v_mfma_f32_32x32x16_bf16 v[144:159], a[12:15], v[64:67], v[144:159]
    ds_read_b64_tr_b16 v[84:85], v58 offset:20576
    ds_read_b64_tr_b16 v[86:87], v58 offset:21856
    s_waitcnt lgkmcnt(8)
    v_mfma_f32_32x32x16_bf16 v[160:175], a[12:15], v[68:71], v[160:175]
    s_add_u32 m0, s34, 7168
    s_nop 0
    global_load_lds_dwordx4 v49, s[4:5]
    s_add_u32 s4, s4, 128
    s_addc_u32 s5, s5, 0
    ds_read_b64_tr_b16 v[64:65], v58 offset:20608
    ds_read_b64_tr_b16 v[66:67], v58 offset:21888
    s_waitcnt lgkmcnt(8)
    v_mfma_f32_32x32x16_bf16 v[96:111], a[16:19], v[72:75], v[96:111]
    ds_read_b64_tr_b16 v[68:69], v59 offset:20480
    ds_read_b64_tr_b16 v[70:71], v59 offset:21760
    s_waitcnt lgkmcnt(8)
    v_mfma_f32_32x32x16_bf16 v[112:127], a[16:19], v[76:79], v[112:127]
    ds_read_b64_tr_b16 v[72:73], v59 offset:20512
    ds_read_b64_tr_b16 v[74:75], v59 offset:21792
    s_waitcnt lgkmcnt(8)
    v_mfma_f32_32x32x16_bf16 v[128:143], a[16:19], v[80:83], v[128:143]
    ds_read_b64_tr_b16 v[76:77], v59 offset:20544
    ds_read_b64_tr_b16 v[78:79], v59 offset:21824
    s_waitcnt lgkmcnt(8)
    v_mfma_f32_32x32x16_bf16 v[144:159], a[16:19], v[84:87], v[144:159]
    ds_read_b64_tr_b16 v[80:81], v59 offset:20576
    ds_read_b64_tr_b16 v[82:83], v59 offset:21856
    s_waitcnt vmcnt(7)
    s_barrier
    s_waitcnt lgkmcnt(8)
    v_mfma_f32_32x32x16_bf16 v[160:175], a[16:19], v[64:67], v[160:175]
    ds_read_b64_tr_b16 v[84:85], v59 offset:20608
    ds_read_b64_tr_b16 v[86:87], v59 offset:21888
    s_waitcnt lgkmcnt(8)
    v_mfma_f32_32x32x16_bf16 v[96:111], a[20:23], v[68:71], v[96:111]
    ds_read_b128 a[0:3], v50 offset:0
    ds_read_b64_tr_b16 v[64:65], v60 offset:20480
    ds_read_b64_tr_b16 v[66:67], v60 offset:21760
    s_waitcnt lgkmcnt(9)
    v_mfma_f32_32x32x16_bf16 v[112:127], a[20:23], v[72:75], v[112:127]
    ds_read_b128 a[4:7], v51 offset:0
    ds_read_b64_tr_b16 v[68:69], v60 offset:20512
    ds_read_b64_tr_b16 v[70:71], v60 offset:21792
    s_waitcnt lgkmcnt(10)
    v_mfma_f32_32x32x16_bf16 v[128:143], a[20:23], v[76:79], v[128:143]
    ds_read_b128 a[8:11], v52 offset:0
    ds_read_b64_tr_b16 v[72:73], v60 offset:20544
    ds_read_b64_tr_b16 v[74:75], v60 offset:21824
    s_waitcnt lgkmcnt(11)
    v_mfma_f32_32x32x16_bf16 v[144:159], a[20:23], v[80:83], v[144:159]
    ds_read_b128 a[12:15], v53 offset:0
    ds_read_b64_tr_b16 v[76:77], v60 offset:20576
    ds_read_b64_tr_b16 v[78:79], v60 offset:21856
    s_waitcnt lgkmcnt(12)
    v_mfma_f32_32x32x16_bf16 v[160:175], a[20:23], v[84:87], v[160:175]
    ds_read_b64_tr_b16 v[80:81], v60 offset:20608
    ds_read_b64_tr_b16 v[82:83], v60 offset:21888
    s_waitcnt lgkmcnt(11)
    v_mfma_f32_32x32x16_bf16 v[96:111], a[24:27], v[64:67], v[96:111]
    ds_read_b64_tr_b16 v[84:85], v61 offset:20480
    ds_read_b64_tr_b16 v[86:87], v61 offset:21760
    s_waitcnt lgkmcnt(10)
    v_mfma_f32_32x32x16_bf16 v[112:127], a[24:27], v[68:71], v[112:127]
    ds_read_b64_tr_b16 v[64:65], v61 offset:20512
    ds_read_b64_tr_b16 v[66:67], v61 offset:21792
    s_waitcnt lgkmcnt(9)
    v_mfma_f32_32x32x16_bf16 v[128:143], a[24:27], v[72:75], v[128:143]
    ds_read_b64_tr_b16 v[68:69], v61 offset:20544
    ds_read_b64_tr_b16 v[70:71], v61 offset:21824
    s_waitcnt lgkmcnt(8)
    v_mfma_f32_32x32x16_bf16 v[144:159], a[24:27], v[76:79], v[144:159]
    ds_read_b64_tr_b16 v[72:73], v61 offset:20576
    ds_read_b64_tr_b16 v[74:75], v61 offset:21856
    s_waitcnt lgkmcnt(8)
    v_mfma_f32_32x32x16_bf16 v[160:175], a[24:27], v[80:83], v[160:175]
    ds_read_b64_tr_b16 v[76:77], v61 offset:20608
    ds_read_b64_tr_b16 v[78:79], v61 offset:21888
    s_waitcnt lgkmcnt(8)
    v_mfma_f32_32x32x16_bf16 v[96:111], a[28:31], v[84:87], v[96:111]
    ds_read_b64_tr_b16 v[80:81], v54 offset:0
    ds_read_b64_tr_b16 v[82:83], v54 offset:1280
    s_waitcnt lgkmcnt(8)
    v_mfma_f32_32x32x16_bf16 v[112:127], a[28:31], v[64:67], v[112:127]
    ds_read_b64_tr_b16 v[84:85], v54 offset:32
    ds_read_b64_tr_b16 v[86:87], v54 offset:1312
    s_waitcnt lgkmcnt(8)
    v_mfma_f32_32x32x16_bf16 v[128:143], a[28:31], v[68:71], v[128:143]
    ds_read_b64_tr_b16 v[64:65], v54 offset:64
    ds_read_b64_tr_b16 v[66:67], v54 offset:1344
    s_waitcnt lgkmcnt(8)
    v_mfma_f32_32x32x16_bf16 v[144:159], a[28:31], v[72:75], v[144:159]
    ds_read_b64_tr_b16 v[68:69], v54 offset:96
    ds_read_b64_tr_b16 v[70:71], v54 offset:1376
    s_waitcnt lgkmcnt(8)
    v_mfma_f32_32x32x16_bf16 v[160:175], a[28:31], v[76:79], v[160:175]
    ds_read_b64_tr_b16 v[72:73], v54 offset:128
    ds_read_b64_tr_b16 v[74:75], v54 offset:1408
    s_waitcnt lgkmcnt(8)
    v_mfma_f32_32x32x16_bf16 v[96:111], a[0:3], v[80:83], v[96:111]
    ds_read_b64_tr_b16 v[76:77], v55 offset:0
    ds_read_b64_tr_b16 v[78:79], v55 offset:1280
    s_waitcnt lgkmcnt(8)
    v_mfma_f32_32x32x16_bf16 v[112:127], a[0:3], v[84:87], v[112:127]
    ds_read_b64_tr_b16 v[80:81], v55 offset:32
    ds_read_b64_tr_b16 v[82:83], v55 offset:1312
    s_waitcnt lgkmcnt(8)
    v_mfma_f32_32x32x16_bf16 v[128:143], a[0:3], v[64:67], v[128:143]
    ds_read_b64_tr_b16 v[84:85], v55 offset:64
    ds_read_b64_tr_b16 v[86:87], v55 offset:1344
    s_waitcnt lgkmcnt(8)
    v_mfma_f32_32x32x16_bf16 v[144:159], a[0:3], v[68:71], v[144:159]
    ds_read_b64_tr_b16 v[64:65], v55 offset:96
    ds_read_b64_tr_b16 v[66:67], v55 offset:1376
    s_waitcnt vmcnt(0)
    s_barrier
    s_waitcnt lgkmcnt(8)
    v_mfma_f32_32x32x16_bf16 v[160:175], a[0:3], v[72:75], v[160:175]
    ds_read_b64_tr_b16 v[68:69], v55 offset:128
    ds_read_b64_tr_b16 v[70:71], v55 offset:1408
    s_waitcnt lgkmcnt(8)
    v_mfma_f32_32x32x16_bf16 v[96:111], a[4:7], v[76:79], v[96:111]
    ds_read_b128 a[16:19], v50 offset:4096
    ds_read_b64_tr_b16 v[72:73], v56 offset:0
    ds_read_b64_tr_b16 v[74:75], v56 offset:1280
    s_waitcnt lgkmcnt(9)
    v_mfma_f32_32x32x16_bf16 v[112:127], a[4:7], v[80:83], v[112:127]
    ds_read_b128 a[20:23], v51 offset:4096
    ds_read_b64_tr_b16 v[76:77], v56 offset:32
    ds_read_b64_tr_b16 v[78:79], v56 offset:1312
    s_waitcnt lgkmcnt(10)
    v_mfma_f32_32x32x16_bf16 v[128:143], a[4:7], v[84:87], v[128:143]
    ds_read_b128 a[24:27], v52 offset:4096
    ds_read_b64_tr_b16 v[80:81], v56 offset:64
    ds_read_b64_tr_b16 v[82:83], v56 offset:1344
    s_waitcnt lgkmcnt(11)
    v_mfma_f32_32x32x16_bf16 v[144:159], a[4:7], v[64:67], v[144:159]
    ds_read_b128 a[28:31], v53 offset:4096
    ds_read_b64_tr_b16 v[84:85], v56 offset:96
    ds_read_b64_tr_b16 v[86:87], v56 offset:1376
    s_waitcnt lgkmcnt(12)
    v_mfma_f32_32x32x16_bf16 v[160:175], a[4:7], v[68:71], v[160:175]
    ds_read_b64_tr_b16 v[64:65], v56 offset:128
    ds_read_b64_tr_b16 v[66:67], v56 offset:1408
    s_waitcnt lgkmcnt(11)
    v_mfma_f32_32x32x16_bf16 v[96:111], a[8:11], v[72:75], v[96:111]
    ds_read_b64_tr_b16 v[68:69], v57 offset:0
    ds_read_b64_tr_b16 v[70:71], v57 offset:1280
    s_waitcnt lgkmcnt(10)
    v_mfma_f32_32x32x16_bf16 v[112:127], a[8:11], v[76:79], v[112:127]
    ds_read_b64_tr_b16 v[72:73], v57 offset:32
    ds_read_b64_tr_b16 v[74:75], v57 offset:1312
    v_lshlrev_b32 v38, 2, v2
    global_load_dword v32, v38, s[44:45] sc0 sc1
    s_waitcnt lgkmcnt(9)
    v_mfma_f32_32x32x16_bf16 v[128:143], a[8:11], v[80:83], v[128:143]
    ds_read_b64_tr_b16 v[76:77], v57 offset:64
    ds_read_b64_tr_b16 v[78:79], v57 offset:1344
    s_waitcnt lgkmcnt(8)
    v_mfma_f32_32x32x16_bf16 v[144:159], a[8:11], v[84:87], v[144:159]
    ds_read_b64_tr_b16 v[80:81], v57 offset:96
    ds_read_b64_tr_b16 v[82:83], v57 offset:1376
    s_waitcnt lgkmcnt(8)
    v_mfma_f32_32x32x16_bf16 v[160:175], a[8:11], v[64:67], v[160:175]
    ds_read_b64_tr_b16 v[84:85], v57 offset:128
    ds_read_b64_tr_b16 v[86:87], v57 offset:1408
    s_waitcnt lgkmcnt(8)
    v_mfma_f32_32x32x16_bf16 v[96:111], a[12:15], v[68:71], v[96:111]
    ds_read_b64_tr_b16 v[64:65], v54 offset:20480
    ds_read_b64_tr_b16 v[66:67], v54 offset:21760
    s_waitcnt lgkmcnt(8)
    v_mfma_f32_32x32x16_bf16 v[112:127], a[12:15], v[72:75], v[112:127]
    ds_read_b64_tr_b16 v[68:69], v54 offset:20512
    ds_read_b64_tr_b16 v[70:71], v54 offset:21792
    s_waitcnt lgkmcnt(8)
    v_mfma_f32_32x32x16_bf16 v[128:143], a[12:15], v[76:79], v[128:143]
    ds_read_b64_tr_b16 v[72:73], v54 offset:20544
    ds_read_b64_tr_b16 v[74:75], v54 offset:21824
    s_waitcnt lgkmcnt(8)
    v_mfma_f32_32x32x16_bf16 v[144:159], a[12:15], v[80:83], v[144:159]
    ds_read_b64_tr_b16 v[76:77], v54 offset:20576
    ds_read_b64_tr_b16 v[78:79], v54 offset:21856
    s_waitcnt lgkmcnt(8)
    v_mfma_f32_32x32x16_bf16 v[160:175], a[12:15], v[84:87], v[160:175]
    ds_read_b64_tr_b16 v[80:81], v54 offset:20608
    ds_read_b64_tr_b16 v[82:83], v54 offset:21888
    s_waitcnt lgkmcnt(8)
    v_mfma_f32_32x32x16_bf16 v[96:111], a[16:19], v[64:67], v[96:111]
    ds_read_b64_tr_b16 v[84:85], v55 offset:20480
    ds_read_b64_tr_b16 v[86:87], v55 offset:21760
    s_waitcnt lgkmcnt(8)
    v_mfma_f32_32x32x16_bf16 v[112:127], a[16:19], v[68:71], v[112:127]
    ds_read_b64_tr_b16 v[64:65], v55 offset:20512
    ds_read_b64_tr_b16 v[66:67], v55 offset:21792
    s_waitcnt lgkmcnt(8)
    v_mfma_f32_32x32x16_bf16 v[128:143], a[16:19], v[72:75], v[128:143]
    ds_read_b64_tr_b16 v[68:69], v55 offset:20544
    ds_read_b64_tr_b16 v[70:71], v55 offset:21824
    s_waitcnt lgkmcnt(8)
    v_mfma_f32_32x32x16_bf16 v[144:159], a[16:19], v[76:79], v[144:159]
    ds_read_b64_tr_b16 v[72:73], v55 offset:20576
    ds_read_b64_tr_b16 v[74:75], v55 offset:21856
    s_waitcnt lgkmcnt(8)
    v_mfma_f32_32x32x16_bf16 v[160:175], a[16:19], v[80:83], v[160:175]
    ds_read_b64_tr_b16 v[76:77], v55 offset:20608
    ds_read_b64_tr_b16 v[78:79], v55 offset:21888
    s_waitcnt lgkmcnt(8)
    v_mfma_f32_32x32x16_bf16 v[96:111], a[20:23], v[84:87], v[96:111]
    ds_read_b64_tr_b16 v[80:81], v56 offset:20480
    ds_read_b64_tr_b16 v[82:83], v56 offset:21760
    s_waitcnt lgkmcnt(8)
    v_mfma_f32_32x32x16_bf16 v[112:127], a[20:23], v[64:67], v[112:127]
    ds_read_b64_tr_b16 v[84:85], v56 offset:20512
    ds_read_b64_tr_b16 v[86:87], v56 offset:21792
    s_waitcnt lgkmcnt(8)
    v_mfma_f32_32x32x16_bf16 v[128:143], a[20:23], v[68:71], v[128:143]
    ds_read_b64_tr_b16 v[64:65], v56 offset:20544
    ds_read_b64_tr_b16 v[66:67], v56 offset:21824
    s_waitcnt lgkmcnt(8)
    v_mfma_f32_32x32x16_bf16 v[144:159], a[20:23], v[72:75], v[144:159]
    ds_read_b64_tr_b16 v[68:69], v56 offset:20576
    ds_read_b64_tr_b16 v[70:71], v56 offset:21856
    s_waitcnt lgkmcnt(8)
    v_mfma_f32_32x32x16_bf16 v[160:175], a[20:23], v[76:79], v[160:175]
    ds_read_b64_tr_b16 v[72:73], v56 offset:20608
    ds_read_b64_tr_b16 v[74:75], v56 offset:21888
    s_waitcnt vmcnt(0)
    v_cmp_ne_u32 vcc, 0x01010101, v32
    v_lshlrev_b32 v38, 3, v3
    s_nop 2
    s_cmp_eq_u64 vcc, 0
    s_cselect_b32 s48, 1, 0
    s_cbranch_scc0 L_nopre_a5e0_11
    global_load_dwordx2 v[30:31], v38, s[42:43] sc0 sc1
    global_load_dword v10, v8, s[54:55] offset:-2560 sc0 sc1
    global_load_dword v11, v8, s[54:55] offset:-1920 sc0 sc1
    global_load_dword v12, v8, s[54:55] offset:-1280 sc0 sc1
    global_load_dword v13, v8, s[54:55] offset:-640 sc0 sc1
    global_load_dword v14, v8, s[54:55] offset:0 sc0 sc1
    global_load_dword v15, v8, s[54:55] offset:640 sc0 sc1
    global_load_dword v16, v8, s[54:55] offset:1280 sc0 sc1
    global_load_dword v17, v8, s[54:55] offset:1920 sc0 sc1
L_nopre_a5e0_11:
    s_waitcnt lgkmcnt(8)
    v_mfma_f32_32x32x16_bf16 v[96:111], a[24:27], v[80:83], v[96:111]
    ds_read_b64_tr_b16 v[76:77], v57 offset:20480
    ds_read_b64_tr_b16 v[78:79], v57 offset:21760
    s_waitcnt lgkmcnt(8)
    v_mfma_f32_32x32x16_bf16 v[112:127], a[24:27], v[84:87], v[112:127]
    ds_read_b64_tr_b16 v[80:81], v57 offset:20512
    ds_read_b64_tr_b16 v[82:83], v57 offset:21792
    s_waitcnt lgkmcnt(8)
    v_mfma_f32_32x32x16_bf16 v[128:143], a[24:27], v[64:67], v[128:143]
    ds_read_b64_tr_b16 v[84:85], v57 offset:20544
    ds_read_b64_tr_b16 v[86:87], v57 offset:21824
    s_waitcnt lgkmcnt(8)
    v_mfma_f32_32x32x16_bf16 v[144:159], a[24:27], v[68:71], v[144:159]
    ds_read_b64_tr_b16 v[64:65], v57 offset:20576
    ds_read_b64_tr_b16 v[66:67], v57 offset:21856
    s_waitcnt lgkmcnt(8)
    v_mfma_f32_32x32x16_bf16 v[160:175], a[24:27], v[72:75], v[160:175]
    ds_read_b64_tr_b16 v[68:69], v57 offset:20608
    ds_read_b64_tr_b16 v[70:71], v57 offset:21888
    s_waitcnt lgkmcnt(8)
    v_mfma_f32_32x32x16_bf16 v[96:111], a[28:31], v[76:79], v[96:111]
    s_waitcnt lgkmcnt(6)
    v_mfma_f32_32x32x16_bf16 v[112:127], a[28:31], v[80:83], v[112:127]
    s_cmp_eq_u32 s48, 1
    s_cbranch_scc0 L_nocs_a5e0_12
    s_waitcnt vmcnt(0)
    v_add_f32 v10, v10, v11
    v_add_f32 v12, v12, v13
    v_add_f32 v14, v14, v15
    v_add_f32 v16, v16, v17
    v_add_f32 v10, v10, v12
    v_add_f32 v14, v14, v16
    v_add_f32 v10, v10, v14
    v_min_u32 v5, 255, v0
    v_lshlrev_b32 v5, 2, v5
    v_add_u32 v5, 147456, v5
    ds_write_b32 v5, v10
    s_waitcnt lgkmcnt(0)

L_nocs_a5e0_12:
    s_waitcnt lgkmcnt(4)
    v_mfma_f32_32x32x16_bf16 v[128:143], a[28:31], v[84:87], v[128:143]
    s_waitcnt lgkmcnt(2)
    v_mfma_f32_32x32x16_bf16 v[144:159], a[28:31], v[64:67], v[144:159]
    s_waitcnt lgkmcnt(0)
    v_mfma_f32_32x32x16_bf16 v[160:175], a[28:31], v[68:71], v[160:175]
    s_cmp_eq_u32 s48, 1
    s_cbranch_scc1 L_k1_bar1
    s_mov_b32 s40, 4096
    v_lshlrev_b32 v5, 2, v2
    s_mov_b32 s41, 0x01010101

L_k1_poll1:
    global_load_dword v6, v5, s[44:45] sc0 sc1
    s_waitcnt vmcnt(0)
    v_cmp_ne_u32 vcc, s41, v6
    s_nop 3
    s_cmp_eq_u64 vcc, 0
    s_cbranch_scc1 L_k1_ok1
    s_sleep 4
    s_sub_u32 s40, s40, 1
    s_cmp_lg_u32 s40, 0
    s_cbranch_scc1 L_k1_poll1
    v_lshrrev_b32 v9, 4, v2
    v_add_u32 v9, s22, v9
    v_lshlrev_b32 v7, 3, v9
    v_mul_u32_u24 v9, 1280, v9
    v_and_b32 v6, 15, v2
    v_lshl_add_u32 v9, v6, 4, v9
    s_mov_b32 s40, 8

L_k1_fb1:
    global_load_dwordx4 v[64:67], v9, s[38:39] offset:0
    global_load_dwordx4 v[68:71], v9, s[38:39] offset:256
    global_load_dwordx4 v[72:75], v9, s[38:39] offset:512
    global_load_dwordx4 v[76:79], v9, s[38:39] offset:768
    global_load_dwordx4 v[80:83], v9, s[38:39] offset:1024
    s_waitcnt vmcnt(0)
    v_mov_b32 v30, 0
    v_mov_b32 v31, 0
    v_mov_b32 v33, 0
    v_mov_b32 v34, 0
    v_mov_b32 v5, v64
    v_lshlrev_b32 v6, 16, v5
    v_and_b32 v5, 0xffff0000, v5
    v_add_f32 v30, v30, v6
    v_add_f32 v31, v31, v5
    v_mov_b32 v5, v65
    v_lshlrev_b32 v6, 16, v5
    v_and_b32 v5, 0xffff0000, v5
    v_add_f32 v33, v33, v6
    v_add_f32 v34, v34, v5
    v_mov_b32 v5, v66
    v_lshlrev_b32 v6, 16, v5
    v_and_b32 v5, 0xffff0000, v5
    v_add_f32 v30, v30, v6
    v_add_f32 v31, v31, v5
    v_mov_b32 v5, v67
    v_lshlrev_b32 v6, 16, v5
    v_and_b32 v5, 0xffff0000, v5
    v_add_f32 v33, v33, v6
    v_add_f32 v34, v34, v5
    v_mov_b32 v5, v68
    v_lshlrev_b32 v6, 16, v5
    v_and_b32 v5, 0xffff0000, v5
    v_add_f32 v30, v30, v6
    v_add_f32 v31, v31, v5
    v_mov_b32 v5, v69
    v_lshlrev_b32 v6, 16, v5
    v_and_b32 v5, 0xffff0000, v5
    v_add_f32 v33, v33, v6
    v_add_f32 v34, v34, v5
    v_mov_b32 v5, v70
    v_lshlrev_b32 v6, 16, v5
    v_and_b32 v5, 0xffff0000, v5
    v_add_f32 v30, v30, v6
    v_add_f32 v31, v31, v5
    v_mov_b32 v5, v71
    v_lshlrev_b32 v6, 16, v5
    v_and_b32 v5, 0xffff0000, v5
    v_add_f32 v33, v33, v6
    v_add_f32 v34, v34, v5
    v_mov_b32 v5, v72
    v_lshlrev_b32 v6, 16, v5
    v_and_b32 v5, 0xffff0000, v5
    v_add_f32 v30, v30, v6
    v_add_f32 v31, v31, v5
    v_mov_b32 v5, v73
    v_lshlrev_b32 v6, 16, v5
    v_and_b32 v5, 0xffff0000, v5
    v_add_f32 v33, v33, v6
    v_add_f32 v34, v34, v5
    v_mov_b32 v5, v74
    v_lshlrev_b32 v6, 16, v5
    v_and_b32 v5, 0xffff0000, v5
    v_add_f32 v30, v30, v6
    v_add_f32 v31, v31, v5
    v_mov_b32 v5, v75
    v_lshlrev_b32 v6, 16, v5
    v_and_b32 v5, 0xffff0000, v5
    v_add_f32 v33, v33, v6
    v_add_f32 v34, v34, v5
    v_mov_b32 v5, v76
    v_lshlrev_b32 v6, 16, v5
    v_and_b32 v5, 0xffff0000, v5
    v_add_f32 v30, v30, v6
    v_add_f32 v31, v31, v5
    v_mov_b32 v5, v77
    v_lshlrev_b32 v6, 16, v5
    v_and_b32 v5, 0xffff0000, v5
    v_add_f32 v33, v33, v6
    v_add_f32 v34, v34, v5
    v_mov_b32 v5, v78
    v_lshlrev_b32 v6, 16, v5
    v_and_b32 v5, 0xffff0000, v5
    v_add_f32 v30, v30, v6
    v_add_f32 v31, v31, v5
    v_mov_b32 v5, v79
    v_lshlrev_b32 v6, 16, v5
    v_and_b32 v5, 0xffff0000, v5
    v_add_f32 v33, v33, v6
    v_add_f32 v34, v34, v5
    v_mov_b32 v5, v80
    v_lshlrev_b32 v6, 16, v5
    v_and_b32 v5, 0xffff0000, v5
    v_add_f32 v30, v30, v6
    v_add_f32 v31, v31, v5
    v_mov_b32 v5, v81
    v_lshlrev_b32 v6, 16, v5
    v_and_b32 v5, 0xffff0000, v5
    v_add_f32 v33, v33, v6
    v_add_f32 v34, v34, v5
    v_mov_b32 v5, v82
    v_lshlrev_b32 v6, 16, v5
    v_and_b32 v5, 0xffff0000, v5
    v_add_f32 v30, v30, v6
    v_add_f32 v31, v31, v5
    v_mov_b32 v5, v83
    v_lshlrev_b32 v6, 16, v5
    v_and_b32 v5, 0xffff0000, v5
    v_add_f32 v33, v33, v6
    v_add_f32 v34, v34, v5
    v_add_f32 v30, v30, v31
    v_add_f32 v33, v33, v34
    v_add_f32 v30, v30, v33
    s_nop 1
    v_add_f32_dpp v30, v30, v30 row_ror:8 row_mask:0xf bank_mask:0xf
    s_nop 1
    v_add_f32_dpp v30, v30, v30 row_ror:4 row_mask:0xf bank_mask:0xf
    s_nop 1
    v_add_f32_dpp v30, v30, v30 row_ror:2 row_mask:0xf bank_mask:0xf
    s_nop 1
    v_add_f32_dpp v30, v30, v30 row_ror:1 row_mask:0xf bank_mask:0xf
    v_mul_f32 v30, 0x3acccccd, v30
    v_mov_b32 v31, 0
    v_mov_b32 v33, 0
    v_mov_b32 v5, v64
    v_lshlrev_b32 v6, 16, v5
    v_and_b32 v5, 0xffff0000, v5
    v_sub_f32 v6, v6, v30
    v_sub_f32 v5, v5, v30
    v_fmac_f32 v31, v6, v6
    v_fmac_f32 v33, v5, v5
    v_mov_b32 v5, v65
    v_lshlrev_b32 v6, 16, v5
    v_and_b32 v5, 0xffff0000, v5
    v_sub_f32 v6, v6, v30
    v_sub_f32 v5, v5, v30
    v_fmac_f32 v31, v6, v6
    v_fmac_f32 v33, v5, v5
    v_mov_b32 v5, v66
    v_lshlrev_b32 v6, 16, v5
    v_and_b32 v5, 0xffff0000, v5
    v_sub_f32 v6, v6, v30
    v_sub_f32 v5, v5, v30
    v_fmac_f32 v31, v6, v6
    v_fmac_f32 v33, v5, v5
    v_mov_b32 v5, v67
    v_lshlrev_b32 v6, 16, v5
    v_and_b32 v5, 0xffff0000, v5
    v_sub_f32 v6, v6, v30
    v_sub_f32 v5, v5, v30
    v_fmac_f32 v31, v6, v6
    v_fmac_f32 v33, v5, v5
    v_mov_b32 v5, v68
    v_lshlrev_b32 v6, 16, v5
    v_and_b32 v5, 0xffff0000, v5
    v_sub_f32 v6, v6, v30
    v_sub_f32 v5, v5, v30
    v_fmac_f32 v31, v6, v6
    v_fmac_f32 v33, v5, v5
    v_mov_b32 v5, v69
    v_lshlrev_b32 v6, 16, v5
    v_and_b32 v5, 0xffff0000, v5
    v_sub_f32 v6, v6, v30
    v_sub_f32 v5, v5, v30
    v_fmac_f32 v31, v6, v6
    v_fmac_f32 v33, v5, v5
    v_mov_b32 v5, v70
    v_lshlrev_b32 v6, 16, v5
    v_and_b32 v5, 0xffff0000, v5
    v_sub_f32 v6, v6, v30
    v_sub_f32 v5, v5, v30
    v_fmac_f32 v31, v6, v6
    v_fmac_f32 v33, v5, v5
    v_mov_b32 v5, v71
    v_lshlrev_b32 v6, 16, v5
    v_and_b32 v5, 0xffff0000, v5
    v_sub_f32 v6, v6, v30
    v_sub_f32 v5, v5, v30
    v_fmac_f32 v31, v6, v6
    v_fmac_f32 v33, v5, v5
    v_mov_b32 v5, v72
    v_lshlrev_b32 v6, 16, v5
    v_and_b32 v5, 0xffff0000, v5
    v_sub_f32 v6, v6, v30
    v_sub_f32 v5, v5, v30
    v_fmac_f32 v31, v6, v6
    v_fmac_f32 v33, v5, v5
    v_mov_b32 v5, v73
    v_lshlrev_b32 v6, 16, v5
    v_and_b32 v5, 0xffff0000, v5
    v_sub_f32 v6, v6, v30
    v_sub_f32 v5, v5, v30
    v_fmac_f32 v31, v6, v6
    v_fmac_f32 v33, v5, v5
    v_mov_b32 v5, v74
    v_lshlrev_b32 v6, 16, v5
    v_and_b32 v5, 0xffff0000, v5
    v_sub_f32 v6, v6, v30
    v_sub_f32 v5, v5, v30
    v_fmac_f32 v31, v6, v6
    v_fmac_f32 v33, v5, v5
    v_mov_b32 v5, v75
    v_lshlrev_b32 v6, 16, v5
    v_and_b32 v5, 0xffff0000, v5
    v_sub_f32 v6, v6, v30
    v_sub_f32 v5, v5, v30
    v_fmac_f32 v31, v6, v6
    v_fmac_f32 v33, v5, v5
    v_mov_b32 v5, v76
    v_lshlrev_b32 v6, 16, v5
    v_and_b32 v5, 0xffff0000, v5
    v_sub_f32 v6, v6, v30
    v_sub_f32 v5, v5, v30
    v_fmac_f32 v31, v6, v6
    v_fmac_f32 v33, v5, v5
    v_mov_b32 v5, v77
    v_lshlrev_b32 v6, 16, v5
    v_and_b32 v5, 0xffff0000, v5
    v_sub_f32 v6, v6, v30
    v_sub_f32 v5, v5, v30
    v_fmac_f32 v31, v6, v6
    v_fmac_f32 v33, v5, v5
    v_mov_b32 v5, v78
    v_lshlrev_b32 v6, 16, v5
    v_and_b32 v5, 0xffff0000, v5
    v_sub_f32 v6, v6, v30
    v_sub_f32 v5, v5, v30
    v_fmac_f32 v31, v6, v6
    v_fmac_f32 v33, v5, v5
    v_mov_b32 v5, v79
    v_lshlrev_b32 v6, 16, v5
    v_and_b32 v5, 0xffff0000, v5
    v_sub_f32 v6, v6, v30
    v_sub_f32 v5, v5, v30
    v_fmac_f32 v31, v6, v6
    v_fmac_f32 v33, v5, v5
    v_mov_b32 v5, v80
    v_lshlrev_b32 v6, 16, v5
    v_and_b32 v5, 0xffff0000, v5
    v_sub_f32 v6, v6, v30
    v_sub_f32 v5, v5, v30
    v_fmac_f32 v31, v6, v6
    v_fmac_f32 v33, v5, v5
    v_mov_b32 v5, v81
    v_lshlrev_b32 v6, 16, v5
    v_and_b32 v5, 0xffff0000, v5
    v_sub_f32 v6, v6, v30
    v_sub_f32 v5, v5, v30
    v_fmac_f32 v31, v6, v6
    v_fmac_f32 v33, v5, v5
    v_mov_b32 v5, v82
    v_lshlrev_b32 v6, 16, v5
    v_and_b32 v5, 0xffff0000, v5
    v_sub_f32 v6, v6, v30
    v_sub_f32 v5, v5, v30
    v_fmac_f32 v31, v6, v6
    v_fmac_f32 v33, v5, v5
    v_mov_b32 v5, v83
    v_lshlrev_b32 v6, 16, v5
    v_and_b32 v5, 0xffff0000, v5
    v_sub_f32 v6, v6, v30
    v_sub_f32 v5, v5, v30
    v_fmac_f32 v31, v6, v6
    v_fmac_f32 v33, v5, v5
    v_add_f32 v31, v31, v33
    s_nop 1
    v_add_f32_dpp v31, v31, v31 row_ror:8 row_mask:0xf bank_mask:0xf
    s_nop 1
    v_add_f32_dpp v31, v31, v31 row_ror:4 row_mask:0xf bank_mask:0xf
    s_nop 1
    v_add_f32_dpp v31, v31, v31 row_ror:2 row_mask:0xf bank_mask:0xf
    s_nop 1
    v_add_f32_dpp v31, v31, v31 row_ror:1 row_mask:0xf bank_mask:0xf
    v_mul_f32 v31, 0x3acccccd, v31
    v_cvt_pk_bf16_f32 v5, v30, v31
    v_lshlrev_b32 v30, 16, v5
    v_and_b32 v31, 0xffff0000, v5
    v_add_f32 v31, 0x3727c5ac, v31
    v_cvt_pk_bf16_f32 v5, v31, v31
    v_lshlrev_b32 v31, 16, v5
    v_sqrt_f32 v31, v31
    s_nop 0
    v_cvt_pk_bf16_f32 v5, v31, v31
    v_lshlrev_b32 v31, 16, v5
    v_rcp_f32 v31, v31
    s_nop 0
    s_mov_b32 exec_lo, 0x00010001
    s_mov_b32 exec_hi, 0x00010001
    global_store_dwordx2 v7, v[30:31], s[42:43] sc0 sc1
    s_mov_b64 exec, -1
    v_add_u32 v9, 5120, v9
    v_add_u32 v7, 32, v7
    s_sub_u32 s40, s40, 1
    s_cmp_lg_u32 s40, 0
    s_cbranch_scc1 L_k1_fb1
    v_lshrrev_b32 v6, 1, v8
    v_cmp_le_u32 vcc, 160, v6
    v_mov_b32 v11, s56
    v_mov_b32 v12, s57
    v_mov_b32 v13, s58
    v_mov_b32 v14, s59
    v_cndmask_b32 v11, v11, v13, vcc
    v_cndmask_b32 v12, v12, v14, vcc
    v_add_co_u32 v28, vcc, v11, v6
    v_addc_co_u32 v29, vcc, 0, v12, vcc
    v_mov_b32 v10, 0
    s_mov_b32 s40, 640

L_k1_fc1:
    global_load_ushort v11, v[28:29], off
    v_add_co_u32 v28, vcc, s49, v28
    v_addc_co_u32 v29, vcc, 0, v29, vcc
    s_waitcnt vmcnt(0)
    v_lshlrev_b32 v11, 16, v11
    v_add_f32 v10, v10, v11
    s_sub_u32 s40, s40, 1
    s_cmp_lg_u32 s40, 0
    s_cbranch_scc1 L_k1_fc1
    v_lshlrev_b32 v5, 3, v3
    global_load_dwordx2 v[30:31], v5, s[42:43] sc0 sc1
    s_waitcnt vmcnt(0)
    s_branch L_k1_csd1

L_k1_ok1:
    v_lshlrev_b32 v5, 3, v3
    global_load_dwordx2 v[30:31], v5, s[42:43] sc0 sc1

    global_load_dword v10, v8, s[54:55] offset:-2560 sc0 sc1
    global_load_dword v11, v8, s[54:55] offset:-1920 sc0 sc1
    global_load_dword v12, v8, s[54:55] offset:-1280 sc0 sc1
    global_load_dword v13, v8, s[54:55] offset:-640 sc0 sc1
    global_load_dword v14, v8, s[54:55] offset:0 sc0 sc1
    global_load_dword v15, v8, s[54:55] offset:640 sc0 sc1
    global_load_dword v16, v8, s[54:55] offset:1280 sc0 sc1
    global_load_dword v17, v8, s[54:55] offset:1920 sc0 sc1
L_k1_fast1:
    s_waitcnt vmcnt(0)
    v_add_f32 v10, v10, v11
    v_add_f32 v12, v12, v13
    v_add_f32 v14, v14, v15
    v_add_f32 v16, v16, v17
    v_add_f32 v10, v10, v12
    v_add_f32 v14, v14, v16
    v_add_f32 v10, v10, v14

L_k1_csd1:
    v_min_u32 v5, 255, v0
    v_lshlrev_b32 v5, 2, v5
    v_add_u32 v5, 147456, v5
    ds_write_b32 v5, v10
    s_waitcnt lgkmcnt(0)

L_k1_bar1:
    s_barrier
    s_lshl_b32 s29, s22, 3
    v_lshlrev_b32 v5, 5, v4
    v_add_u32 v5, s29, v5
    v_and_b32 v6, 31, v2
    v_lshlrev_b32 v6, 2, v6
    v_add_u32 v6, 147456, v6

    global_load_dwordx4 v[40:43], v5, s[42:43] offset:0 sc0 sc1
    global_load_dwordx4 v[44:47], v5, s[42:43] offset:16 sc0 sc1
    global_load_dwordx4 v[48:51], v5, s[42:43] offset:64 sc0 sc1
    global_load_dwordx4 v[52:55], v5, s[42:43] offset:80 sc0 sc1
    global_load_dwordx4 v[56:59], v5, s[42:43] offset:128 sc0 sc1
    global_load_dwordx4 v[60:63], v5, s[42:43] offset:144 sc0 sc1
    global_load_dwordx4 v[64:67], v5, s[42:43] offset:192 sc0 sc1
    global_load_dwordx4 v[68:71], v5, s[42:43] offset:208 sc0 sc1
    ds_read_b32 v88, v6 offset:0
    ds_read_b32 v89, v6 offset:128
    ds_read_b32 v90, v6 offset:256
    ds_read_b32 v91, v6 offset:384
    ds_read_b32 v92, v6 offset:512
    s_waitcnt vmcnt(0) lgkmcnt(0)
    v_fma_f32 v96, -v40, v88, v96
    v_mul_f32 v96, v96, v41
    v_fma_f32 v97, -v42, v88, v97
    v_mul_f32 v97, v97, v43
    v_fma_f32 v98, -v44, v88, v98
    v_mul_f32 v98, v98, v45
    v_fma_f32 v99, -v46, v88, v99
    v_mul_f32 v99, v99, v47
    v_fma_f32 v100, -v48, v88, v100
    v_mul_f32 v100, v100, v49
    v_fma_f32 v101, -v50, v88, v101
    v_mul_f32 v101, v101, v51
    v_fma_f32 v102, -v52, v88, v102
    v_mul_f32 v102, v102, v53
    v_fma_f32 v103, -v54, v88, v103
    v_mul_f32 v103, v103, v55
    v_fma_f32 v104, -v56, v88, v104
    v_mul_f32 v104, v104, v57
    v_fma_f32 v105, -v58, v88, v105
    v_mul_f32 v105, v105, v59
    v_fma_f32 v106, -v60, v88, v106
    v_mul_f32 v106, v106, v61
    v_fma_f32 v107, -v62, v88, v107
    v_mul_f32 v107, v107, v63
    v_fma_f32 v108, -v64, v88, v108
    v_mul_f32 v108, v108, v65
    v_fma_f32 v109, -v66, v88, v109
    v_mul_f32 v109, v109, v67
    v_fma_f32 v110, -v68, v88, v110
    v_mul_f32 v110, v110, v69
    v_fma_f32 v111, -v70, v88, v111
    v_mul_f32 v111, v111, v71
    v_fma_f32 v112, -v40, v89, v112
    v_mul_f32 v112, v112, v41
    v_fma_f32 v113, -v42, v89, v113
    v_mul_f32 v113, v113, v43
    v_fma_f32 v114, -v44, v89, v114
    v_mul_f32 v114, v114, v45
    v_fma_f32 v115, -v46, v89, v115
    v_mul_f32 v115, v115, v47
    v_fma_f32 v116, -v48, v89, v116
    v_mul_f32 v116, v116, v49
    v_fma_f32 v117, -v50, v89, v117
    v_mul_f32 v117, v117, v51
    v_fma_f32 v118, -v52, v89, v118
    v_mul_f32 v118, v118, v53
    v_fma_f32 v119, -v54, v89, v119
    v_mul_f32 v119, v119, v55
    v_fma_f32 v120, -v56, v89, v120
    v_mul_f32 v120, v120, v57
    v_fma_f32 v121, -v58, v89, v121
    v_mul_f32 v121, v121, v59
    v_fma_f32 v122, -v60, v89, v122
    v_mul_f32 v122, v122, v61
    v_fma_f32 v123, -v62, v89, v123
    v_mul_f32 v123, v123, v63
    v_fma_f32 v124, -v64, v89, v124
    v_mul_f32 v124, v124, v65
    v_fma_f32 v125, -v66, v89, v125
    v_mul_f32 v125, v125, v67
    v_fma_f32 v126, -v68, v89, v126
    v_mul_f32 v126, v126, v69
    v_fma_f32 v127, -v70, v89, v127
    v_mul_f32 v127, v127, v71
    v_fma_f32 v128, -v40, v90, v128
    v_mul_f32 v128, v128, v41
    v_fma_f32 v129, -v42, v90, v129
    v_mul_f32 v129, v129, v43
    v_fma_f32 v130, -v44, v90, v130
    v_mul_f32 v130, v130, v45
    v_fma_f32 v131, -v46, v90, v131
    v_mul_f32 v131, v131, v47
    v_fma_f32 v132, -v48, v90, v132
    v_mul_f32 v132, v132, v49
    v_fma_f32 v133, -v50, v90, v133
    v_mul_f32 v133, v133, v51
    v_fma_f32 v134, -v52, v90, v134
    v_mul_f32 v134, v134, v53
    v_fma_f32 v135, -v54, v90, v135
    v_mul_f32 v135, v135, v55
    v_fma_f32 v136, -v56, v90, v136
    v_mul_f32 v136, v136, v57
    v_fma_f32 v137, -v58, v90, v137
    v_mul_f32 v137, v137, v59
    v_fma_f32 v138, -v60, v90, v138
    v_mul_f32 v138, v138, v61
    v_fma_f32 v139, -v62, v90, v139
    v_mul_f32 v139, v139, v63
    v_fma_f32 v140, -v64, v90, v140
    v_mul_f32 v140, v140, v65
    v_fma_f32 v141, -v66, v90, v141
    v_mul_f32 v141, v141, v67
    v_fma_f32 v142, -v68, v90, v142
    v_mul_f32 v142, v142, v69
    v_fma_f32 v143, -v70, v90, v143
    v_mul_f32 v143, v143, v71
    v_fma_f32 v144, -v40, v91, v144
    v_mul_f32 v144, v144, v41
    v_fma_f32 v145, -v42, v91, v145
    v_mul_f32 v145, v145, v43
    v_fma_f32 v146, -v44, v91, v146
    v_mul_f32 v146, v146, v45
    v_fma_f32 v147, -v46, v91, v147
    v_mul_f32 v147, v147, v47
    v_fma_f32 v148, -v48, v91, v148
    v_mul_f32 v148, v148, v49
    v_fma_f32 v149, -v50, v91, v149
    v_mul_f32 v149, v149, v51
    v_fma_f32 v150, -v52, v91, v150
    v_mul_f32 v150, v150, v53
    v_fma_f32 v151, -v54, v91, v151
    v_mul_f32 v151, v151, v55
    v_fma_f32 v152, -v56, v91, v152
    v_mul_f32 v152, v152, v57
    v_fma_f32 v153, -v58, v91, v153
    v_mul_f32 v153, v153, v59
    v_fma_f32 v154, -v60, v91, v154
    v_mul_f32 v154, v154, v61
    v_fma_f32 v155, -v62, v91, v155
    v_mul_f32 v155, v155, v63
    v_fma_f32 v156, -v64, v91, v156
    v_mul_f32 v156, v156, v65
    v_fma_f32 v157, -v66, v91, v157
    v_mul_f32 v157, v157, v67
    v_fma_f32 v158, -v68, v91, v158
    v_mul_f32 v158, v158, v69
    v_fma_f32 v159, -v70, v91, v159
    v_mul_f32 v159, v159, v71
    v_fma_f32 v160, -v40, v92, v160
    v_mul_f32 v160, v160, v41
    v_fma_f32 v161, -v42, v92, v161
    v_mul_f32 v161, v161, v43
    v_fma_f32 v162, -v44, v92, v162
    v_mul_f32 v162, v162, v45
    v_fma_f32 v163, -v46, v92, v163
    v_mul_f32 v163, v163, v47
    v_fma_f32 v164, -v48, v92, v164
    v_mul_f32 v164, v164, v49
    v_fma_f32 v165, -v50, v92, v165
    v_mul_f32 v165, v165, v51
    v_fma_f32 v166, -v52, v92, v166
    v_mul_f32 v166, v166, v53
    v_fma_f32 v167, -v54, v92, v167
    v_mul_f32 v167, v167, v55
    v_fma_f32 v168, -v56, v92, v168
    v_mul_f32 v168, v168, v57
    v_fma_f32 v169, -v58, v92, v169
    v_mul_f32 v169, v169, v59
    v_fma_f32 v170, -v60, v92, v170
    v_mul_f32 v170, v170, v61
    v_fma_f32 v171, -v62, v92, v171
    v_mul_f32 v171, v171, v63
    v_fma_f32 v172, -v64, v92, v172
    v_mul_f32 v172, v172, v65
    v_fma_f32 v173, -v66, v92, v173
    v_mul_f32 v173, v173, v67
    v_fma_f32 v174, -v68, v92, v174
    v_mul_f32 v174, v174, v69
    v_fma_f32 v175, -v70, v92, v175
    v_mul_f32 v175, v175, v71
    s_sub_u32 s28, s13, 8
    s_mul_i32 s28, s28, 655360
    s_lshr_b32 s29, s22, 5
    s_mul_i32 s29, s29, 1280
    s_add_u32 s28, s28, s29
    s_add_u32 s28, s28, 11534336
    v_and_b32 v5, 15, v2
    v_lshrrev_b32 v6, 4, v2
    v_and_b32 v6, 1, v6
    v_mul_u32_u24 v6, 80, v6
    v_add_u32 v5, v5, v6
    v_mov_b32 v20, 256
    v_mov_b32 v21, 64

    v_add_u32 v6, 0, v5
    v_mul_u32_u24 v7, 3277, v6
    v_lshrrev_b32 v7, 16, v7
    v_mul_u32_u24 v16, 20, v7
    v_sub_u32 v6, v6, v16
    v_mul_u32_u24 v7, 81920, v7
    v_lshlrev_b32 v16, 4, v6
    v_add_u32 v17, 768, v16
    v_cmp_gt_u32 vcc, 16, v6
    s_nop 1
    v_cndmask_b32 v16, v17, v16, vcc
    v_cndmask_b32 v17, v21, v20, vcc
    v_add_u32 v7, v7, v16
    v_mad_u32_u24 v18, v17, v4, v7
    v_lshl_add_u32 v19, v17, 1, v18

    v_cvt_pk_bf16_f32 v24, v96, v97
    v_cvt_pk_bf16_f32 v25, v98, v99
    v_cvt_pk_bf16_f32 v26, v104, v105
    v_cvt_pk_bf16_f32 v27, v106, v107
    buffer_store_dwordx4 v[24:27], v18, s[8:11], s28 offen sc1
    v_cvt_pk_bf16_f32 v28, v100, v101
    v_cvt_pk_bf16_f32 v29, v102, v103
    v_cvt_pk_bf16_f32 v30, v108, v109
    v_cvt_pk_bf16_f32 v31, v110, v111
    buffer_store_dwordx4 v[28:31], v19, s[8:11], s28 offen sc1
    v_add_u32 v6, 16, v5
    v_mul_u32_u24 v7, 3277, v6
    v_lshrrev_b32 v7, 16, v7
    v_mul_u32_u24 v16, 20, v7
    v_sub_u32 v6, v6, v16
    v_mul_u32_u24 v7, 81920, v7
    v_lshlrev_b32 v16, 4, v6
    v_add_u32 v17, 768, v16
    v_cmp_gt_u32 vcc, 16, v6
    s_nop 1
    v_cndmask_b32 v16, v17, v16, vcc
    v_cndmask_b32 v17, v21, v20, vcc
    v_add_u32 v7, v7, v16
    v_mad_u32_u24 v18, v17, v4, v7
    v_lshl_add_u32 v19, v17, 1, v18

    v_cvt_pk_bf16_f32 v32, v112, v113
    v_cvt_pk_bf16_f32 v33, v114, v115
    v_cvt_pk_bf16_f32 v34, v120, v121
    v_cvt_pk_bf16_f32 v35, v122, v123
    buffer_store_dwordx4 v[32:35], v18, s[8:11], s28 offen sc1
    v_cvt_pk_bf16_f32 v36, v116, v117
    v_cvt_pk_bf16_f32 v37, v118, v119
    v_cvt_pk_bf16_f32 v38, v124, v125
    v_cvt_pk_bf16_f32 v39, v126, v127
    buffer_store_dwordx4 v[36:39], v19, s[8:11], s28 offen sc1
    v_add_u32 v6, 32, v5
    v_mul_u32_u24 v7, 3277, v6
    v_lshrrev_b32 v7, 16, v7
    v_mul_u32_u24 v16, 20, v7
    v_sub_u32 v6, v6, v16
    v_mul_u32_u24 v7, 81920, v7
    v_lshlrev_b32 v16, 4, v6
    v_add_u32 v17, 768, v16
    v_cmp_gt_u32 vcc, 16, v6
    s_nop 1
    v_cndmask_b32 v16, v17, v16, vcc
    v_cndmask_b32 v17, v21, v20, vcc
    v_add_u32 v7, v7, v16
    v_mad_u32_u24 v18, v17, v4, v7
    v_lshl_add_u32 v19, v17, 1, v18

    v_cvt_pk_bf16_f32 v24, v128, v129
    v_cvt_pk_bf16_f32 v25, v130, v131
    v_cvt_pk_bf16_f32 v26, v136, v137
    v_cvt_pk_bf16_f32 v27, v138, v139
    buffer_store_dwordx4 v[24:27], v18, s[8:11], s28 offen sc1
    v_cvt_pk_bf16_f32 v28, v132, v133
    v_cvt_pk_bf16_f32 v29, v134, v135
    v_cvt_pk_bf16_f32 v30, v140, v141
    v_cvt_pk_bf16_f32 v31, v142, v143
    buffer_store_dwordx4 v[28:31], v19, s[8:11], s28 offen sc1
    v_add_u32 v6, 48, v5
    v_mul_u32_u24 v7, 3277, v6
    v_lshrrev_b32 v7, 16, v7
    v_mul_u32_u24 v16, 20, v7
    v_sub_u32 v6, v6, v16
    v_mul_u32_u24 v7, 81920, v7
    v_lshlrev_b32 v16, 4, v6
    v_add_u32 v17, 768, v16
    v_cmp_gt_u32 vcc, 16, v6
    s_nop 1
    v_cndmask_b32 v16, v17, v16, vcc
    v_cndmask_b32 v17, v21, v20, vcc
    v_add_u32 v7, v7, v16
    v_mad_u32_u24 v18, v17, v4, v7
    v_lshl_add_u32 v19, v17, 1, v18

    v_cvt_pk_bf16_f32 v32, v144, v145
    v_cvt_pk_bf16_f32 v33, v146, v147
    v_cvt_pk_bf16_f32 v34, v152, v153
    v_cvt_pk_bf16_f32 v35, v154, v155
    buffer_store_dwordx4 v[32:35], v18, s[8:11], s28 offen sc1
    v_cvt_pk_bf16_f32 v36, v148, v149
    v_cvt_pk_bf16_f32 v37, v150, v151
    v_cvt_pk_bf16_f32 v38, v156, v157
    v_cvt_pk_bf16_f32 v39, v158, v159
    buffer_store_dwordx4 v[36:39], v19, s[8:11], s28 offen sc1
    v_add_u32 v6, 64, v5
    v_mul_u32_u24 v7, 3277, v6
    v_lshrrev_b32 v7, 16, v7
    v_mul_u32_u24 v16, 20, v7
    v_sub_u32 v6, v6, v16
    v_mul_u32_u24 v7, 81920, v7
    v_lshlrev_b32 v16, 4, v6
    v_add_u32 v17, 768, v16
    v_cmp_gt_u32 vcc, 16, v6
    s_nop 1
    v_cndmask_b32 v16, v17, v16, vcc
    v_cndmask_b32 v17, v21, v20, vcc
    v_add_u32 v7, v7, v16
    v_mad_u32_u24 v18, v17, v4, v7
    v_lshl_add_u32 v19, v17, 1, v18

    v_cvt_pk_bf16_f32 v24, v160, v161
    v_cvt_pk_bf16_f32 v25, v162, v163
    v_cvt_pk_bf16_f32 v26, v168, v169
    v_cvt_pk_bf16_f32 v27, v170, v171
    buffer_store_dwordx4 v[24:27], v18, s[8:11], s28 offen sc1
    v_cvt_pk_bf16_f32 v28, v164, v165
    v_cvt_pk_bf16_f32 v29, v166, v167
    v_cvt_pk_bf16_f32 v30, v172, v173
    v_cvt_pk_bf16_f32 v31, v174, v175
    buffer_store_dwordx4 v[28:31], v19, s[8:11], s28 offen sc1
L_k1_end:
    s_waitcnt vmcnt(0)
L_k1_done:
    s_endpgm
.globl attn_kernel
.p2align 8
.type attn_kernel,@function
attn_kernel:

    s_cmp_ge_u32 s2, 512
    s_cbranch_scc1 L_k2_done

    s_load_dwordx2 s[6:7], s[0:1], 72
    s_load_dwordx2 s[50:51], s[0:1], 16
    s_load_dwordx2 s[52:53], s[0:1], 48
    s_and_b32 s12, s2, 7
    s_lshl_b32 s12, s12, 2
    s_lshr_b32 s13, s2, 7
    s_add_u32 s12, s12, s13
    s_lshr_b32 s13, s2, 3
    s_and_b32 s13, s13, 15
    s_lshl_b32 s13, s13, 7
    v_lshrrev_b32 v1, 6, v0
    v_and_b32 v2, 63, v0
    s_nop 0
    v_readfirstlane_b32 s14, v1
    v_lshlrev_b32 v3, 4, v2
    s_lshr_b32 s15, s13, 4
    s_mul_i32 s16, s14, 6
    s_add_u32 s15, s15, s16
    s_sub_u32 s15, s15, 16
    s_mul_i32 s15, s15, 768
    s_mul_i32 s16, s12, 98304
    s_add_u32 s15, s15, s16
    s_add_u32 s15, s15, 8388608
    s_mul_i32 s17, s14, 6144
    s_lshr_b32 s20, s13, 5
    s_sub_u32 s20, s20, 8
    s_mul_i32 s20, s20, 1280
    s_mul_i32 s21, s12, 81920
    s_add_u32 s20, s20, s21
    s_lshl_b32 s21, s14, 12
    s_add_u32 s20, s20, s21
    s_add_u32 s20, s20, 11534336
    s_add_u32 s21, s21, 24576
    v_mov_b32 v48, 0
    v_mov_b32 v49, 0
    v_mov_b32 v50, 0
    v_mov_b32 v51, 0
    v_mov_b32 v52, 0
    v_mov_b32 v53, 0
    v_mov_b32 v54, 0
    v_mov_b32 v55, 0
    s_waitcnt lgkmcnt(0)
    s_add_u32 s18, s6, s15
    s_addc_u32 s19, s7, 0
    s_add_u32 s22, s6, s20
    s_addc_u32 s23, s7, 0
    s_mov_b32 m0, s21
    s_nop 0

    s_mov_b32 exec_hi, 0xffff
    s_add_u32 m0, s17, 0
    s_nop 0
    global_load_lds_dwordx4 v3, s[18:19]
    s_add_u32 s18, s18, 768
    s_addc_u32 s19, s19, 0
    s_add_u32 m0, s17, 1024
    s_nop 0
    global_load_lds_dwordx4 v3, s[18:19]
    s_add_u32 s18, s18, 768
    s_addc_u32 s19, s19, 0
    s_add_u32 m0, s17, 2048
    s_nop 0
    global_load_lds_dwordx4 v3, s[18:19]
    s_add_u32 s18, s18, 768
    s_addc_u32 s19, s19, 0
    s_add_u32 m0, s17, 3072
    s_nop 0
    global_load_lds_dwordx4 v3, s[18:19]
    s_add_u32 s18, s18, 768
    s_addc_u32 s19, s19, 0
    s_add_u32 m0, s17, 4096
    s_nop 0
    global_load_lds_dwordx4 v3, s[18:19]
    s_add_u32 s18, s18, 768
    s_addc_u32 s19, s19, 0
    s_add_u32 m0, s17, 5120
    s_nop 0
    global_load_lds_dwordx4 v3, s[18:19]
    s_add_u32 s18, s18, 768
    s_addc_u32 s19, s19, 0
    s_lshl_b32 s24, s14, 5
    s_add_u32 s25, s13, s24
    s_lshr_b32 s26, s25, 4
    s_mul_i32 s26, s26, 768
    s_mul_i32 s27, s12, 98304
    s_add_u32 s26, s26, s27
    s_add_u32 s26, s26, 4194304
    s_add_u32 s18, s6, s26
    s_addc_u32 s19, s7, 0

    global_load_dwordx4 v[48:51], v3, s[18:19]
    global_load_dwordx4 v[52:55], v3, s[18:19] offset:768
    s_mov_b64 exec, -1
    s_mov_b32 m0, s21
    s_nop 0
    global_load_lds_dwordx4 v3, s[22:23] offset:0
    global_load_lds_dwordx4 v3, s[22:23] offset:1024
    global_load_lds_dwordx4 v3, s[22:23] offset:2048
    global_load_lds_dwordx4 v3, s[22:23] offset:3072
    s_cmp_ge_u32 s2, 170
    s_cbranch_scc1 L_k2_norel1
    s_mul_i32 s54, s2, 13108
    s_lshr_b32 s54, s54, 16
    s_mul_i32 s55, s54, 5
    s_sub_u32 s55, s2, s55
    v_lshrrev_b32 v20, 4, v2
    v_mul_u32_u24 v20, 1280, v20
    v_and_b32 v21, 15, v2
    v_lshl_add_u32 v20, v21, 4, v20
    s_cmp_ge_u32 s54, 10
    s_cselect_b32 s56, s52, s50
    s_cselect_b32 s57, s53, s51
    s_cselect_b32 s58, 10, 0
    s_sub_u32 s58, s54, s58
    s_lshl_b32 s58, s58, 6
    s_lshl_b32 s59, s14, 4
    s_add_u32 s58, s58, s59
    s_mul_i32 s58, s58, 1280
    s_lshl_b32 s59, s55, 8
    s_add_u32 s58, s58, s59
    s_add_u32 s56, s56, s58
    s_addc_u32 s57, s57, 0
    s_lshl_b32 s60, s14, 12
    s_add_u32 s60, s60, 40960

    s_add_u32 m0, s60, 0
    s_nop 0
    global_load_lds_dwordx4 v20, s[56:57]
    s_add_u32 s56, s56, 5120
    s_addc_u32 s57, s57, 0
    s_add_u32 m0, s60, 1024
    s_nop 0
    global_load_lds_dwordx4 v20, s[56:57]
    s_add_u32 s56, s56, 5120
    s_addc_u32 s57, s57, 0
    s_add_u32 m0, s60, 2048
    s_nop 0
    global_load_lds_dwordx4 v20, s[56:57]
    s_add_u32 s56, s56, 5120
    s_addc_u32 s57, s57, 0
    s_add_u32 m0, s60, 3072
    s_nop 0
    global_load_lds_dwordx4 v20, s[56:57]
    s_add_u32 s56, s56, 5120
    s_addc_u32 s57, s57, 0
L_k2_norel1:
    v_and_b32 v5, 15, v2
    v_lshrrev_b32 v6, 4, v2
    v_lshlrev_b32 v7, 10, v6
    v_lshl_add_u32 v7, v5, 4, v7
    v_add_u32 v7, s17, v7
    v_mov_b32 v12, 0
    v_mov_b32 v13, 0
    v_mov_b32 v14, 0
    v_mov_b32 v15, 0
    ds_write_b128 v7, v[12:15] offset:768
    s_mov_b32 exec_hi, 0
    ds_write_b128 v7, v[12:15] offset:4864
    s_mov_b64 exec, -1
    s_lshl_b32 s26, s14, 11
    v_add_u32 v8, s26, v3
    s_mul_i32 s26, s14, 1280
    s_add_u32 s26, s26, 24576
    v_add_u32 v9, s26, v3
    v_and_b32 v10, 3, v5
    v_lshlrev_b32 v10, 4, v10
    v_lshl_add_u32 v10, v6, 6, v10
    v_add_u32 v10, s26, v10
    s_sub_u32 s25, s25, 256
    v_lshlrev_b32 v11, 2, v6
    v_sub_u32 v11, v5, v11
    v_cmp_le_i32 s[32:33], 0, v11
    v_cmp_le_i32 s[34:35], 1, v11
    v_cmp_le_i32 s[36:37], 2, v11
    v_cmp_le_i32 s[38:39], 3, v11
    v_mov_b32 v11, 0xff800000
    s_mov_b32 s40, 0x3ea52b5c
    s_waitcnt lgkmcnt(0)

    s_cmp_ge_u32 s2, 170
    s_cbranch_scc1 L_k2_w0
    s_waitcnt vmcnt(8)
    s_branch L_k2_w1

L_k2_w0:
    s_waitcnt vmcnt(4)
L_k2_w1:
    s_barrier
    ds_read_b128 v[32:35], v8 offset:0
    ds_read_b128 v[36:39], v8 offset:1024
    ds_read_b128 v[40:43], v8 offset:2048
    ds_read_b128 v[44:47], v8 offset:3072
    s_waitcnt lgkmcnt(3)
    v_mfma_f32_16x16x32_bf16 v[64:67], v[32:35], v[48:51], 0
    ds_read_b128 v[32:35], v8 offset:4096
    s_waitcnt lgkmcnt(3)
    v_mfma_f32_16x16x32_bf16 v[68:71], v[36:39], v[48:51], 0
    v_mfma_f32_16x16x32_bf16 v[140:143], v[36:39], v[52:55], 0
    ds_read_b128 v[36:39], v8 offset:5120
    s_waitcnt lgkmcnt(3)
    v_mfma_f32_16x16x32_bf16 v[72:75], v[40:43], v[48:51], 0
    v_mfma_f32_16x16x32_bf16 v[144:147], v[40:43], v[52:55], 0
    ds_read_b128 v[40:43], v8 offset:6144
    s_waitcnt lgkmcnt(3)
    v_mfma_f32_16x16x32_bf16 v[76:79], v[44:47], v[48:51], 0
    v_mfma_f32_16x16x32_bf16 v[148:151], v[44:47], v[52:55], 0
    ds_read_b128 v[44:47], v8 offset:7168
    s_waitcnt lgkmcnt(3)
    v_mfma_f32_16x16x32_bf16 v[80:83], v[32:35], v[48:51], 0
    v_mfma_f32_16x16x32_bf16 v[152:155], v[32:35], v[52:55], 0
    ds_read_b128 v[32:35], v8 offset:8192
    s_waitcnt lgkmcnt(3)
    v_mfma_f32_16x16x32_bf16 v[84:87], v[36:39], v[48:51], 0
    v_mfma_f32_16x16x32_bf16 v[156:159], v[36:39], v[52:55], 0
    ds_read_b128 v[36:39], v8 offset:9216
    s_waitcnt lgkmcnt(3)
    v_mfma_f32_16x16x32_bf16 v[88:91], v[40:43], v[48:51], 0
    v_mfma_f32_16x16x32_bf16 v[160:163], v[40:43], v[52:55], 0
    ds_read_b128 v[40:43], v8 offset:10240
    s_waitcnt lgkmcnt(3)
    v_mfma_f32_16x16x32_bf16 v[92:95], v[44:47], v[48:51], 0
    v_mfma_f32_16x16x32_bf16 v[164:167], v[44:47], v[52:55], 0
    ds_read_b128 v[44:47], v8 offset:11264
    s_waitcnt lgkmcnt(3)
    v_mfma_f32_16x16x32_bf16 v[96:99], v[32:35], v[48:51], 0
    v_mfma_f32_16x16x32_bf16 v[168:171], v[32:35], v[52:55], 0
    ds_read_b128 v[32:35], v8 offset:12288
    s_waitcnt lgkmcnt(3)
    v_mfma_f32_16x16x32_bf16 v[100:103], v[36:39], v[48:51], 0
    v_mfma_f32_16x16x32_bf16 v[172:175], v[36:39], v[52:55], 0
    ds_read_b128 v[36:39], v8 offset:13312
    s_waitcnt lgkmcnt(3)
    v_mfma_f32_16x16x32_bf16 v[104:107], v[40:43], v[48:51], 0
    v_mfma_f32_16x16x32_bf16 v[176:179], v[40:43], v[52:55], 0
    ds_read_b128 v[40:43], v8 offset:14336
    s_waitcnt lgkmcnt(3)
    v_mfma_f32_16x16x32_bf16 v[108:111], v[44:47], v[48:51], 0
    v_mfma_f32_16x16x32_bf16 v[180:183], v[44:47], v[52:55], 0
    ds_read_b128 v[44:47], v8 offset:15360
    s_waitcnt lgkmcnt(3)
    v_mfma_f32_16x16x32_bf16 v[112:115], v[32:35], v[48:51], 0
    v_mfma_f32_16x16x32_bf16 v[184:187], v[32:35], v[52:55], 0
    ds_read_b128 v[32:35], v8 offset:16384
    s_waitcnt lgkmcnt(3)
    v_mfma_f32_16x16x32_bf16 v[116:119], v[36:39], v[48:51], 0
    v_mfma_f32_16x16x32_bf16 v[188:191], v[36:39], v[52:55], 0
    ds_read_b128 v[36:39], v8 offset:17408
    s_waitcnt lgkmcnt(3)
    v_mfma_f32_16x16x32_bf16 v[120:123], v[40:43], v[48:51], 0
    v_mfma_f32_16x16x32_bf16 v[192:195], v[40:43], v[52:55], 0
    s_waitcnt lgkmcnt(2)
    v_mfma_f32_16x16x32_bf16 v[124:127], v[44:47], v[48:51], 0
    v_mfma_f32_16x16x32_bf16 v[196:199], v[44:47], v[52:55], 0
    s_waitcnt lgkmcnt(1)
    v_mfma_f32_16x16x32_bf16 v[128:131], v[32:35], v[48:51], 0
    v_mfma_f32_16x16x32_bf16 v[200:203], v[32:35], v[52:55], 0
    s_waitcnt lgkmcnt(0)
    v_mfma_f32_16x16x32_bf16 v[204:207], v[36:39], v[52:55], 0
    s_nop 7
    s_nop 7
    s_cmp_ge_i32 s25, 0
    s_cbranch_scc1 L_k2_v_c310_1
    v_mov_b32 v64, v11
    v_mov_b32 v65, v11
    v_mov_b32 v66, v11
    v_mov_b32 v67, v11
    v_mov_b32 v68, v11
    v_mov_b32 v69, v11
    v_mov_b32 v70, v11
    v_mov_b32 v71, v11
    v_mov_b32 v140, v11
    v_mov_b32 v141, v11
    v_mov_b32 v142, v11
    v_mov_b32 v143, v11
L_k2_v_c310_1:
    s_cmp_ge_i32 s25, -32
    s_cbranch_scc1 L_k2_v_c310_2
    v_mov_b32 v72, v11
    v_mov_b32 v73, v11
    v_mov_b32 v74, v11
    v_mov_b32 v75, v11
    v_mov_b32 v76, v11
    v_mov_b32 v77, v11
    v_mov_b32 v78, v11
    v_mov_b32 v79, v11
    v_mov_b32 v144, v11
    v_mov_b32 v145, v11
    v_mov_b32 v146, v11
    v_mov_b32 v147, v11
    v_mov_b32 v148, v11
    v_mov_b32 v149, v11
    v_mov_b32 v150, v11
    v_mov_b32 v151, v11
L_k2_v_c310_2:
    s_cmp_ge_i32 s25, -64
    s_cbranch_scc1 L_k2_v_c310_3
    v_mov_b32 v80, v11
    v_mov_b32 v81, v11
    v_mov_b32 v82, v11
    v_mov_b32 v83, v11
    v_mov_b32 v84, v11
    v_mov_b32 v85, v11
    v_mov_b32 v86, v11
    v_mov_b32 v87, v11
    v_mov_b32 v152, v11
    v_mov_b32 v153, v11
    v_mov_b32 v154, v11
    v_mov_b32 v155, v11
    v_mov_b32 v156, v11
    v_mov_b32 v157, v11
    v_mov_b32 v158, v11
    v_mov_b32 v159, v11
L_k2_v_c310_3:
    s_cmp_ge_i32 s25, -96
    s_cbranch_scc1 L_k2_v_c310_4
    v_mov_b32 v88, v11
    v_mov_b32 v89, v11
    v_mov_b32 v90, v11
    v_mov_b32 v91, v11
    v_mov_b32 v92, v11
    v_mov_b32 v93, v11
    v_mov_b32 v94, v11
    v_mov_b32 v95, v11
    v_mov_b32 v160, v11
    v_mov_b32 v161, v11
    v_mov_b32 v162, v11
    v_mov_b32 v163, v11
    v_mov_b32 v164, v11
    v_mov_b32 v165, v11
    v_mov_b32 v166, v11
    v_mov_b32 v167, v11
L_k2_v_c310_4:
    s_cmp_ge_i32 s25, -128
    s_cbranch_scc1 L_k2_v_c310_5
    v_mov_b32 v96, v11
    v_mov_b32 v97, v11
    v_mov_b32 v98, v11
    v_mov_b32 v99, v11
    v_mov_b32 v100, v11
    v_mov_b32 v101, v11
    v_mov_b32 v102, v11
    v_mov_b32 v103, v11
    v_mov_b32 v168, v11
    v_mov_b32 v169, v11
    v_mov_b32 v170, v11
    v_mov_b32 v171, v11
    v_mov_b32 v172, v11
    v_mov_b32 v173, v11
    v_mov_b32 v174, v11
    v_mov_b32 v175, v11
L_k2_v_c310_5:
    s_cmp_ge_i32 s25, -160
    s_cbranch_scc1 L_k2_v_c310_6
    v_mov_b32 v104, v11
    v_mov_b32 v105, v11
    v_mov_b32 v106, v11
    v_mov_b32 v107, v11
    v_mov_b32 v108, v11
    v_mov_b32 v109, v11
    v_mov_b32 v110, v11
    v_mov_b32 v111, v11
    v_mov_b32 v176, v11
    v_mov_b32 v177, v11
    v_mov_b32 v178, v11
    v_mov_b32 v179, v11
    v_mov_b32 v180, v11
    v_mov_b32 v181, v11
    v_mov_b32 v182, v11
    v_mov_b32 v183, v11
L_k2_v_c310_6:
    s_cmp_ge_i32 s25, -192
    s_cbranch_scc1 L_k2_v_c310_7
    v_mov_b32 v112, v11
    v_mov_b32 v113, v11
    v_mov_b32 v114, v11
    v_mov_b32 v115, v11
    v_mov_b32 v116, v11
    v_mov_b32 v117, v11
    v_mov_b32 v118, v11
    v_mov_b32 v119, v11
    v_mov_b32 v184, v11
    v_mov_b32 v185, v11
    v_mov_b32 v186, v11
    v_mov_b32 v187, v11
    v_mov_b32 v188, v11
    v_mov_b32 v189, v11
    v_mov_b32 v190, v11
    v_mov_b32 v191, v11
L_k2_v_c310_7:
    s_cmp_ge_i32 s25, -224
    s_cbranch_scc1 L_k2_v_c310_8
    v_mov_b32 v120, v11
    v_mov_b32 v121, v11
    v_mov_b32 v122, v11
    v_mov_b32 v123, v11
    v_mov_b32 v124, v11
    v_mov_b32 v125, v11
    v_mov_b32 v126, v11
    v_mov_b32 v127, v11
    v_mov_b32 v192, v11
    v_mov_b32 v193, v11
    v_mov_b32 v194, v11
    v_mov_b32 v195, v11
    v_mov_b32 v196, v11
    v_mov_b32 v197, v11
    v_mov_b32 v198, v11
    v_mov_b32 v199, v11
L_k2_v_c310_8:
    v_cndmask_b32 v64, v64, v11, s[32:33]
    v_cndmask_b32 v128, v11, v128, s[32:33]
    v_cndmask_b32 v65, v65, v11, s[34:35]
    v_cndmask_b32 v129, v11, v129, s[34:35]
    v_cndmask_b32 v66, v66, v11, s[36:37]
    v_cndmask_b32 v130, v11, v130, s[36:37]
    v_cndmask_b32 v67, v67, v11, s[38:39]
    v_cndmask_b32 v131, v11, v131, s[38:39]
    v_cndmask_b32 v140, v140, v11, s[32:33]
    v_cndmask_b32 v204, v11, v204, s[32:33]
    v_cndmask_b32 v141, v141, v11, s[34:35]
    v_cndmask_b32 v205, v11, v205, s[34:35]
    v_cndmask_b32 v142, v142, v11, s[36:37]
    v_cndmask_b32 v206, v11, v206, s[36:37]
    v_cndmask_b32 v143, v143, v11, s[38:39]
    v_cndmask_b32 v207, v11, v207, s[38:39]
    v_max3_f32 v12, v64, v65, v66
    v_max3_f32 v12, v12, v67, v68
    v_max3_f32 v12, v12, v69, v70
    v_max3_f32 v12, v12, v71, v72
    v_max3_f32 v12, v12, v73, v74
    v_max3_f32 v12, v12, v75, v76
    v_max3_f32 v12, v12, v77, v78
    v_max3_f32 v12, v12, v79, v80
    v_max3_f32 v12, v12, v81, v82
    v_max3_f32 v12, v12, v83, v84
    v_max3_f32 v12, v12, v85, v86
    v_max3_f32 v12, v12, v87, v88
    v_max3_f32 v12, v12, v89, v90
    v_max3_f32 v12, v12, v91, v92
    v_max3_f32 v12, v12, v93, v94
    v_max3_f32 v12, v12, v95, v96
    v_max3_f32 v12, v12, v97, v98
    v_max3_f32 v12, v12, v99, v100
    v_max3_f32 v12, v12, v101, v102
    v_max3_f32 v12, v12, v103, v104
    v_max3_f32 v12, v12, v105, v106
    v_max3_f32 v12, v12, v107, v108
    v_max3_f32 v12, v12, v109, v110
    v_max3_f32 v12, v12, v111, v112
    v_max3_f32 v12, v12, v113, v114
    v_max3_f32 v12, v12, v115, v116
    v_max3_f32 v12, v12, v117, v118
    v_max3_f32 v12, v12, v119, v120
    v_max3_f32 v12, v12, v121, v122
    v_max3_f32 v12, v12, v123, v124
    v_max3_f32 v12, v12, v125, v126
    v_max3_f32 v12, v12, v127, v128
    v_max3_f32 v12, v12, v129, v130
    v_max_f32 v12, v12, v131
    v_max3_f32 v13, v140, v141, v142
    v_max3_f32 v13, v13, v143, v144
    v_max3_f32 v13, v13, v145, v146
    v_max3_f32 v13, v13, v147, v148
    v_max3_f32 v13, v13, v149, v150
    v_max3_f32 v13, v13, v151, v152
    v_max3_f32 v13, v13, v153, v154
    v_max3_f32 v13, v13, v155, v156
    v_max3_f32 v13, v13, v157, v158
    v_max3_f32 v13, v13, v159, v160
    v_max3_f32 v13, v13, v161, v162
    v_max3_f32 v13, v13, v163, v164
    v_max3_f32 v13, v13, v165, v166
    v_max3_f32 v13, v13, v167, v168
    v_max3_f32 v13, v13, v169, v170
    v_max3_f32 v13, v13, v171, v172
    v_max3_f32 v13, v13, v173, v174
    v_max3_f32 v13, v13, v175, v176
    v_max3_f32 v13, v13, v177, v178
    v_max3_f32 v13, v13, v179, v180
    v_max3_f32 v13, v13, v181, v182
    v_max3_f32 v13, v13, v183, v184
    v_max3_f32 v13, v13, v185, v186
    v_max3_f32 v13, v13, v187, v188
    v_max3_f32 v13, v13, v189, v190
    v_max3_f32 v13, v13, v191, v192
    v_max3_f32 v13, v13, v193, v194
    v_max3_f32 v13, v13, v195, v196
    v_max3_f32 v13, v13, v197, v198
    v_max3_f32 v13, v13, v199, v200
    v_max3_f32 v13, v13, v201, v202
    v_max3_f32 v13, v13, v203, v204
    v_max3_f32 v13, v13, v205, v206
    v_max_f32 v13, v13, v207
    v_mov_b32 v16, v12
    s_nop 1
    v_permlane32_swap_b32 v16, v12
    s_nop 1
    v_max_f32 v12, v12, v16
    v_mov_b32 v16, v12
    s_nop 1
    v_permlane16_swap_b32 v16, v12
    s_nop 1
    v_max_f32 v12, v12, v16

    v_mul_f32 v12, s40, v12
    v_mov_b32 v16, v13
    s_nop 1
    v_permlane32_swap_b32 v16, v13
    s_nop 1
    v_max_f32 v13, v13, v16
    v_mov_b32 v16, v13
    s_nop 1
    v_permlane16_swap_b32 v16, v13
    s_nop 1
    v_max_f32 v13, v13, v16

    v_mul_f32 v13, s40, v13
    v_mov_b32 v24, s40
    v_mov_b32 v25, s40
    v_mov_b32 v26, v12
    v_mov_b32 v27, v12
    v_mov_b32 v30, 0
    v_mov_b32 v31, 0
    v_mov_b32 v28, v13
    v_mov_b32 v29, v13
    v_mov_b32 v32, 0
    v_mov_b32 v33, 0
    v_pk_fma_f32 v[64:65], v[64:65], v[24:25], v[26:27] neg_lo:[0,0,1] neg_hi:[0,0,1]
    v_pk_fma_f32 v[66:67], v[66:67], v[24:25], v[26:27] neg_lo:[0,0,1] neg_hi:[0,0,1]
    v_exp_f32 v64, v64
    v_exp_f32 v65, v65
    v_exp_f32 v66, v66
    v_exp_f32 v67, v67
    s_nop 0
    v_pk_add_f32 v[18:19], v[64:65], v[66:67]
    v_pk_add_f32 v[30:31], v[30:31], v[18:19]
    v_pk_fma_f32 v[68:69], v[68:69], v[24:25], v[26:27] neg_lo:[0,0,1] neg_hi:[0,0,1]
    v_pk_fma_f32 v[70:71], v[70:71], v[24:25], v[26:27] neg_lo:[0,0,1] neg_hi:[0,0,1]
    v_exp_f32 v68, v68
    v_exp_f32 v69, v69
    v_exp_f32 v70, v70
    v_exp_f32 v71, v71
    s_nop 0
    v_pk_add_f32 v[18:19], v[68:69], v[70:71]
    v_pk_add_f32 v[30:31], v[30:31], v[18:19]
    v_pk_fma_f32 v[72:73], v[72:73], v[24:25], v[26:27] neg_lo:[0,0,1] neg_hi:[0,0,1]
    v_pk_fma_f32 v[74:75], v[74:75], v[24:25], v[26:27] neg_lo:[0,0,1] neg_hi:[0,0,1]
    v_exp_f32 v72, v72
    v_exp_f32 v73, v73
    v_exp_f32 v74, v74
    v_exp_f32 v75, v75
    s_nop 0
    v_pk_add_f32 v[18:19], v[72:73], v[74:75]
    v_pk_add_f32 v[30:31], v[30:31], v[18:19]
    v_pk_fma_f32 v[76:77], v[76:77], v[24:25], v[26:27] neg_lo:[0,0,1] neg_hi:[0,0,1]
    v_pk_fma_f32 v[78:79], v[78:79], v[24:25], v[26:27] neg_lo:[0,0,1] neg_hi:[0,0,1]
    v_exp_f32 v76, v76
    v_exp_f32 v77, v77
    v_exp_f32 v78, v78
    v_exp_f32 v79, v79
    s_nop 0
    v_pk_add_f32 v[18:19], v[76:77], v[78:79]
    v_pk_add_f32 v[30:31], v[30:31], v[18:19]
    v_pk_fma_f32 v[80:81], v[80:81], v[24:25], v[26:27] neg_lo:[0,0,1] neg_hi:[0,0,1]
    v_pk_fma_f32 v[82:83], v[82:83], v[24:25], v[26:27] neg_lo:[0,0,1] neg_hi:[0,0,1]
    v_exp_f32 v80, v80
    v_exp_f32 v81, v81
    v_exp_f32 v82, v82
    v_exp_f32 v83, v83
    s_nop 0
    v_pk_add_f32 v[18:19], v[80:81], v[82:83]
    v_pk_add_f32 v[30:31], v[30:31], v[18:19]
    v_pk_fma_f32 v[84:85], v[84:85], v[24:25], v[26:27] neg_lo:[0,0,1] neg_hi:[0,0,1]
    v_pk_fma_f32 v[86:87], v[86:87], v[24:25], v[26:27] neg_lo:[0,0,1] neg_hi:[0,0,1]
    v_exp_f32 v84, v84
    v_exp_f32 v85, v85
    v_exp_f32 v86, v86
    v_exp_f32 v87, v87
    s_nop 0
    v_pk_add_f32 v[18:19], v[84:85], v[86:87]
    v_pk_add_f32 v[30:31], v[30:31], v[18:19]
    v_pk_fma_f32 v[88:89], v[88:89], v[24:25], v[26:27] neg_lo:[0,0,1] neg_hi:[0,0,1]
    v_pk_fma_f32 v[90:91], v[90:91], v[24:25], v[26:27] neg_lo:[0,0,1] neg_hi:[0,0,1]
    v_exp_f32 v88, v88
    v_exp_f32 v89, v89
    v_exp_f32 v90, v90
    v_exp_f32 v91, v91
    s_nop 0
    v_pk_add_f32 v[18:19], v[88:89], v[90:91]
    v_pk_add_f32 v[30:31], v[30:31], v[18:19]
    v_pk_fma_f32 v[92:93], v[92:93], v[24:25], v[26:27] neg_lo:[0,0,1] neg_hi:[0,0,1]
    v_pk_fma_f32 v[94:95], v[94:95], v[24:25], v[26:27] neg_lo:[0,0,1] neg_hi:[0,0,1]
    v_exp_f32 v92, v92
    v_exp_f32 v93, v93
    v_exp_f32 v94, v94
    v_exp_f32 v95, v95
    s_nop 0
    v_pk_add_f32 v[18:19], v[92:93], v[94:95]
    v_pk_add_f32 v[30:31], v[30:31], v[18:19]
    v_pk_fma_f32 v[96:97], v[96:97], v[24:25], v[26:27] neg_lo:[0,0,1] neg_hi:[0,0,1]
    v_pk_fma_f32 v[98:99], v[98:99], v[24:25], v[26:27] neg_lo:[0,0,1] neg_hi:[0,0,1]
    v_exp_f32 v96, v96
    v_exp_f32 v97, v97
    v_exp_f32 v98, v98
    v_exp_f32 v99, v99
    s_nop 0
    v_pk_add_f32 v[18:19], v[96:97], v[98:99]
    v_pk_add_f32 v[30:31], v[30:31], v[18:19]
    v_pk_fma_f32 v[100:101], v[100:101], v[24:25], v[26:27] neg_lo:[0,0,1] neg_hi:[0,0,1]
    v_pk_fma_f32 v[102:103], v[102:103], v[24:25], v[26:27] neg_lo:[0,0,1] neg_hi:[0,0,1]
    v_exp_f32 v100, v100
    v_exp_f32 v101, v101
    v_exp_f32 v102, v102
    v_exp_f32 v103, v103
    s_nop 0
    v_pk_add_f32 v[18:19], v[100:101], v[102:103]
    v_pk_add_f32 v[30:31], v[30:31], v[18:19]
    v_pk_fma_f32 v[104:105], v[104:105], v[24:25], v[26:27] neg_lo:[0,0,1] neg_hi:[0,0,1]
    v_pk_fma_f32 v[106:107], v[106:107], v[24:25], v[26:27] neg_lo:[0,0,1] neg_hi:[0,0,1]
    v_exp_f32 v104, v104
    v_exp_f32 v105, v105
    v_exp_f32 v106, v106
    v_exp_f32 v107, v107
    s_nop 0
    v_pk_add_f32 v[18:19], v[104:105], v[106:107]
    v_pk_add_f32 v[30:31], v[30:31], v[18:19]
    v_pk_fma_f32 v[108:109], v[108:109], v[24:25], v[26:27] neg_lo:[0,0,1] neg_hi:[0,0,1]
    v_pk_fma_f32 v[110:111], v[110:111], v[24:25], v[26:27] neg_lo:[0,0,1] neg_hi:[0,0,1]
    v_exp_f32 v108, v108
    v_exp_f32 v109, v109
    v_exp_f32 v110, v110
    v_exp_f32 v111, v111
    s_nop 0
    v_pk_add_f32 v[18:19], v[108:109], v[110:111]
    v_pk_add_f32 v[30:31], v[30:31], v[18:19]
    v_pk_fma_f32 v[112:113], v[112:113], v[24:25], v[26:27] neg_lo:[0,0,1] neg_hi:[0,0,1]
    v_pk_fma_f32 v[114:115], v[114:115], v[24:25], v[26:27] neg_lo:[0,0,1] neg_hi:[0,0,1]
    v_exp_f32 v112, v112
    v_exp_f32 v113, v113
    v_exp_f32 v114, v114
    v_exp_f32 v115, v115
    s_nop 0
    v_pk_add_f32 v[18:19], v[112:113], v[114:115]
    v_pk_add_f32 v[30:31], v[30:31], v[18:19]
    v_pk_fma_f32 v[116:117], v[116:117], v[24:25], v[26:27] neg_lo:[0,0,1] neg_hi:[0,0,1]
    v_pk_fma_f32 v[118:119], v[118:119], v[24:25], v[26:27] neg_lo:[0,0,1] neg_hi:[0,0,1]
    v_exp_f32 v116, v116
    v_exp_f32 v117, v117
    v_exp_f32 v118, v118
    v_exp_f32 v119, v119
    s_nop 0
    v_pk_add_f32 v[18:19], v[116:117], v[118:119]
    v_pk_add_f32 v[30:31], v[30:31], v[18:19]
    v_pk_fma_f32 v[120:121], v[120:121], v[24:25], v[26:27] neg_lo:[0,0,1] neg_hi:[0,0,1]
    v_pk_fma_f32 v[122:123], v[122:123], v[24:25], v[26:27] neg_lo:[0,0,1] neg_hi:[0,0,1]
    v_exp_f32 v120, v120
    v_exp_f32 v121, v121
    v_exp_f32 v122, v122
    v_exp_f32 v123, v123
    s_nop 0
    v_pk_add_f32 v[18:19], v[120:121], v[122:123]
    v_pk_add_f32 v[30:31], v[30:31], v[18:19]
    v_pk_fma_f32 v[124:125], v[124:125], v[24:25], v[26:27] neg_lo:[0,0,1] neg_hi:[0,0,1]
    v_pk_fma_f32 v[126:127], v[126:127], v[24:25], v[26:27] neg_lo:[0,0,1] neg_hi:[0,0,1]
    v_exp_f32 v124, v124
    v_exp_f32 v125, v125
    v_exp_f32 v126, v126
    v_exp_f32 v127, v127
    s_nop 0
    v_pk_add_f32 v[18:19], v[124:125], v[126:127]
    v_pk_add_f32 v[30:31], v[30:31], v[18:19]
    v_pk_fma_f32 v[128:129], v[128:129], v[24:25], v[26:27] neg_lo:[0,0,1] neg_hi:[0,0,1]
    v_pk_fma_f32 v[130:131], v[130:131], v[24:25], v[26:27] neg_lo:[0,0,1] neg_hi:[0,0,1]
    v_exp_f32 v128, v128
    v_exp_f32 v129, v129
    v_exp_f32 v130, v130
    v_exp_f32 v131, v131
    s_nop 0
    v_pk_add_f32 v[18:19], v[128:129], v[130:131]
    v_pk_add_f32 v[30:31], v[30:31], v[18:19]
    v_pk_fma_f32 v[140:141], v[140:141], v[24:25], v[28:29] neg_lo:[0,0,1] neg_hi:[0,0,1]
    v_pk_fma_f32 v[142:143], v[142:143], v[24:25], v[28:29] neg_lo:[0,0,1] neg_hi:[0,0,1]
    v_exp_f32 v140, v140
    v_exp_f32 v141, v141
    v_exp_f32 v142, v142
    v_exp_f32 v143, v143
    s_nop 0
    v_pk_add_f32 v[18:19], v[140:141], v[142:143]
    v_pk_add_f32 v[32:33], v[32:33], v[18:19]
    v_pk_fma_f32 v[144:145], v[144:145], v[24:25], v[28:29] neg_lo:[0,0,1] neg_hi:[0,0,1]
    v_pk_fma_f32 v[146:147], v[146:147], v[24:25], v[28:29] neg_lo:[0,0,1] neg_hi:[0,0,1]
    v_exp_f32 v144, v144
    v_exp_f32 v145, v145
    v_exp_f32 v146, v146
    v_exp_f32 v147, v147
    s_nop 0
    v_pk_add_f32 v[18:19], v[144:145], v[146:147]
    v_pk_add_f32 v[32:33], v[32:33], v[18:19]
    v_pk_fma_f32 v[148:149], v[148:149], v[24:25], v[28:29] neg_lo:[0,0,1] neg_hi:[0,0,1]
    v_pk_fma_f32 v[150:151], v[150:151], v[24:25], v[28:29] neg_lo:[0,0,1] neg_hi:[0,0,1]
    v_exp_f32 v148, v148
    v_exp_f32 v149, v149
    v_exp_f32 v150, v150
    v_exp_f32 v151, v151
    s_nop 0
    v_pk_add_f32 v[18:19], v[148:149], v[150:151]
    v_pk_add_f32 v[32:33], v[32:33], v[18:19]
    v_pk_fma_f32 v[152:153], v[152:153], v[24:25], v[28:29] neg_lo:[0,0,1] neg_hi:[0,0,1]
    v_pk_fma_f32 v[154:155], v[154:155], v[24:25], v[28:29] neg_lo:[0,0,1] neg_hi:[0,0,1]
    v_exp_f32 v152, v152
    v_exp_f32 v153, v153
    v_exp_f32 v154, v154
    v_exp_f32 v155, v155
    s_nop 0
    v_pk_add_f32 v[18:19], v[152:153], v[154:155]
    v_pk_add_f32 v[32:33], v[32:33], v[18:19]
    v_pk_fma_f32 v[156:157], v[156:157], v[24:25], v[28:29] neg_lo:[0,0,1] neg_hi:[0,0,1]
    v_pk_fma_f32 v[158:159], v[158:159], v[24:25], v[28:29] neg_lo:[0,0,1] neg_hi:[0,0,1]
    v_exp_f32 v156, v156
    v_exp_f32 v157, v157
    v_exp_f32 v158, v158
    v_exp_f32 v159, v159
    s_nop 0
    v_pk_add_f32 v[18:19], v[156:157], v[158:159]
    v_pk_add_f32 v[32:33], v[32:33], v[18:19]
    v_pk_fma_f32 v[160:161], v[160:161], v[24:25], v[28:29] neg_lo:[0,0,1] neg_hi:[0,0,1]
    v_pk_fma_f32 v[162:163], v[162:163], v[24:25], v[28:29] neg_lo:[0,0,1] neg_hi:[0,0,1]
    v_exp_f32 v160, v160
    v_exp_f32 v161, v161
    v_exp_f32 v162, v162
    v_exp_f32 v163, v163
    s_nop 0
    v_pk_add_f32 v[18:19], v[160:161], v[162:163]
    v_pk_add_f32 v[32:33], v[32:33], v[18:19]
    v_pk_fma_f32 v[164:165], v[164:165], v[24:25], v[28:29] neg_lo:[0,0,1] neg_hi:[0,0,1]
    v_pk_fma_f32 v[166:167], v[166:167], v[24:25], v[28:29] neg_lo:[0,0,1] neg_hi:[0,0,1]
    v_exp_f32 v164, v164
    v_exp_f32 v165, v165
    v_exp_f32 v166, v166
    v_exp_f32 v167, v167
    s_nop 0
    v_pk_add_f32 v[18:19], v[164:165], v[166:167]
    v_pk_add_f32 v[32:33], v[32:33], v[18:19]
    v_pk_fma_f32 v[168:169], v[168:169], v[24:25], v[28:29] neg_lo:[0,0,1] neg_hi:[0,0,1]
    v_pk_fma_f32 v[170:171], v[170:171], v[24:25], v[28:29] neg_lo:[0,0,1] neg_hi:[0,0,1]
    v_exp_f32 v168, v168
    v_exp_f32 v169, v169
    v_exp_f32 v170, v170
    v_exp_f32 v171, v171
    s_nop 0
    v_pk_add_f32 v[18:19], v[168:169], v[170:171]
    v_pk_add_f32 v[32:33], v[32:33], v[18:19]
    v_pk_fma_f32 v[172:173], v[172:173], v[24:25], v[28:29] neg_lo:[0,0,1] neg_hi:[0,0,1]
    v_pk_fma_f32 v[174:175], v[174:175], v[24:25], v[28:29] neg_lo:[0,0,1] neg_hi:[0,0,1]
    v_exp_f32 v172, v172
    v_exp_f32 v173, v173
    v_exp_f32 v174, v174
    v_exp_f32 v175, v175
    s_nop 0
    v_pk_add_f32 v[18:19], v[172:173], v[174:175]
    v_pk_add_f32 v[32:33], v[32:33], v[18:19]
    v_pk_fma_f32 v[176:177], v[176:177], v[24:25], v[28:29] neg_lo:[0,0,1] neg_hi:[0,0,1]
    v_pk_fma_f32 v[178:179], v[178:179], v[24:25], v[28:29] neg_lo:[0,0,1] neg_hi:[0,0,1]
    v_exp_f32 v176, v176
    v_exp_f32 v177, v177
    v_exp_f32 v178, v178
    v_exp_f32 v179, v179
    s_nop 0
    v_pk_add_f32 v[18:19], v[176:177], v[178:179]
    v_pk_add_f32 v[32:33], v[32:33], v[18:19]
    v_pk_fma_f32 v[180:181], v[180:181], v[24:25], v[28:29] neg_lo:[0,0,1] neg_hi:[0,0,1]
    v_pk_fma_f32 v[182:183], v[182:183], v[24:25], v[28:29] neg_lo:[0,0,1] neg_hi:[0,0,1]
    v_exp_f32 v180, v180
    v_exp_f32 v181, v181
    v_exp_f32 v182, v182
    v_exp_f32 v183, v183
    s_nop 0
    v_pk_add_f32 v[18:19], v[180:181], v[182:183]
    v_pk_add_f32 v[32:33], v[32:33], v[18:19]
    v_pk_fma_f32 v[184:185], v[184:185], v[24:25], v[28:29] neg_lo:[0,0,1] neg_hi:[0,0,1]
    v_pk_fma_f32 v[186:187], v[186:187], v[24:25], v[28:29] neg_lo:[0,0,1] neg_hi:[0,0,1]
    v_exp_f32 v184, v184
    v_exp_f32 v185, v185
    v_exp_f32 v186, v186
    v_exp_f32 v187, v187
    s_nop 0
    v_pk_add_f32 v[18:19], v[184:185], v[186:187]
    v_pk_add_f32 v[32:33], v[32:33], v[18:19]
    v_pk_fma_f32 v[188:189], v[188:189], v[24:25], v[28:29] neg_lo:[0,0,1] neg_hi:[0,0,1]
    v_pk_fma_f32 v[190:191], v[190:191], v[24:25], v[28:29] neg_lo:[0,0,1] neg_hi:[0,0,1]
    v_exp_f32 v188, v188
    v_exp_f32 v189, v189
    v_exp_f32 v190, v190
    v_exp_f32 v191, v191
    s_nop 0
    v_pk_add_f32 v[18:19], v[188:189], v[190:191]
    v_pk_add_f32 v[32:33], v[32:33], v[18:19]
    v_pk_fma_f32 v[192:193], v[192:193], v[24:25], v[28:29] neg_lo:[0,0,1] neg_hi:[0,0,1]
    v_pk_fma_f32 v[194:195], v[194:195], v[24:25], v[28:29] neg_lo:[0,0,1] neg_hi:[0,0,1]
    v_exp_f32 v192, v192
    v_exp_f32 v193, v193
    v_exp_f32 v194, v194
    v_exp_f32 v195, v195
    s_nop 0
    v_pk_add_f32 v[18:19], v[192:193], v[194:195]
    v_pk_add_f32 v[32:33], v[32:33], v[18:19]
    v_pk_fma_f32 v[196:197], v[196:197], v[24:25], v[28:29] neg_lo:[0,0,1] neg_hi:[0,0,1]
    v_pk_fma_f32 v[198:199], v[198:199], v[24:25], v[28:29] neg_lo:[0,0,1] neg_hi:[0,0,1]
    v_exp_f32 v196, v196
    v_exp_f32 v197, v197
    v_exp_f32 v198, v198
    v_exp_f32 v199, v199
    s_nop 0
    v_pk_add_f32 v[18:19], v[196:197], v[198:199]
    v_pk_add_f32 v[32:33], v[32:33], v[18:19]
    v_pk_fma_f32 v[200:201], v[200:201], v[24:25], v[28:29] neg_lo:[0,0,1] neg_hi:[0,0,1]
    v_pk_fma_f32 v[202:203], v[202:203], v[24:25], v[28:29] neg_lo:[0,0,1] neg_hi:[0,0,1]
    v_exp_f32 v200, v200
    v_exp_f32 v201, v201
    v_exp_f32 v202, v202
    v_exp_f32 v203, v203
    s_nop 0
    v_pk_add_f32 v[18:19], v[200:201], v[202:203]
    v_pk_add_f32 v[32:33], v[32:33], v[18:19]
    v_pk_fma_f32 v[204:205], v[204:205], v[24:25], v[28:29] neg_lo:[0,0,1] neg_hi:[0,0,1]
    v_pk_fma_f32 v[206:207], v[206:207], v[24:25], v[28:29] neg_lo:[0,0,1] neg_hi:[0,0,1]
    v_exp_f32 v204, v204
    v_exp_f32 v205, v205
    v_exp_f32 v206, v206
    v_exp_f32 v207, v207
    s_nop 0
    v_pk_add_f32 v[18:19], v[204:205], v[206:207]
    v_pk_add_f32 v[32:33], v[32:33], v[18:19]
    v_add_f32 v14, v30, v31
    v_add_f32 v15, v32, v33
    v_cvt_pk_bf16_f32 v64, v64, v65
    v_cvt_pk_bf16_f32 v65, v66, v67
    v_cvt_pk_bf16_f32 v66, v68, v69
    v_cvt_pk_bf16_f32 v67, v70, v71
    v_cvt_pk_bf16_f32 v72, v72, v73
    v_cvt_pk_bf16_f32 v73, v74, v75
    v_cvt_pk_bf16_f32 v74, v76, v77
    v_cvt_pk_bf16_f32 v75, v78, v79
    v_cvt_pk_bf16_f32 v80, v80, v81
    v_cvt_pk_bf16_f32 v81, v82, v83
    v_cvt_pk_bf16_f32 v82, v84, v85
    v_cvt_pk_bf16_f32 v83, v86, v87
    v_cvt_pk_bf16_f32 v88, v88, v89
    v_cvt_pk_bf16_f32 v89, v90, v91
    v_cvt_pk_bf16_f32 v90, v92, v93
    v_cvt_pk_bf16_f32 v91, v94, v95
    v_cvt_pk_bf16_f32 v96, v96, v97
    v_cvt_pk_bf16_f32 v97, v98, v99
    v_cvt_pk_bf16_f32 v98, v100, v101
    v_cvt_pk_bf16_f32 v99, v102, v103
    v_cvt_pk_bf16_f32 v104, v104, v105
    v_cvt_pk_bf16_f32 v105, v106, v107
    v_cvt_pk_bf16_f32 v106, v108, v109
    v_cvt_pk_bf16_f32 v107, v110, v111
    v_cvt_pk_bf16_f32 v112, v112, v113
    v_cvt_pk_bf16_f32 v113, v114, v115
    v_cvt_pk_bf16_f32 v114, v116, v117
    v_cvt_pk_bf16_f32 v115, v118, v119
    v_cvt_pk_bf16_f32 v120, v120, v121
    v_cvt_pk_bf16_f32 v121, v122, v123
    v_cvt_pk_bf16_f32 v122, v124, v125
    v_cvt_pk_bf16_f32 v123, v126, v127
    v_cvt_pk_bf16_f32 v128, v128, v129
    v_cvt_pk_bf16_f32 v129, v130, v131
    v_mov_b32 v130, 0
    v_mov_b32 v131, 0
    v_mov_b32 v136, 0
    v_mov_b32 v137, 0
    v_cvt_pk_bf16_f32 v138, v140, v141
    v_cvt_pk_bf16_f32 v139, v142, v143
    v_cvt_pk_bf16_f32 v144, v144, v145
    v_cvt_pk_bf16_f32 v145, v146, v147
    v_cvt_pk_bf16_f32 v146, v148, v149
    v_cvt_pk_bf16_f32 v147, v150, v151
    v_cvt_pk_bf16_f32 v152, v152, v153
    v_cvt_pk_bf16_f32 v153, v154, v155
    v_cvt_pk_bf16_f32 v154, v156, v157
    v_cvt_pk_bf16_f32 v155, v158, v159
    v_cvt_pk_bf16_f32 v160, v160, v161
    v_cvt_pk_bf16_f32 v161, v162, v163
    v_cvt_pk_bf16_f32 v162, v164, v165
    v_cvt_pk_bf16_f32 v163, v166, v167
    v_cvt_pk_bf16_f32 v168, v168, v169
    v_cvt_pk_bf16_f32 v169, v170, v171
    v_cvt_pk_bf16_f32 v170, v172, v173
    v_cvt_pk_bf16_f32 v171, v174, v175
    v_cvt_pk_bf16_f32 v176, v176, v177
    v_cvt_pk_bf16_f32 v177, v178, v179
    v_cvt_pk_bf16_f32 v178, v180, v181
    v_cvt_pk_bf16_f32 v179, v182, v183
    v_cvt_pk_bf16_f32 v184, v184, v185
    v_cvt_pk_bf16_f32 v185, v186, v187
    v_cvt_pk_bf16_f32 v186, v188, v189
    v_cvt_pk_bf16_f32 v187, v190, v191
    v_cvt_pk_bf16_f32 v192, v192, v193
    v_cvt_pk_bf16_f32 v193, v194, v195
    v_cvt_pk_bf16_f32 v194, v196, v197
    v_cvt_pk_bf16_f32 v195, v198, v199
    v_cvt_pk_bf16_f32 v200, v200, v201
    v_cvt_pk_bf16_f32 v201, v202, v203
    v_cvt_pk_bf16_f32 v202, v204, v205
    v_cvt_pk_bf16_f32 v203, v206, v207
    s_cmp_ge_u32 s2, 170
    s_cbranch_scc1 L_k2_w2
    s_waitcnt vmcnt(4)
    s_branch L_k2_w3

L_k2_w2:
    s_waitcnt vmcnt(0)
L_k2_w3:
    s_barrier
    ds_read_b128 v[208:211], v9 offset:0
    ds_read_b128 v[212:215], v10 offset:1024
    ds_read_b128 v[216:219], v9 offset:1280
    ds_read_b128 v[220:223], v10 offset:2304
    ds_read_b128 v[224:227], v9 offset:2560
    ds_read_b128 v[228:231], v10 offset:3584
    v_mov_b32 v16, v14
    s_nop 1
    v_permlane32_swap_b32 v16, v14
    s_nop 1
    v_add_f32 v14, v14, v16
    v_mov_b32 v16, v14
    s_nop 1
    v_permlane16_swap_b32 v16, v14
    s_nop 1
    v_add_f32 v14, v14, v16

    v_rcp_f32 v14, v14
    v_mov_b32 v16, v15
    s_nop 1
    v_permlane32_swap_b32 v16, v15
    s_nop 1
    v_add_f32 v15, v15, v16
    v_mov_b32 v16, v15
    s_nop 1
    v_permlane16_swap_b32 v16, v15
    s_nop 1
    v_add_f32 v15, v15, v16

    v_rcp_f32 v15, v15
    ds_read_b128 v[232:235], v9 offset:3840
    ds_read_b128 v[236:239], v10 offset:4864
    s_waitcnt lgkmcnt(6)
    v_mfma_f32_16x16x32_bf16 v[240:243], v[208:211], v[64:67], 0
    v_mfma_f32_16x16x32_bf16 v[244:247], v[212:215], v[64:67], 0
    v_mfma_f32_16x16x32_bf16 v[248:251], v[208:211], v[136:139], 0
    v_mfma_f32_16x16x32_bf16 v[252:255], v[212:215], v[136:139], 0
    ds_read_b128 v[208:211], v9 offset:5120
    ds_read_b128 v[212:215], v10 offset:6144
    s_waitcnt lgkmcnt(6)
    v_mfma_f32_16x16x32_bf16 v[240:243], v[216:219], v[72:75], v[240:243]
    v_mfma_f32_16x16x32_bf16 v[244:247], v[220:223], v[72:75], v[244:247]
    v_mfma_f32_16x16x32_bf16 v[248:251], v[216:219], v[144:147], v[248:251]
    v_mfma_f32_16x16x32_bf16 v[252:255], v[220:223], v[144:147], v[252:255]
    ds_read_b128 v[216:219], v9 offset:6400
    ds_read_b128 v[220:223], v10 offset:7424
    s_waitcnt lgkmcnt(6)
    v_mfma_f32_16x16x32_bf16 v[240:243], v[224:227], v[80:83], v[240:243]
    v_mfma_f32_16x16x32_bf16 v[244:247], v[228:231], v[80:83], v[244:247]
    v_mfma_f32_16x16x32_bf16 v[248:251], v[224:227], v[152:155], v[248:251]
    v_mfma_f32_16x16x32_bf16 v[252:255], v[228:231], v[152:155], v[252:255]
    ds_read_b128 v[224:227], v9 offset:7680
    ds_read_b128 v[228:231], v10 offset:8704
    s_waitcnt lgkmcnt(6)
    v_mfma_f32_16x16x32_bf16 v[240:243], v[232:235], v[88:91], v[240:243]
    v_mfma_f32_16x16x32_bf16 v[244:247], v[236:239], v[88:91], v[244:247]
    v_mfma_f32_16x16x32_bf16 v[248:251], v[232:235], v[160:163], v[248:251]
    v_mfma_f32_16x16x32_bf16 v[252:255], v[236:239], v[160:163], v[252:255]
    ds_read_b128 v[232:235], v9 offset:8960
    ds_read_b128 v[236:239], v10 offset:9984
    s_waitcnt lgkmcnt(6)
    v_mfma_f32_16x16x32_bf16 v[240:243], v[208:211], v[96:99], v[240:243]
    v_mfma_f32_16x16x32_bf16 v[244:247], v[212:215], v[96:99], v[244:247]
    v_mfma_f32_16x16x32_bf16 v[248:251], v[208:211], v[168:171], v[248:251]
    v_mfma_f32_16x16x32_bf16 v[252:255], v[212:215], v[168:171], v[252:255]
    ds_read_b128 v[208:211], v9 offset:10240
    ds_read_b128 v[212:215], v10 offset:11264
    s_waitcnt lgkmcnt(6)
    v_mfma_f32_16x16x32_bf16 v[240:243], v[216:219], v[104:107], v[240:243]
    v_mfma_f32_16x16x32_bf16 v[244:247], v[220:223], v[104:107], v[244:247]
    v_mfma_f32_16x16x32_bf16 v[248:251], v[216:219], v[176:179], v[248:251]
    v_mfma_f32_16x16x32_bf16 v[252:255], v[220:223], v[176:179], v[252:255]
    s_waitcnt lgkmcnt(4)
    v_mfma_f32_16x16x32_bf16 v[240:243], v[224:227], v[112:115], v[240:243]
    v_mfma_f32_16x16x32_bf16 v[244:247], v[228:231], v[112:115], v[244:247]
    v_mfma_f32_16x16x32_bf16 v[248:251], v[224:227], v[184:187], v[248:251]
    v_mfma_f32_16x16x32_bf16 v[252:255], v[228:231], v[184:187], v[252:255]
    s_waitcnt lgkmcnt(2)
    v_mfma_f32_16x16x32_bf16 v[240:243], v[232:235], v[120:123], v[240:243]
    v_mfma_f32_16x16x32_bf16 v[244:247], v[236:239], v[120:123], v[244:247]
    v_mfma_f32_16x16x32_bf16 v[248:251], v[232:235], v[192:195], v[248:251]
    v_mfma_f32_16x16x32_bf16 v[252:255], v[236:239], v[192:195], v[252:255]
    s_waitcnt lgkmcnt(0)
    v_mfma_f32_16x16x32_bf16 v[240:243], v[208:211], v[128:131], v[240:243]
    v_mfma_f32_16x16x32_bf16 v[244:247], v[212:215], v[128:131], v[244:247]
    v_mfma_f32_16x16x32_bf16 v[248:251], v[208:211], v[200:203], v[248:251]
    v_mfma_f32_16x16x32_bf16 v[252:255], v[212:215], v[200:203], v[252:255]
    s_add_u32 s26, s13, s24
    s_lshr_b32 s26, s26, 4
    s_mul_i32 s26, s26, 69632
    s_add_u32 s26, s26, 16777216
    s_add_u32 s18, s6, s26
    s_addc_u32 s19, s7, 0
    s_mul_i32 s27, s12, 20
    v_lshl_add_u32 v20, v6, 2, s27
    v_add_u32 v22, 16, v20
    v_lshrrev_b32 v21, 3, v20
    v_lshlrev_b32 v21, 8, v21
    v_and_b32 v20, 4, v20
    v_lshl_add_u32 v21, v20, 1, v21
    v_lshl_add_u32 v20, v5, 4, v21
    v_lshrrev_b32 v21, 3, v22
    v_lshlrev_b32 v21, 8, v21
    v_and_b32 v22, 4, v22
    v_lshl_add_u32 v21, v22, 1, v21
    v_lshl_add_u32 v21, v5, 4, v21
    v_add_u32 v22, 69632, v20
    v_add_u32 v23, 69632, v21
    s_nop 3

    v_mul_f32 v240, v240, v14
    v_mul_f32 v241, v241, v14
    v_mul_f32 v242, v242, v14
    v_mul_f32 v243, v243, v14
    v_cvt_pk_bf16_f32 v240, v240, v241
    v_cvt_pk_bf16_f32 v241, v242, v243
    v_mul_f32 v244, v244, v14
    v_mul_f32 v245, v245, v14
    v_mul_f32 v246, v246, v14
    v_mul_f32 v247, v247, v14
    v_cvt_pk_bf16_f32 v244, v244, v245
    v_cvt_pk_bf16_f32 v245, v246, v247
    v_mul_f32 v248, v248, v15
    v_mul_f32 v249, v249, v15
    v_mul_f32 v250, v250, v15
    v_mul_f32 v251, v251, v15
    v_cvt_pk_bf16_f32 v248, v248, v249
    v_cvt_pk_bf16_f32 v249, v250, v251
    v_mul_f32 v252, v252, v15
    v_mul_f32 v253, v253, v15
    v_mul_f32 v254, v254, v15
    v_mul_f32 v255, v255, v15
    v_cvt_pk_bf16_f32 v252, v252, v253
    v_cvt_pk_bf16_f32 v253, v254, v255
    global_store_dwordx2 v20, v[240:241], s[18:19]
    global_store_dwordx2 v22, v[248:249], s[18:19]
    s_mov_b64 exec, 0xffff
    global_store_dwordx2 v21, v[244:245], s[18:19]
    global_store_dwordx2 v23, v[252:253], s[18:19]
    s_mov_b64 exec, -1
    s_cmp_ge_u32 s2, 170
    s_cbranch_scc1 L_k2_norel2
    s_waitcnt vmcnt(0)
    s_barrier
    v_lshrrev_b32 v20, 2, v5
    v_lshl_add_u32 v20, v6, 3, v20
    v_lshlrev_b32 v20, 8, v20
    v_and_b32 v21, 3, v2
    v_lshl_add_u32 v20, v21, 3, v20
    s_lshl_b32 s61, s14, 6
    s_add_u32 s61, s61, 40960
    v_add_u32 v20, s61, v20

    ds_read_b64_tr_b16 v[208:209], v20 offset:0
    ds_read_b64_tr_b16 v[210:211], v20 offset:1024
    ds_read_b64_tr_b16 v[212:213], v20 offset:8192
    ds_read_b64_tr_b16 v[214:215], v20 offset:9216
    ds_read_b64_tr_b16 v[216:217], v20 offset:32
    ds_read_b64_tr_b16 v[218:219], v20 offset:1056
    ds_read_b64_tr_b16 v[220:221], v20 offset:8224
    ds_read_b64_tr_b16 v[222:223], v20 offset:9248
    s_lshl_b32 s62, s55, 3
    s_lshl_b32 s63, s14, 1
    s_add_u32 s62, s62, s63
    s_mul_i32 s62, s62, 68
    s_lshl_b32 s63, s54, 1
    s_add_u32 s62, s62, s63
    s_lshl_b32 s62, s62, 10
    s_add_u32 s62, s62, 27262976
    s_add_u32 s56, s6, s62
    s_addc_u32 s57, s7, 0
    v_add_u32 v21, 69632, v3
    s_waitcnt lgkmcnt(0)

    global_store_dwordx4 v3, v[208:211], s[56:57] offset:0
    global_store_dwordx4 v3, v[212:215], s[56:57] offset:1024
    global_store_dwordx4 v21, v[216:219], s[56:57] offset:0
    global_store_dwordx4 v21, v[220:223], s[56:57] offset:1024
    s_nop 1
L_k2_norel2:
    s_waitcnt vmcnt(0)
L_k2_done:
    s_endpgm
.globl gemm2_kernel
.p2align 8
.type gemm2_kernel,@function
gemm2_kernel:

    s_cmp_ge_u32 s2, 256
    s_cbranch_scc1 L_k3_done

    s_load_dwordx2 s[4:5], s[0:1], 0
    s_load_dwordx2 s[8:9], s[0:1], 16
    s_load_dwordx2 s[10:11], s[0:1], 48
    s_load_dwordx2 s[24:25], s[0:1], 56
    s_load_dwordx2 s[6:7], s[0:1], 72

    s_and_b32 s3, s2, 7
    s_lshr_b32 s15, s2, 3
    s_and_b32 s12, s3, 3
    s_lshl_b32 s12, s12, 3
    s_and_b32 s13, s15, 7
    s_add_u32 s12, s12, s13
    s_lshr_b32 s13, s3, 2
    s_lshl_b32 s13, s13, 2
    s_lshr_b32 s15, s15, 3
    s_add_u32 s13, s13, s15
    s_mul_i32 s13, s13, 160
    v_lshrrev_b32 v1, 6, v0
    v_and_b32 v2, 63, v0
    s_nop 0
    v_readfirstlane_b32 s14, v1
    v_and_b32 v3, 15, v2
    v_lshrrev_b32 v4, 4, v2

    v_lshlrev_b32 v5, 4, v2
    v_mov_b32 v120, v5
    v_add_u32 v121, 69632, v5
    v_add_u32 v122, 139264, v5
    v_add_u32 v123, 208896, v5
    v_add_u32 v124, 278528, v5
    s_waitcnt lgkmcnt(0)

    s_mul_i32 s15, s14, 17408
    s_mul_i32 s22, s12, 278528
    s_add_u32 s22, s22, s15
    s_add_u32 s22, s22, 16777216
    s_add_u32 s16, s6, s22
    s_addc_u32 s17, s7, 0
    s_mul_i32 s22, s13, 2176
    s_add_u32 s22, s22, s15
    s_add_u32 s22, s22, 27262976
    s_add_u32 s18, s6, s22
    s_addc_u32 s19, s7, 0
    v_mov_b32 v130, v5
    v_add_u32 v131, 69632, v5
    v_add_u32 v132, 139264, v5
    v_add_u32 v133, 208896, v5

    global_load_dwordx4 a[16:19], v120, s[18:19]
    global_load_dwordx4 a[20:23], v121, s[18:19]
    global_load_dwordx4 a[24:27], v122, s[18:19]
    global_load_dwordx4 a[28:31], v123, s[18:19]
    global_load_dwordx4 a[32:35], v124, s[18:19]
    global_load_dwordx4 a[0:3], v130, s[16:17]
    global_load_dwordx4 a[4:7], v131, s[16:17]
    global_load_dwordx4 a[8:11], v132, s[16:17]
    global_load_dwordx4 a[12:15], v133, s[16:17]
    s_add_u32 s16, s16, 1024
    s_addc_u32 s17, s17, 0
    s_add_u32 s18, s18, 1024
    s_addc_u32 s19, s19, 0
    global_load_dwordx4 a[52:55], v120, s[18:19]
    global_load_dwordx4 a[56:59], v121, s[18:19]
    global_load_dwordx4 a[60:63], v122, s[18:19]
    global_load_dwordx4 a[64:67], v123, s[18:19]
    global_load_dwordx4 a[68:71], v124, s[18:19]
    global_load_dwordx4 a[36:39], v130, s[16:17]
    global_load_dwordx4 a[40:43], v131, s[16:17]
    global_load_dwordx4 a[44:47], v132, s[16:17]
    global_load_dwordx4 a[48:51], v133, s[16:17]
    s_add_u32 s16, s16, 1024
    s_addc_u32 s17, s17, 0
    s_add_u32 s18, s18, 1024
    s_addc_u32 s19, s19, 0
    global_load_dwordx4 a[88:91], v120, s[18:19]
    global_load_dwordx4 a[92:95], v121, s[18:19]
    global_load_dwordx4 a[96:99], v122, s[18:19]
    global_load_dwordx4 a[100:103], v123, s[18:19]
    global_load_dwordx4 a[104:107], v124, s[18:19]
    global_load_dwordx4 a[72:75], v130, s[16:17]
    global_load_dwordx4 a[76:79], v131, s[16:17]
    global_load_dwordx4 a[80:83], v132, s[16:17]
    global_load_dwordx4 a[84:87], v133, s[16:17]
    s_add_u32 s16, s16, 1024
    s_addc_u32 s17, s17, 0
    s_add_u32 s18, s18, 1024
    s_addc_u32 s19, s19, 0
    global_load_dwordx4 a[124:127], v120, s[18:19]
    global_load_dwordx4 a[128:131], v121, s[18:19]
    global_load_dwordx4 a[132:135], v122, s[18:19]
    global_load_dwordx4 a[136:139], v123, s[18:19]
    global_load_dwordx4 a[140:143], v124, s[18:19]
    global_load_dwordx4 a[108:111], v130, s[16:17]
    global_load_dwordx4 a[112:115], v131, s[16:17]
    global_load_dwordx4 a[116:119], v132, s[16:17]
    global_load_dwordx4 a[120:123], v133, s[16:17]
    s_add_u32 s16, s16, 1024
    s_addc_u32 s17, s17, 0
    s_add_u32 s18, s18, 1024
    s_addc_u32 s19, s19, 0
    global_load_dwordx4 a[160:163], v120, s[18:19]
    global_load_dwordx4 a[164:167], v121, s[18:19]
    global_load_dwordx4 a[168:171], v122, s[18:19]
    global_load_dwordx4 a[172:175], v123, s[18:19]
    global_load_dwordx4 a[176:179], v124, s[18:19]
    global_load_dwordx4 a[144:147], v130, s[16:17]
    global_load_dwordx4 a[148:151], v131, s[16:17]
    global_load_dwordx4 a[152:155], v132, s[16:17]
    global_load_dwordx4 a[156:159], v133, s[16:17]
    s_add_u32 s16, s16, 1024
    s_addc_u32 s17, s17, 0
    s_add_u32 s18, s18, 1024
    s_addc_u32 s19, s19, 0
    global_load_dwordx4 a[196:199], v120, s[18:19]
    global_load_dwordx4 a[200:203], v121, s[18:19]
    global_load_dwordx4 a[204:207], v122, s[18:19]
    global_load_dwordx4 a[208:211], v123, s[18:19]
    global_load_dwordx4 a[212:215], v124, s[18:19]
    global_load_dwordx4 a[180:183], v130, s[16:17]
    global_load_dwordx4 a[184:187], v131, s[16:17]
    global_load_dwordx4 a[188:191], v132, s[16:17]
    global_load_dwordx4 a[192:195], v133, s[16:17]
    s_add_u32 s16, s16, 1024
    s_addc_u32 s17, s17, 0
    s_add_u32 s18, s18, 1024
    s_addc_u32 s19, s19, 0
    global_load_dwordx4 a[232:235], v120, s[18:19]
    global_load_dwordx4 a[236:239], v121, s[18:19]
    global_load_dwordx4 a[240:243], v122, s[18:19]
    global_load_dwordx4 a[244:247], v123, s[18:19]
    global_load_dwordx4 a[248:251], v124, s[18:19]
    global_load_dwordx4 a[216:219], v130, s[16:17]
    global_load_dwordx4 a[220:223], v131, s[16:17]
    global_load_dwordx4 a[224:227], v132, s[16:17]
    global_load_dwordx4 a[228:231], v133, s[16:17]
    s_add_u32 s16, s16, 1024
    s_addc_u32 s17, s17, 0
    s_add_u32 s18, s18, 1024
    s_addc_u32 s19, s19, 0
    s_waitcnt vmcnt(54)
    v_mfma_f32_16x16x32_bf16 v[16:19], a[16:19], a[0:3], 0
    v_mfma_f32_16x16x32_bf16 v[36:39], a[16:19], a[4:7], 0
    global_load_dwordx4 v[148:151], v120, s[18:19]
    v_mfma_f32_16x16x32_bf16 v[56:59], a[16:19], a[8:11], 0
    v_mfma_f32_16x16x32_bf16 v[76:79], a[16:19], a[12:15], 0
    global_load_dwordx4 v[152:155], v121, s[18:19]
    v_mfma_f32_16x16x32_bf16 v[20:23], a[20:23], a[0:3], 0
    v_mfma_f32_16x16x32_bf16 v[40:43], a[20:23], a[4:7], 0
    global_load_dwordx4 v[156:159], v122, s[18:19]
    v_mfma_f32_16x16x32_bf16 v[60:63], a[20:23], a[8:11], 0
    v_mfma_f32_16x16x32_bf16 v[80:83], a[20:23], a[12:15], 0
    global_load_dwordx4 v[160:163], v123, s[18:19]
    v_mfma_f32_16x16x32_bf16 v[24:27], a[24:27], a[0:3], 0
    v_mfma_f32_16x16x32_bf16 v[44:47], a[24:27], a[4:7], 0
    global_load_dwordx4 v[164:167], v124, s[18:19]
    v_mfma_f32_16x16x32_bf16 v[64:67], a[24:27], a[8:11], 0
    v_mfma_f32_16x16x32_bf16 v[84:87], a[24:27], a[12:15], 0
    global_load_dwordx4 a[252:255], v130, s[16:17]
    v_mfma_f32_16x16x32_bf16 v[28:31], a[28:31], a[0:3], 0
    v_mfma_f32_16x16x32_bf16 v[48:51], a[28:31], a[4:7], 0
    global_load_dwordx4 v[136:139], v131, s[16:17]
    v_mfma_f32_16x16x32_bf16 v[68:71], a[28:31], a[8:11], 0
    v_mfma_f32_16x16x32_bf16 v[88:91], a[28:31], a[12:15], 0
    global_load_dwordx4 v[140:143], v132, s[16:17]
    v_mfma_f32_16x16x32_bf16 v[32:35], a[32:35], a[0:3], 0
    v_mfma_f32_16x16x32_bf16 v[52:55], a[32:35], a[4:7], 0
    global_load_dwordx4 v[144:147], v133, s[16:17]
    v_mfma_f32_16x16x32_bf16 v[72:75], a[32:35], a[8:11], 0
    v_mfma_f32_16x16x32_bf16 v[92:95], a[32:35], a[12:15], 0
    s_add_u32 s16, s16, 1024
    s_addc_u32 s17, s17, 0
    s_add_u32 s18, s18, 1024
    s_addc_u32 s19, s19, 0
    s_waitcnt vmcnt(54)
    v_mfma_f32_16x16x32_bf16 v[16:19], a[52:55], a[36:39], v[16:19]
    v_mfma_f32_16x16x32_bf16 v[36:39], a[52:55], a[40:43], v[36:39]
    global_load_dwordx4 a[16:19], v120, s[18:19]
    v_mfma_f32_16x16x32_bf16 v[56:59], a[52:55], a[44:47], v[56:59]
    v_mfma_f32_16x16x32_bf16 v[76:79], a[52:55], a[48:51], v[76:79]
    global_load_dwordx4 a[20:23], v121, s[18:19]
    v_mfma_f32_16x16x32_bf16 v[20:23], a[56:59], a[36:39], v[20:23]
    v_mfma_f32_16x16x32_bf16 v[40:43], a[56:59], a[40:43], v[40:43]
    global_load_dwordx4 a[24:27], v122, s[18:19]
    v_mfma_f32_16x16x32_bf16 v[60:63], a[56:59], a[44:47], v[60:63]
    v_mfma_f32_16x16x32_bf16 v[80:83], a[56:59], a[48:51], v[80:83]
    global_load_dwordx4 a[28:31], v123, s[18:19]
    v_mfma_f32_16x16x32_bf16 v[24:27], a[60:63], a[36:39], v[24:27]
    v_mfma_f32_16x16x32_bf16 v[44:47], a[60:63], a[40:43], v[44:47]
    global_load_dwordx4 a[32:35], v124, s[18:19]
    v_mfma_f32_16x16x32_bf16 v[64:67], a[60:63], a[44:47], v[64:67]
    v_mfma_f32_16x16x32_bf16 v[84:87], a[60:63], a[48:51], v[84:87]
    global_load_dwordx4 a[0:3], v130, s[16:17]
    v_mfma_f32_16x16x32_bf16 v[28:31], a[64:67], a[36:39], v[28:31]
    v_mfma_f32_16x16x32_bf16 v[48:51], a[64:67], a[40:43], v[48:51]
    global_load_dwordx4 a[4:7], v131, s[16:17]
    v_mfma_f32_16x16x32_bf16 v[68:71], a[64:67], a[44:47], v[68:71]
    v_mfma_f32_16x16x32_bf16 v[88:91], a[64:67], a[48:51], v[88:91]
    global_load_dwordx4 a[8:11], v132, s[16:17]
    v_mfma_f32_16x16x32_bf16 v[32:35], a[68:71], a[36:39], v[32:35]
    v_mfma_f32_16x16x32_bf16 v[52:55], a[68:71], a[40:43], v[52:55]
    global_load_dwordx4 a[12:15], v133, s[16:17]
    v_mfma_f32_16x16x32_bf16 v[72:75], a[68:71], a[44:47], v[72:75]
    v_mfma_f32_16x16x32_bf16 v[92:95], a[68:71], a[48:51], v[92:95]
    s_add_u32 s16, s16, 1024
    s_addc_u32 s17, s17, 0
    s_add_u32 s18, s18, 1024
    s_addc_u32 s19, s19, 0
    s_waitcnt vmcnt(54)
    v_mfma_f32_16x16x32_bf16 v[16:19], a[88:91], a[72:75], v[16:19]
    v_mfma_f32_16x16x32_bf16 v[36:39], a[88:91], a[76:79], v[36:39]
    global_load_dwordx4 a[52:55], v120, s[18:19]
    v_mfma_f32_16x16x32_bf16 v[56:59], a[88:91], a[80:83], v[56:59]
    v_mfma_f32_16x16x32_bf16 v[76:79], a[88:91], a[84:87], v[76:79]
    global_load_dwordx4 a[56:59], v121, s[18:19]
    v_mfma_f32_16x16x32_bf16 v[20:23], a[92:95], a[72:75], v[20:23]
    v_mfma_f32_16x16x32_bf16 v[40:43], a[92:95], a[76:79], v[40:43]
    global_load_dwordx4 a[60:63], v122, s[18:19]
    v_mfma_f32_16x16x32_bf16 v[60:63], a[92:95], a[80:83], v[60:63]
    v_mfma_f32_16x16x32_bf16 v[80:83], a[92:95], a[84:87], v[80:83]
    global_load_dwordx4 a[64:67], v123, s[18:19]
    v_mfma_f32_16x16x32_bf16 v[24:27], a[96:99], a[72:75], v[24:27]
    v_mfma_f32_16x16x32_bf16 v[44:47], a[96:99], a[76:79], v[44:47]
    global_load_dwordx4 a[68:71], v124, s[18:19]
    v_mfma_f32_16x16x32_bf16 v[64:67], a[96:99], a[80:83], v[64:67]
    v_mfma_f32_16x16x32_bf16 v[84:87], a[96:99], a[84:87], v[84:87]
    global_load_dwordx4 a[36:39], v130, s[16:17]
    v_mfma_f32_16x16x32_bf16 v[28:31], a[100:103], a[72:75], v[28:31]
    v_mfma_f32_16x16x32_bf16 v[48:51], a[100:103], a[76:79], v[48:51]
    global_load_dwordx4 a[40:43], v131, s[16:17]
    v_mfma_f32_16x16x32_bf16 v[68:71], a[100:103], a[80:83], v[68:71]
    v_mfma_f32_16x16x32_bf16 v[88:91], a[100:103], a[84:87], v[88:91]
    global_load_dwordx4 a[44:47], v132, s[16:17]
    v_mfma_f32_16x16x32_bf16 v[32:35], a[104:107], a[72:75], v[32:35]
    v_mfma_f32_16x16x32_bf16 v[52:55], a[104:107], a[76:79], v[52:55]
    global_load_dwordx4 a[48:51], v133, s[16:17]
    v_mfma_f32_16x16x32_bf16 v[72:75], a[104:107], a[80:83], v[72:75]
    v_mfma_f32_16x16x32_bf16 v[92:95], a[104:107], a[84:87], v[92:95]
    s_add_u32 s16, s16, 1024
    s_addc_u32 s17, s17, 0
    s_add_u32 s18, s18, 1024
    s_addc_u32 s19, s19, 0
    s_waitcnt vmcnt(54)
    v_mfma_f32_16x16x32_bf16 v[16:19], a[124:127], a[108:111], v[16:19]
    v_mfma_f32_16x16x32_bf16 v[36:39], a[124:127], a[112:115], v[36:39]
    global_load_dwordx4 a[88:91], v120, s[18:19]
    v_mfma_f32_16x16x32_bf16 v[56:59], a[124:127], a[116:119], v[56:59]
    v_mfma_f32_16x16x32_bf16 v[76:79], a[124:127], a[120:123], v[76:79]
    global_load_dwordx4 a[92:95], v121, s[18:19]
    v_mfma_f32_16x16x32_bf16 v[20:23], a[128:131], a[108:111], v[20:23]
    v_mfma_f32_16x16x32_bf16 v[40:43], a[128:131], a[112:115], v[40:43]
    global_load_dwordx4 a[96:99], v122, s[18:19]
    v_mfma_f32_16x16x32_bf16 v[60:63], a[128:131], a[116:119], v[60:63]
    v_mfma_f32_16x16x32_bf16 v[80:83], a[128:131], a[120:123], v[80:83]
    global_load_dwordx4 a[100:103], v123, s[18:19]
    v_mfma_f32_16x16x32_bf16 v[24:27], a[132:135], a[108:111], v[24:27]
    v_mfma_f32_16x16x32_bf16 v[44:47], a[132:135], a[112:115], v[44:47]
    global_load_dwordx4 a[104:107], v124, s[18:19]
    v_mfma_f32_16x16x32_bf16 v[64:67], a[132:135], a[116:119], v[64:67]
    v_mfma_f32_16x16x32_bf16 v[84:87], a[132:135], a[120:123], v[84:87]
    global_load_dwordx4 a[72:75], v130, s[16:17]
    v_mfma_f32_16x16x32_bf16 v[28:31], a[136:139], a[108:111], v[28:31]
    v_mfma_f32_16x16x32_bf16 v[48:51], a[136:139], a[112:115], v[48:51]
    global_load_dwordx4 a[76:79], v131, s[16:17]
    v_mfma_f32_16x16x32_bf16 v[68:71], a[136:139], a[116:119], v[68:71]
    v_mfma_f32_16x16x32_bf16 v[88:91], a[136:139], a[120:123], v[88:91]
    global_load_dwordx4 a[80:83], v132, s[16:17]
    v_mfma_f32_16x16x32_bf16 v[32:35], a[140:143], a[108:111], v[32:35]
    v_mfma_f32_16x16x32_bf16 v[52:55], a[140:143], a[112:115], v[52:55]
    global_load_dwordx4 a[84:87], v133, s[16:17]
    v_mfma_f32_16x16x32_bf16 v[72:75], a[140:143], a[116:119], v[72:75]
    v_mfma_f32_16x16x32_bf16 v[92:95], a[140:143], a[120:123], v[92:95]
    s_add_u32 s16, s16, 1024
    s_addc_u32 s17, s17, 0
    s_add_u32 s18, s18, 1024
    s_addc_u32 s19, s19, 0
    s_waitcnt vmcnt(54)
    v_mfma_f32_16x16x32_bf16 v[16:19], a[160:163], a[144:147], v[16:19]
    v_mfma_f32_16x16x32_bf16 v[36:39], a[160:163], a[148:151], v[36:39]
    global_load_dwordx4 a[124:127], v120, s[18:19]
    v_mfma_f32_16x16x32_bf16 v[56:59], a[160:163], a[152:155], v[56:59]
    v_mfma_f32_16x16x32_bf16 v[76:79], a[160:163], a[156:159], v[76:79]
    global_load_dwordx4 a[128:131], v121, s[18:19]
    v_mfma_f32_16x16x32_bf16 v[20:23], a[164:167], a[144:147], v[20:23]
    v_mfma_f32_16x16x32_bf16 v[40:43], a[164:167], a[148:151], v[40:43]
    global_load_dwordx4 a[132:135], v122, s[18:19]
    v_mfma_f32_16x16x32_bf16 v[60:63], a[164:167], a[152:155], v[60:63]
    v_mfma_f32_16x16x32_bf16 v[80:83], a[164:167], a[156:159], v[80:83]
    global_load_dwordx4 a[136:139], v123, s[18:19]
    v_mfma_f32_16x16x32_bf16 v[24:27], a[168:171], a[144:147], v[24:27]
    v_mfma_f32_16x16x32_bf16 v[44:47], a[168:171], a[148:151], v[44:47]
    global_load_dwordx4 a[140:143], v124, s[18:19]
    v_mfma_f32_16x16x32_bf16 v[64:67], a[168:171], a[152:155], v[64:67]
    v_mfma_f32_16x16x32_bf16 v[84:87], a[168:171], a[156:159], v[84:87]
    global_load_dwordx4 a[108:111], v130, s[16:17]
    v_mfma_f32_16x16x32_bf16 v[28:31], a[172:175], a[144:147], v[28:31]
    v_mfma_f32_16x16x32_bf16 v[48:51], a[172:175], a[148:151], v[48:51]
    global_load_dwordx4 a[112:115], v131, s[16:17]
    v_mfma_f32_16x16x32_bf16 v[68:71], a[172:175], a[152:155], v[68:71]
    v_mfma_f32_16x16x32_bf16 v[88:91], a[172:175], a[156:159], v[88:91]
    global_load_dwordx4 a[116:119], v132, s[16:17]
    v_mfma_f32_16x16x32_bf16 v[32:35], a[176:179], a[144:147], v[32:35]
    v_mfma_f32_16x16x32_bf16 v[52:55], a[176:179], a[148:151], v[52:55]
    global_load_dwordx4 a[120:123], v133, s[16:17]
    v_mfma_f32_16x16x32_bf16 v[72:75], a[176:179], a[152:155], v[72:75]
    v_mfma_f32_16x16x32_bf16 v[92:95], a[176:179], a[156:159], v[92:95]
    s_add_u32 s16, s16, 1024
    s_addc_u32 s17, s17, 0
    s_add_u32 s18, s18, 1024
    s_addc_u32 s19, s19, 0
    s_waitcnt vmcnt(54)
    v_mfma_f32_16x16x32_bf16 v[16:19], a[196:199], a[180:183], v[16:19]
    v_mfma_f32_16x16x32_bf16 v[36:39], a[196:199], a[184:187], v[36:39]
    global_load_dwordx4 a[160:163], v120, s[18:19]
    v_mfma_f32_16x16x32_bf16 v[56:59], a[196:199], a[188:191], v[56:59]
    v_mfma_f32_16x16x32_bf16 v[76:79], a[196:199], a[192:195], v[76:79]
    global_load_dwordx4 a[164:167], v121, s[18:19]
    v_mfma_f32_16x16x32_bf16 v[20:23], a[200:203], a[180:183], v[20:23]
    v_mfma_f32_16x16x32_bf16 v[40:43], a[200:203], a[184:187], v[40:43]
    global_load_dwordx4 a[168:171], v122, s[18:19]
    v_mfma_f32_16x16x32_bf16 v[60:63], a[200:203], a[188:191], v[60:63]
    v_mfma_f32_16x16x32_bf16 v[80:83], a[200:203], a[192:195], v[80:83]
    global_load_dwordx4 a[172:175], v123, s[18:19]
    v_mfma_f32_16x16x32_bf16 v[24:27], a[204:207], a[180:183], v[24:27]
    v_mfma_f32_16x16x32_bf16 v[44:47], a[204:207], a[184:187], v[44:47]
    global_load_dwordx4 a[176:179], v124, s[18:19]
    v_mfma_f32_16x16x32_bf16 v[64:67], a[204:207], a[188:191], v[64:67]
    v_mfma_f32_16x16x32_bf16 v[84:87], a[204:207], a[192:195], v[84:87]
    global_load_dwordx4 a[144:147], v130, s[16:17]
    v_mfma_f32_16x16x32_bf16 v[28:31], a[208:211], a[180:183], v[28:31]
    v_mfma_f32_16x16x32_bf16 v[48:51], a[208:211], a[184:187], v[48:51]
    global_load_dwordx4 a[148:151], v131, s[16:17]
    v_mfma_f32_16x16x32_bf16 v[68:71], a[208:211], a[188:191], v[68:71]
    v_mfma_f32_16x16x32_bf16 v[88:91], a[208:211], a[192:195], v[88:91]
    global_load_dwordx4 a[152:155], v132, s[16:17]
    v_mfma_f32_16x16x32_bf16 v[32:35], a[212:215], a[180:183], v[32:35]
    v_mfma_f32_16x16x32_bf16 v[52:55], a[212:215], a[184:187], v[52:55]
    global_load_dwordx4 a[156:159], v133, s[16:17]
    v_mfma_f32_16x16x32_bf16 v[72:75], a[212:215], a[188:191], v[72:75]
    v_mfma_f32_16x16x32_bf16 v[92:95], a[212:215], a[192:195], v[92:95]
    s_add_u32 s16, s16, 1024
    s_addc_u32 s17, s17, 0
    s_add_u32 s18, s18, 1024
    s_addc_u32 s19, s19, 0
    s_waitcnt vmcnt(54)
    v_mfma_f32_16x16x32_bf16 v[16:19], a[232:235], a[216:219], v[16:19]
    v_mfma_f32_16x16x32_bf16 v[36:39], a[232:235], a[220:223], v[36:39]
    global_load_dwordx4 a[196:199], v120, s[18:19]
    v_mfma_f32_16x16x32_bf16 v[56:59], a[232:235], a[224:227], v[56:59]
    v_mfma_f32_16x16x32_bf16 v[76:79], a[232:235], a[228:231], v[76:79]
    global_load_dwordx4 a[200:203], v121, s[18:19]
    v_mfma_f32_16x16x32_bf16 v[20:23], a[236:239], a[216:219], v[20:23]
    v_mfma_f32_16x16x32_bf16 v[40:43], a[236:239], a[220:223], v[40:43]
    global_load_dwordx4 a[204:207], v122, s[18:19]
    v_mfma_f32_16x16x32_bf16 v[60:63], a[236:239], a[224:227], v[60:63]
    v_mfma_f32_16x16x32_bf16 v[80:83], a[236:239], a[228:231], v[80:83]
    global_load_dwordx4 a[208:211], v123, s[18:19]
    v_mfma_f32_16x16x32_bf16 v[24:27], a[240:243], a[216:219], v[24:27]
    v_mfma_f32_16x16x32_bf16 v[44:47], a[240:243], a[220:223], v[44:47]
    global_load_dwordx4 a[212:215], v124, s[18:19]
    v_mfma_f32_16x16x32_bf16 v[64:67], a[240:243], a[224:227], v[64:67]
    v_mfma_f32_16x16x32_bf16 v[84:87], a[240:243], a[228:231], v[84:87]
    global_load_dwordx4 a[180:183], v130, s[16:17]
    v_mfma_f32_16x16x32_bf16 v[28:31], a[244:247], a[216:219], v[28:31]
    v_mfma_f32_16x16x32_bf16 v[48:51], a[244:247], a[220:223], v[48:51]
    global_load_dwordx4 a[184:187], v131, s[16:17]
    v_mfma_f32_16x16x32_bf16 v[68:71], a[244:247], a[224:227], v[68:71]
    v_mfma_f32_16x16x32_bf16 v[88:91], a[244:247], a[228:231], v[88:91]
    global_load_dwordx4 a[188:191], v132, s[16:17]
    v_mfma_f32_16x16x32_bf16 v[32:35], a[248:251], a[216:219], v[32:35]
    v_mfma_f32_16x16x32_bf16 v[52:55], a[248:251], a[220:223], v[52:55]
    global_load_dwordx4 a[192:195], v133, s[16:17]
    v_mfma_f32_16x16x32_bf16 v[72:75], a[248:251], a[224:227], v[72:75]
    v_mfma_f32_16x16x32_bf16 v[92:95], a[248:251], a[228:231], v[92:95]
    s_add_u32 s16, s16, 1024
    s_addc_u32 s17, s17, 0
    s_add_u32 s18, s18, 1024
    s_addc_u32 s19, s19, 0
    s_waitcnt vmcnt(54)
    v_mfma_f32_16x16x32_bf16 v[16:19], v[148:151], a[252:255], v[16:19]
    v_mfma_f32_16x16x32_bf16 v[36:39], v[148:151], v[136:139], v[36:39]
    global_load_dwordx4 a[232:235], v120, s[18:19]
    v_mfma_f32_16x16x32_bf16 v[56:59], v[148:151], v[140:143], v[56:59]
    v_mfma_f32_16x16x32_bf16 v[76:79], v[148:151], v[144:147], v[76:79]
    global_load_dwordx4 a[236:239], v121, s[18:19]
    v_mfma_f32_16x16x32_bf16 v[20:23], v[152:155], a[252:255], v[20:23]
    v_mfma_f32_16x16x32_bf16 v[40:43], v[152:155], v[136:139], v[40:43]
    global_load_dwordx4 a[240:243], v122, s[18:19]
    v_mfma_f32_16x16x32_bf16 v[60:63], v[152:155], v[140:143], v[60:63]
    v_mfma_f32_16x16x32_bf16 v[80:83], v[152:155], v[144:147], v[80:83]
    global_load_dwordx4 a[244:247], v123, s[18:19]
    v_mfma_f32_16x16x32_bf16 v[24:27], v[156:159], a[252:255], v[24:27]
    v_mfma_f32_16x16x32_bf16 v[44:47], v[156:159], v[136:139], v[44:47]
    global_load_dwordx4 a[248:251], v124, s[18:19]
    v_mfma_f32_16x16x32_bf16 v[64:67], v[156:159], v[140:143], v[64:67]
    v_mfma_f32_16x16x32_bf16 v[84:87], v[156:159], v[144:147], v[84:87]
    global_load_dwordx4 a[216:219], v130, s[16:17]
    v_mfma_f32_16x16x32_bf16 v[28:31], v[160:163], a[252:255], v[28:31]
    v_mfma_f32_16x16x32_bf16 v[48:51], v[160:163], v[136:139], v[48:51]
    global_load_dwordx4 a[220:223], v131, s[16:17]
    v_mfma_f32_16x16x32_bf16 v[68:71], v[160:163], v[140:143], v[68:71]
    v_mfma_f32_16x16x32_bf16 v[88:91], v[160:163], v[144:147], v[88:91]
    global_load_dwordx4 a[224:227], v132, s[16:17]
    v_mfma_f32_16x16x32_bf16 v[32:35], v[164:167], a[252:255], v[32:35]
    v_mfma_f32_16x16x32_bf16 v[52:55], v[164:167], v[136:139], v[52:55]
    global_load_dwordx4 a[228:231], v133, s[16:17]
    v_mfma_f32_16x16x32_bf16 v[72:75], v[164:167], v[140:143], v[72:75]
    v_mfma_f32_16x16x32_bf16 v[92:95], v[164:167], v[144:147], v[92:95]
    s_add_u32 s16, s16, 1024
    s_addc_u32 s17, s17, 0
    s_add_u32 s18, s18, 1024
    s_addc_u32 s19, s19, 0
    s_waitcnt vmcnt(54)
    v_mfma_f32_16x16x32_bf16 v[16:19], a[16:19], a[0:3], v[16:19]
    v_mfma_f32_16x16x32_bf16 v[36:39], a[16:19], a[4:7], v[36:39]
    global_load_dwordx4 v[148:151], v120, s[18:19]
    v_mfma_f32_16x16x32_bf16 v[56:59], a[16:19], a[8:11], v[56:59]
    v_mfma_f32_16x16x32_bf16 v[76:79], a[16:19], a[12:15], v[76:79]
    global_load_dwordx4 v[152:155], v121, s[18:19]
    v_mfma_f32_16x16x32_bf16 v[20:23], a[20:23], a[0:3], v[20:23]
    v_mfma_f32_16x16x32_bf16 v[40:43], a[20:23], a[4:7], v[40:43]
    global_load_dwordx4 v[156:159], v122, s[18:19]
    v_mfma_f32_16x16x32_bf16 v[60:63], a[20:23], a[8:11], v[60:63]
    v_mfma_f32_16x16x32_bf16 v[80:83], a[20:23], a[12:15], v[80:83]
    global_load_dwordx4 v[160:163], v123, s[18:19]
    v_mfma_f32_16x16x32_bf16 v[24:27], a[24:27], a[0:3], v[24:27]
    v_mfma_f32_16x16x32_bf16 v[44:47], a[24:27], a[4:7], v[44:47]
    global_load_dwordx4 v[164:167], v124, s[18:19]
    v_mfma_f32_16x16x32_bf16 v[64:67], a[24:27], a[8:11], v[64:67]
    v_mfma_f32_16x16x32_bf16 v[84:87], a[24:27], a[12:15], v[84:87]
    global_load_dwordx4 a[252:255], v130, s[16:17]
    v_mfma_f32_16x16x32_bf16 v[28:31], a[28:31], a[0:3], v[28:31]
    v_mfma_f32_16x16x32_bf16 v[48:51], a[28:31], a[4:7], v[48:51]
    global_load_dwordx4 v[136:139], v131, s[16:17]
    v_mfma_f32_16x16x32_bf16 v[68:71], a[28:31], a[8:11], v[68:71]
    v_mfma_f32_16x16x32_bf16 v[88:91], a[28:31], a[12:15], v[88:91]
    global_load_dwordx4 v[140:143], v132, s[16:17]
    v_mfma_f32_16x16x32_bf16 v[32:35], a[32:35], a[0:3], v[32:35]
    v_mfma_f32_16x16x32_bf16 v[52:55], a[32:35], a[4:7], v[52:55]
    global_load_dwordx4 v[144:147], v133, s[16:17]
    v_mfma_f32_16x16x32_bf16 v[72:75], a[32:35], a[8:11], v[72:75]
    v_mfma_f32_16x16x32_bf16 v[92:95], a[32:35], a[12:15], v[92:95]
    s_add_u32 s16, s16, 1024
    s_addc_u32 s17, s17, 0
    s_add_u32 s18, s18, 1024
    s_addc_u32 s19, s19, 0
    s_waitcnt vmcnt(54)
    v_mfma_f32_16x16x32_bf16 v[16:19], a[52:55], a[36:39], v[16:19]
    v_mfma_f32_16x16x32_bf16 v[36:39], a[52:55], a[40:43], v[36:39]
    global_load_dwordx4 a[16:19], v120, s[18:19]
    v_mfma_f32_16x16x32_bf16 v[56:59], a[52:55], a[44:47], v[56:59]
    v_mfma_f32_16x16x32_bf16 v[76:79], a[52:55], a[48:51], v[76:79]
    global_load_dwordx4 a[20:23], v121, s[18:19]
    v_mfma_f32_16x16x32_bf16 v[20:23], a[56:59], a[36:39], v[20:23]
    v_mfma_f32_16x16x32_bf16 v[40:43], a[56:59], a[40:43], v[40:43]
    global_load_dwordx4 a[24:27], v122, s[18:19]
    v_mfma_f32_16x16x32_bf16 v[60:63], a[56:59], a[44:47], v[60:63]
    v_mfma_f32_16x16x32_bf16 v[80:83], a[56:59], a[48:51], v[80:83]
    global_load_dwordx4 a[28:31], v123, s[18:19]
    v_mfma_f32_16x16x32_bf16 v[24:27], a[60:63], a[36:39], v[24:27]
    v_mfma_f32_16x16x32_bf16 v[44:47], a[60:63], a[40:43], v[44:47]
    global_load_dwordx4 a[32:35], v124, s[18:19]
    v_mfma_f32_16x16x32_bf16 v[64:67], a[60:63], a[44:47], v[64:67]
    v_mfma_f32_16x16x32_bf16 v[84:87], a[60:63], a[48:51], v[84:87]
    global_load_dwordx4 a[0:3], v130, s[16:17]
    v_mfma_f32_16x16x32_bf16 v[28:31], a[64:67], a[36:39], v[28:31]
    v_mfma_f32_16x16x32_bf16 v[48:51], a[64:67], a[40:43], v[48:51]
    global_load_dwordx4 a[4:7], v131, s[16:17]
    v_mfma_f32_16x16x32_bf16 v[68:71], a[64:67], a[44:47], v[68:71]
    v_mfma_f32_16x16x32_bf16 v[88:91], a[64:67], a[48:51], v[88:91]
    global_load_dwordx4 a[8:11], v132, s[16:17]
    v_mfma_f32_16x16x32_bf16 v[32:35], a[68:71], a[36:39], v[32:35]
    v_mfma_f32_16x16x32_bf16 v[52:55], a[68:71], a[40:43], v[52:55]
    global_load_dwordx4 a[12:15], v133, s[16:17]
    v_mfma_f32_16x16x32_bf16 v[72:75], a[68:71], a[44:47], v[72:75]
    v_mfma_f32_16x16x32_bf16 v[92:95], a[68:71], a[48:51], v[92:95]
    s_add_u32 s16, s16, 1024
    s_addc_u32 s17, s17, 0
    s_add_u32 s18, s18, 1024
    s_addc_u32 s19, s19, 0
    s_waitcnt vmcnt(54)
    v_mfma_f32_16x16x32_bf16 v[16:19], a[88:91], a[72:75], v[16:19]
    v_mfma_f32_16x16x32_bf16 v[36:39], a[88:91], a[76:79], v[36:39]
    v_mfma_f32_16x16x32_bf16 v[56:59], a[88:91], a[80:83], v[56:59]
    v_mfma_f32_16x16x32_bf16 v[76:79], a[88:91], a[84:87], v[76:79]
    v_mfma_f32_16x16x32_bf16 v[20:23], a[92:95], a[72:75], v[20:23]
    v_mfma_f32_16x16x32_bf16 v[40:43], a[92:95], a[76:79], v[40:43]
    v_mfma_f32_16x16x32_bf16 v[60:63], a[92:95], a[80:83], v[60:63]
    v_mfma_f32_16x16x32_bf16 v[80:83], a[92:95], a[84:87], v[80:83]
    v_mfma_f32_16x16x32_bf16 v[24:27], a[96:99], a[72:75], v[24:27]
    v_mfma_f32_16x16x32_bf16 v[44:47], a[96:99], a[76:79], v[44:47]
    v_mfma_f32_16x16x32_bf16 v[64:67], a[96:99], a[80:83], v[64:67]
    v_mfma_f32_16x16x32_bf16 v[84:87], a[96:99], a[84:87], v[84:87]
    v_mfma_f32_16x16x32_bf16 v[28:31], a[100:103], a[72:75], v[28:31]
    v_mfma_f32_16x16x32_bf16 v[48:51], a[100:103], a[76:79], v[48:51]
    v_mfma_f32_16x16x32_bf16 v[68:71], a[100:103], a[80:83], v[68:71]
    v_mfma_f32_16x16x32_bf16 v[88:91], a[100:103], a[84:87], v[88:91]
    v_mfma_f32_16x16x32_bf16 v[32:35], a[104:107], a[72:75], v[32:35]
    v_mfma_f32_16x16x32_bf16 v[52:55], a[104:107], a[76:79], v[52:55]
    v_mfma_f32_16x16x32_bf16 v[72:75], a[104:107], a[80:83], v[72:75]
    v_mfma_f32_16x16x32_bf16 v[92:95], a[104:107], a[84:87], v[92:95]
    s_waitcnt vmcnt(45)
    v_mfma_f32_16x16x32_bf16 v[16:19], a[124:127], a[108:111], v[16:19]
    v_mfma_f32_16x16x32_bf16 v[36:39], a[124:127], a[112:115], v[36:39]
    v_mfma_f32_16x16x32_bf16 v[56:59], a[124:127], a[116:119], v[56:59]
    v_mfma_f32_16x16x32_bf16 v[76:79], a[124:127], a[120:123], v[76:79]
    v_mfma_f32_16x16x32_bf16 v[20:23], a[128:131], a[108:111], v[20:23]
    v_mfma_f32_16x16x32_bf16 v[40:43], a[128:131], a[112:115], v[40:43]
    v_mfma_f32_16x16x32_bf16 v[60:63], a[128:131], a[116:119], v[60:63]
    v_mfma_f32_16x16x32_bf16 v[80:83], a[128:131], a[120:123], v[80:83]
    v_mfma_f32_16x16x32_bf16 v[24:27], a[132:135], a[108:111], v[24:27]
    v_mfma_f32_16x16x32_bf16 v[44:47], a[132:135], a[112:115], v[44:47]
    v_mfma_f32_16x16x32_bf16 v[64:67], a[132:135], a[116:119], v[64:67]
    v_mfma_f32_16x16x32_bf16 v[84:87], a[132:135], a[120:123], v[84:87]
    v_mfma_f32_16x16x32_bf16 v[28:31], a[136:139], a[108:111], v[28:31]
    v_mfma_f32_16x16x32_bf16 v[48:51], a[136:139], a[112:115], v[48:51]
    v_mfma_f32_16x16x32_bf16 v[68:71], a[136:139], a[116:119], v[68:71]
    v_mfma_f32_16x16x32_bf16 v[88:91], a[136:139], a[120:123], v[88:91]
    v_mfma_f32_16x16x32_bf16 v[32:35], a[140:143], a[108:111], v[32:35]
    v_mfma_f32_16x16x32_bf16 v[52:55], a[140:143], a[112:115], v[52:55]
    v_mfma_f32_16x16x32_bf16 v[72:75], a[140:143], a[116:119], v[72:75]
    v_mfma_f32_16x16x32_bf16 v[92:95], a[140:143], a[120:123], v[92:95]
    s_waitcnt vmcnt(36)
    v_mfma_f32_16x16x32_bf16 v[16:19], a[160:163], a[144:147], v[16:19]
    v_mfma_f32_16x16x32_bf16 v[36:39], a[160:163], a[148:151], v[36:39]
    v_mfma_f32_16x16x32_bf16 v[56:59], a[160:163], a[152:155], v[56:59]
    v_mfma_f32_16x16x32_bf16 v[76:79], a[160:163], a[156:159], v[76:79]
    v_mfma_f32_16x16x32_bf16 v[20:23], a[164:167], a[144:147], v[20:23]
    v_mfma_f32_16x16x32_bf16 v[40:43], a[164:167], a[148:151], v[40:43]
    v_mfma_f32_16x16x32_bf16 v[60:63], a[164:167], a[152:155], v[60:63]
    v_mfma_f32_16x16x32_bf16 v[80:83], a[164:167], a[156:159], v[80:83]
    v_mfma_f32_16x16x32_bf16 v[24:27], a[168:171], a[144:147], v[24:27]
    v_mfma_f32_16x16x32_bf16 v[44:47], a[168:171], a[148:151], v[44:47]
    v_mfma_f32_16x16x32_bf16 v[64:67], a[168:171], a[152:155], v[64:67]
    v_mfma_f32_16x16x32_bf16 v[84:87], a[168:171], a[156:159], v[84:87]
    v_mfma_f32_16x16x32_bf16 v[28:31], a[172:175], a[144:147], v[28:31]
    v_mfma_f32_16x16x32_bf16 v[48:51], a[172:175], a[148:151], v[48:51]
    v_mfma_f32_16x16x32_bf16 v[68:71], a[172:175], a[152:155], v[68:71]
    v_mfma_f32_16x16x32_bf16 v[88:91], a[172:175], a[156:159], v[88:91]
    v_mfma_f32_16x16x32_bf16 v[32:35], a[176:179], a[144:147], v[32:35]
    v_mfma_f32_16x16x32_bf16 v[52:55], a[176:179], a[148:151], v[52:55]
    v_mfma_f32_16x16x32_bf16 v[72:75], a[176:179], a[152:155], v[72:75]
    v_mfma_f32_16x16x32_bf16 v[92:95], a[176:179], a[156:159], v[92:95]
    s_waitcnt vmcnt(27)
    v_mfma_f32_16x16x32_bf16 v[16:19], a[196:199], a[180:183], v[16:19]
    v_mfma_f32_16x16x32_bf16 v[36:39], a[196:199], a[184:187], v[36:39]
    v_mfma_f32_16x16x32_bf16 v[56:59], a[196:199], a[188:191], v[56:59]
    v_mfma_f32_16x16x32_bf16 v[76:79], a[196:199], a[192:195], v[76:79]
    v_mfma_f32_16x16x32_bf16 v[20:23], a[200:203], a[180:183], v[20:23]
    v_mfma_f32_16x16x32_bf16 v[40:43], a[200:203], a[184:187], v[40:43]
    v_mfma_f32_16x16x32_bf16 v[60:63], a[200:203], a[188:191], v[60:63]
    v_mfma_f32_16x16x32_bf16 v[80:83], a[200:203], a[192:195], v[80:83]
    v_mfma_f32_16x16x32_bf16 v[24:27], a[204:207], a[180:183], v[24:27]
    v_mfma_f32_16x16x32_bf16 v[44:47], a[204:207], a[184:187], v[44:47]
    v_mfma_f32_16x16x32_bf16 v[64:67], a[204:207], a[188:191], v[64:67]
    v_mfma_f32_16x16x32_bf16 v[84:87], a[204:207], a[192:195], v[84:87]
    v_mfma_f32_16x16x32_bf16 v[28:31], a[208:211], a[180:183], v[28:31]
    v_mfma_f32_16x16x32_bf16 v[48:51], a[208:211], a[184:187], v[48:51]
    v_mfma_f32_16x16x32_bf16 v[68:71], a[208:211], a[188:191], v[68:71]
    v_mfma_f32_16x16x32_bf16 v[88:91], a[208:211], a[192:195], v[88:91]
    v_mfma_f32_16x16x32_bf16 v[32:35], a[212:215], a[180:183], v[32:35]
    v_mfma_f32_16x16x32_bf16 v[52:55], a[212:215], a[184:187], v[52:55]
    v_mfma_f32_16x16x32_bf16 v[72:75], a[212:215], a[188:191], v[72:75]
    v_mfma_f32_16x16x32_bf16 v[92:95], a[212:215], a[192:195], v[92:95]
    s_waitcnt vmcnt(18)
    v_mfma_f32_16x16x32_bf16 v[16:19], a[232:235], a[216:219], v[16:19]
    v_mfma_f32_16x16x32_bf16 v[36:39], a[232:235], a[220:223], v[36:39]
    v_mfma_f32_16x16x32_bf16 v[56:59], a[232:235], a[224:227], v[56:59]
    v_mfma_f32_16x16x32_bf16 v[76:79], a[232:235], a[228:231], v[76:79]
    v_mfma_f32_16x16x32_bf16 v[20:23], a[236:239], a[216:219], v[20:23]
    v_mfma_f32_16x16x32_bf16 v[40:43], a[236:239], a[220:223], v[40:43]
    v_mfma_f32_16x16x32_bf16 v[60:63], a[236:239], a[224:227], v[60:63]
    v_mfma_f32_16x16x32_bf16 v[80:83], a[236:239], a[228:231], v[80:83]
    v_mfma_f32_16x16x32_bf16 v[24:27], a[240:243], a[216:219], v[24:27]
    v_mfma_f32_16x16x32_bf16 v[44:47], a[240:243], a[220:223], v[44:47]
    v_mfma_f32_16x16x32_bf16 v[64:67], a[240:243], a[224:227], v[64:67]
    v_mfma_f32_16x16x32_bf16 v[84:87], a[240:243], a[228:231], v[84:87]
    v_mfma_f32_16x16x32_bf16 v[28:31], a[244:247], a[216:219], v[28:31]
    v_mfma_f32_16x16x32_bf16 v[48:51], a[244:247], a[220:223], v[48:51]
    v_mfma_f32_16x16x32_bf16 v[68:71], a[244:247], a[224:227], v[68:71]
    v_mfma_f32_16x16x32_bf16 v[88:91], a[244:247], a[228:231], v[88:91]
    v_mfma_f32_16x16x32_bf16 v[32:35], a[248:251], a[216:219], v[32:35]
    v_mfma_f32_16x16x32_bf16 v[52:55], a[248:251], a[220:223], v[52:55]
    v_mfma_f32_16x16x32_bf16 v[72:75], a[248:251], a[224:227], v[72:75]
    v_mfma_f32_16x16x32_bf16 v[92:95], a[248:251], a[228:231], v[92:95]
    s_waitcnt vmcnt(9)
    v_mfma_f32_16x16x32_bf16 v[16:19], v[148:151], a[252:255], v[16:19]
    v_mfma_f32_16x16x32_bf16 v[36:39], v[148:151], v[136:139], v[36:39]
    v_mfma_f32_16x16x32_bf16 v[56:59], v[148:151], v[140:143], v[56:59]
    v_mfma_f32_16x16x32_bf16 v[76:79], v[148:151], v[144:147], v[76:79]
    v_mfma_f32_16x16x32_bf16 v[20:23], v[152:155], a[252:255], v[20:23]
    v_mfma_f32_16x16x32_bf16 v[40:43], v[152:155], v[136:139], v[40:43]
    v_mfma_f32_16x16x32_bf16 v[60:63], v[152:155], v[140:143], v[60:63]
    v_mfma_f32_16x16x32_bf16 v[80:83], v[152:155], v[144:147], v[80:83]
    v_mfma_f32_16x16x32_bf16 v[24:27], v[156:159], a[252:255], v[24:27]
    v_mfma_f32_16x16x32_bf16 v[44:47], v[156:159], v[136:139], v[44:47]
    v_mfma_f32_16x16x32_bf16 v[64:67], v[156:159], v[140:143], v[64:67]
    v_mfma_f32_16x16x32_bf16 v[84:87], v[156:159], v[144:147], v[84:87]
    v_mfma_f32_16x16x32_bf16 v[28:31], v[160:163], a[252:255], v[28:31]
    v_mfma_f32_16x16x32_bf16 v[48:51], v[160:163], v[136:139], v[48:51]
    v_mfma_f32_16x16x32_bf16 v[68:71], v[160:163], v[140:143], v[68:71]
    v_mfma_f32_16x16x32_bf16 v[88:91], v[160:163], v[144:147], v[88:91]
    v_mfma_f32_16x16x32_bf16 v[32:35], v[164:167], a[252:255], v[32:35]
    v_mfma_f32_16x16x32_bf16 v[52:55], v[164:167], v[136:139], v[52:55]
    v_mfma_f32_16x16x32_bf16 v[72:75], v[164:167], v[140:143], v[72:75]
    v_mfma_f32_16x16x32_bf16 v[92:95], v[164:167], v[144:147], v[92:95]
    s_waitcnt vmcnt(0)
    v_mfma_f32_16x16x32_bf16 v[16:19], a[16:19], a[0:3], v[16:19]
    v_mfma_f32_16x16x32_bf16 v[36:39], a[16:19], a[4:7], v[36:39]
    v_mfma_f32_16x16x32_bf16 v[56:59], a[16:19], a[8:11], v[56:59]
    v_mfma_f32_16x16x32_bf16 v[76:79], a[16:19], a[12:15], v[76:79]
    v_mfma_f32_16x16x32_bf16 v[20:23], a[20:23], a[0:3], v[20:23]
    v_mfma_f32_16x16x32_bf16 v[40:43], a[20:23], a[4:7], v[40:43]
    v_mfma_f32_16x16x32_bf16 v[60:63], a[20:23], a[8:11], v[60:63]
    v_mfma_f32_16x16x32_bf16 v[80:83], a[20:23], a[12:15], v[80:83]
    v_mfma_f32_16x16x32_bf16 v[24:27], a[24:27], a[0:3], v[24:27]
    v_mfma_f32_16x16x32_bf16 v[44:47], a[24:27], a[4:7], v[44:47]
    v_mfma_f32_16x16x32_bf16 v[64:67], a[24:27], a[8:11], v[64:67]
    v_mfma_f32_16x16x32_bf16 v[84:87], a[24:27], a[12:15], v[84:87]
    v_mfma_f32_16x16x32_bf16 v[28:31], a[28:31], a[0:3], v[28:31]
    v_mfma_f32_16x16x32_bf16 v[48:51], a[28:31], a[4:7], v[48:51]
    v_mfma_f32_16x16x32_bf16 v[68:71], a[28:31], a[8:11], v[68:71]
    v_mfma_f32_16x16x32_bf16 v[88:91], a[28:31], a[12:15], v[88:91]
    v_mfma_f32_16x16x32_bf16 v[32:35], a[32:35], a[0:3], v[32:35]
    v_mfma_f32_16x16x32_bf16 v[52:55], a[32:35], a[4:7], v[52:55]
    v_mfma_f32_16x16x32_bf16 v[72:75], a[32:35], a[8:11], v[72:75]
    v_mfma_f32_16x16x32_bf16 v[92:95], a[32:35], a[12:15], v[92:95]
    s_nop 7
    s_nop 1
L_k3_red:
    s_lshl_b32 s12, s12, 6
    v_add_u32 v6, 0, v0
    v_mul_u32_u24 v7, 6554, v6
    v_lshrrev_b32 v7, 16, v7
    v_mul_u32_u24 v8, 10, v7
    v_sub_u32 v8, v6, v8
    v_add_u32 v9, s12, v7
    v_mul_u32_u24 v9, 1280, v9
    v_lshl_add_u32 v9, v8, 4, v9
    v_add_u32 v96, s13, v9
    v_mul_u32_u24 v9, 336, v7
    v_lshl_add_u32 v100, v8, 5, v9
    v_add_u32 v104, 43008, v100

    v_add_u32 v6, 256, v0
    v_mul_u32_u24 v7, 6554, v6
    v_lshrrev_b32 v7, 16, v7
    v_mul_u32_u24 v8, 10, v7
    v_sub_u32 v8, v6, v8
    v_add_u32 v9, s12, v7
    v_mul_u32_u24 v9, 1280, v9
    v_lshl_add_u32 v9, v8, 4, v9
    v_add_u32 v97, s13, v9
    v_mul_u32_u24 v9, 336, v7
    v_lshl_add_u32 v101, v8, 5, v9
    v_add_u32 v105, 43008, v101

    v_add_u32 v6, 512, v0
    v_mul_u32_u24 v7, 6554, v6
    v_lshrrev_b32 v7, 16, v7
    v_mul_u32_u24 v8, 10, v7
    v_sub_u32 v8, v6, v8
    v_add_u32 v9, s12, v7
    v_mul_u32_u24 v9, 1280, v9
    v_lshl_add_u32 v9, v8, 4, v9
    v_add_u32 v98, s13, v9
    v_mul_u32_u24 v9, 336, v7
    v_lshl_add_u32 v102, v8, 5, v9
    v_add_u32 v106, 43008, v102

    v_cmp_gt_u32 vcc, 128, v0
    s_nop 3
    s_mov_b64 s[26:27], vcc
    global_load_dwordx4 v[108:111], v96, s[4:5]
    global_load_dwordx4 v[112:115], v97, s[4:5]
    s_mov_b64 exec, s[26:27]
    s_cbranch_execz L_k3_nox
    global_load_dwordx4 v[116:119], v98, s[4:5]
L_k3_nox:
    s_mov_b64 exec, -1
    s_barrier
    s_mul_i32 s22, s14, 21504
    v_mul_u32_u24 v7, 336, v3
    v_lshl_add_u32 v7, v4, 4, v7
    v_add_u32 v7, s22, v7

    ds_write_b128 v7, v[16:19] offset:0
    ds_write_b128 v7, v[20:23] offset:64
    ds_write_b128 v7, v[24:27] offset:128
    ds_write_b128 v7, v[28:31] offset:192
    ds_write_b128 v7, v[32:35] offset:256
    ds_write_b128 v7, v[36:39] offset:5376
    ds_write_b128 v7, v[40:43] offset:5440
    ds_write_b128 v7, v[44:47] offset:5504
    ds_write_b128 v7, v[48:51] offset:5568
    ds_write_b128 v7, v[52:55] offset:5632
    ds_write_b128 v7, v[56:59] offset:10752
    ds_write_b128 v7, v[60:63] offset:10816
    ds_write_b128 v7, v[64:67] offset:10880
    ds_write_b128 v7, v[68:71] offset:10944
    ds_write_b128 v7, v[72:75] offset:11008
    ds_write_b128 v7, v[76:79] offset:16128
    ds_write_b128 v7, v[80:83] offset:16192
    ds_write_b128 v7, v[84:87] offset:16256
    ds_write_b128 v7, v[88:91] offset:16320
    ds_write_b128 v7, v[92:95] offset:16384
    s_waitcnt lgkmcnt(0)
    s_barrier
    ds_read_b128 v[120:123], v100 offset:0
    ds_read_b128 v[124:127], v100 offset:16
    ds_read_b128 v[128:131], v100 offset:21504
    ds_read_b128 v[132:135], v100 offset:21520
    ds_read_b128 v[136:139], v104 offset:0
    ds_read_b128 v[140:143], v104 offset:16
    ds_read_b128 v[144:147], v104 offset:21504
    ds_read_b128 v[148:151], v104 offset:21520
    ds_read_b128 v[152:155], v101 offset:0
    ds_read_b128 v[156:159], v101 offset:16
    ds_read_b128 v[160:163], v101 offset:21504
    ds_read_b128 v[164:167], v101 offset:21520
    ds_read_b128 v[168:171], v105 offset:0
    ds_read_b128 v[172:175], v105 offset:16
    ds_read_b128 v[176:179], v105 offset:21504
    ds_read_b128 v[180:183], v105 offset:21520
    ds_read_b128 v[184:187], v102 offset:0
    ds_read_b128 v[188:191], v102 offset:16
    ds_read_b128 v[192:195], v102 offset:21504
    ds_read_b128 v[196:199], v102 offset:21520
    ds_read_b128 v[200:203], v106 offset:0
    ds_read_b128 v[204:207], v106 offset:16
    ds_read_b128 v[208:211], v106 offset:21504
    ds_read_b128 v[212:215], v106 offset:21520
    s_waitcnt vmcnt(0)
    s_waitcnt lgkmcnt(15)
    v_pk_add_f32 v[120:121], v[120:121], v[128:129]
    v_pk_add_f32 v[136:137], v[136:137], v[144:145]
    v_pk_add_f32 v[122:123], v[122:123], v[130:131]
    v_pk_add_f32 v[138:139], v[138:139], v[146:147]
    v_pk_add_f32 v[124:125], v[124:125], v[132:133]
    v_pk_add_f32 v[140:141], v[140:141], v[148:149]
    v_pk_add_f32 v[126:127], v[126:127], v[134:135]
    v_pk_add_f32 v[142:143], v[142:143], v[150:151]
    v_pk_add_f32 v[120:121], v[120:121], v[136:137]
    v_pk_add_f32 v[122:123], v[122:123], v[138:139]
    v_pk_add_f32 v[124:125], v[124:125], v[140:141]
    v_pk_add_f32 v[126:127], v[126:127], v[142:143]
    v_lshlrev_b32 v12, 16, v108
    v_and_b32 v13, 0xffff0000, v108
    v_add_f32 v120, v120, v12
    v_add_f32 v121, v121, v13
    v_cvt_pk_bf16_f32 v108, v120, v121

    v_lshlrev_b32 v12, 16, v109
    v_and_b32 v13, 0xffff0000, v109
    v_add_f32 v122, v122, v12
    v_add_f32 v123, v123, v13
    v_cvt_pk_bf16_f32 v109, v122, v123

    v_lshlrev_b32 v12, 16, v110
    v_and_b32 v13, 0xffff0000, v110
    v_add_f32 v124, v124, v12
    v_add_f32 v125, v125, v13
    v_cvt_pk_bf16_f32 v110, v124, v125

    v_lshlrev_b32 v12, 16, v111
    v_and_b32 v13, 0xffff0000, v111
    v_add_f32 v126, v126, v12
    v_add_f32 v127, v127, v13
    v_cvt_pk_bf16_f32 v111, v126, v127

    global_store_dwordx4 v96, v[108:111], s[24:25]
    s_waitcnt lgkmcnt(8)
    v_pk_add_f32 v[152:153], v[152:153], v[160:161]
    v_pk_add_f32 v[168:169], v[168:169], v[176:177]
    v_pk_add_f32 v[154:155], v[154:155], v[162:163]
    v_pk_add_f32 v[170:171], v[170:171], v[178:179]
    v_pk_add_f32 v[156:157], v[156:157], v[164:165]
    v_pk_add_f32 v[172:173], v[172:173], v[180:181]
    v_pk_add_f32 v[158:159], v[158:159], v[166:167]
    v_pk_add_f32 v[174:175], v[174:175], v[182:183]
    v_pk_add_f32 v[152:153], v[152:153], v[168:169]
    v_pk_add_f32 v[154:155], v[154:155], v[170:171]
    v_pk_add_f32 v[156:157], v[156:157], v[172:173]
    v_pk_add_f32 v[158:159], v[158:159], v[174:175]
    v_lshlrev_b32 v12, 16, v112
    v_and_b32 v13, 0xffff0000, v112
    v_add_f32 v152, v152, v12
    v_add_f32 v153, v153, v13
    v_cvt_pk_bf16_f32 v112, v152, v153

    v_lshlrev_b32 v12, 16, v113
    v_and_b32 v13, 0xffff0000, v113
    v_add_f32 v154, v154, v12
    v_add_f32 v155, v155, v13
    v_cvt_pk_bf16_f32 v113, v154, v155

    v_lshlrev_b32 v12, 16, v114
    v_and_b32 v13, 0xffff0000, v114
    v_add_f32 v156, v156, v12
    v_add_f32 v157, v157, v13
    v_cvt_pk_bf16_f32 v114, v156, v157

    v_lshlrev_b32 v12, 16, v115
    v_and_b32 v13, 0xffff0000, v115
    v_add_f32 v158, v158, v12
    v_add_f32 v159, v159, v13
    v_cvt_pk_bf16_f32 v115, v158, v159

    global_store_dwordx4 v97, v[112:115], s[24:25]
    s_waitcnt lgkmcnt(0)
    v_pk_add_f32 v[184:185], v[184:185], v[192:193]
    v_pk_add_f32 v[200:201], v[200:201], v[208:209]
    v_pk_add_f32 v[186:187], v[186:187], v[194:195]
    v_pk_add_f32 v[202:203], v[202:203], v[210:211]
    v_pk_add_f32 v[188:189], v[188:189], v[196:197]
    v_pk_add_f32 v[204:205], v[204:205], v[212:213]
    v_pk_add_f32 v[190:191], v[190:191], v[198:199]
    v_pk_add_f32 v[206:207], v[206:207], v[214:215]
    v_pk_add_f32 v[184:185], v[184:185], v[200:201]
    v_pk_add_f32 v[186:187], v[186:187], v[202:203]
    v_pk_add_f32 v[188:189], v[188:189], v[204:205]
    v_pk_add_f32 v[190:191], v[190:191], v[206:207]
    v_lshlrev_b32 v12, 16, v116
    v_and_b32 v13, 0xffff0000, v116
    v_add_f32 v184, v184, v12
    v_add_f32 v185, v185, v13
    v_cvt_pk_bf16_f32 v116, v184, v185

    v_lshlrev_b32 v12, 16, v117
    v_and_b32 v13, 0xffff0000, v117
    v_add_f32 v186, v186, v12
    v_add_f32 v187, v187, v13
    v_cvt_pk_bf16_f32 v117, v186, v187

    v_lshlrev_b32 v12, 16, v118
    v_and_b32 v13, 0xffff0000, v118
    v_add_f32 v188, v188, v12
    v_add_f32 v189, v189, v13
    v_cvt_pk_bf16_f32 v118, v188, v189

    v_lshlrev_b32 v12, 16, v119
    v_and_b32 v13, 0xffff0000, v119
    v_add_f32 v190, v190, v12
    v_add_f32 v191, v191, v13
    v_cvt_pk_bf16_f32 v119, v190, v191

    s_mov_b64 exec, s[26:27]
    s_cbranch_execz L_k3_nost
    global_store_dwordx4 v98, v[116:119], s[24:25]
L_k3_nost:
    s_waitcnt vmcnt(0)
    s_mov_b64 exec, -1
L_k3_done:
    s_endpgm
.section .rodata,"a"
.p2align 6
.amdhsa_kernel gemm1_kernel
  .amdhsa_next_free_vgpr 232
  .amdhsa_next_free_sgpr 100
  .amdhsa_accum_offset 176
  .amdhsa_group_segment_fixed_size 0
  .amdhsa_kernarg_size 80
  .amdhsa_user_sgpr_count 2
  .amdhsa_user_sgpr_kernarg_segment_ptr 1
  .amdhsa_system_sgpr_workgroup_id_x 1
.end_amdhsa_kernel
.p2align 6
.amdhsa_kernel attn_kernel
  .amdhsa_next_free_vgpr 256
  .amdhsa_next_free_sgpr 100
  .amdhsa_accum_offset 256
  .amdhsa_group_segment_fixed_size 0
  .amdhsa_kernarg_size 80
  .amdhsa_user_sgpr_count 2
  .amdhsa_user_sgpr_kernarg_segment_ptr 1
  .amdhsa_system_sgpr_workgroup_id_x 1
.end_amdhsa_kernel
.p2align 6
.amdhsa_kernel gemm2_kernel
  .amdhsa_next_free_vgpr 472
  .amdhsa_next_free_sgpr 100
  .amdhsa_accum_offset 216
  .amdhsa_group_segment_fixed_size 0
  .amdhsa_kernarg_size 80
  .amdhsa_user_sgpr_count 2
  .amdhsa_user_sgpr_kernarg_segment_ptr 1
  .amdhsa_system_sgpr_workgroup_id_x 1
.end_amdhsa_kernel
```
